```python
import torch

def _softmax(x, axis=-1):
    return torch.softmax(x, dim=axis)
def _gelu(x):
    return torch.nn.functional.gelu(x, approximate="tanh")
def _silu(x):
    return torch.nn.functional.silu(x)
def _sigmoid(x):
    return torch.sigmoid(x)
def _layernorm(x, axis=-1, eps=1e-5):
    m = x.mean(dim=axis, keepdim=True)
    v = x.var(dim=axis, keepdim=True, unbiased=False)
    return (x - m) / torch.sqrt(v + eps)
def _scatter_add(tgt, idx, src, axis=0):
    return tgt.clone().index_add_(axis, idx, src)
def _segment_sum(src, seg, n):
    out = torch.zeros((n,) + src.shape[1:], dtype=src.dtype)
    return out.index_add_(0, seg, src)
def _pad(x, pw):
    flat = tuple(v for pair in reversed(pw) for v in pair)
    return torch.nn.functional.pad(x, flat)

kernel_name = 'recurrent_scan__sliding_block_cached__glu_gated_glu__prompt'

def setup_inputs():

    _w = (lambda a: (lambda t: t.to(torch.bfloat16) if t.is_floating_point() else t)(torch.as_tensor(a)))
    def _A_setup():
        B, Sq, D = 1, 2048, 512
        Hq, Hkv, Sk, Dh = 32, 32, 2048, 128
        assert Hq % Hkv == 0, (Hq, Hkv)
        return {
            "x": _w((lambda *s: torch.randn(*s, dtype=torch.bfloat16) * 0.05)(B, Sq, D)),
            "k_cache": _w((lambda *s: torch.randn(*s, dtype=torch.bfloat16) * 0.8)(B, Hkv, Sk, Dh)),
            "v_cache": _w((lambda *s: torch.randn(*s, dtype=torch.bfloat16) * 0.2)(B, Hkv, Sk, Dh)),
            "wq": _w((lambda *s: torch.randn(*s, dtype=torch.bfloat16) * 0.8)(D, Hq * Dh) * (D ** -0.5)),
            "wo": _w((lambda *s: torch.randn(*s, dtype=torch.bfloat16) * 0.2)(Hq * Dh, D) * ((Hq * Dh) ** -0.5)),
        }
    _A_in = _A_setup()

    def _B_setup():
        B, S, D, F = 1, 2048, 512, 1376
        return {
            "x": _w((lambda *s: torch.randn(*s, dtype=torch.bfloat16) * 0.05)(B, S, D)),
            "w_gate": _w((lambda *s: torch.randn(*s, dtype=torch.bfloat16) * 0.2)(D, F)),
            "w_up": _w((lambda *s: torch.randn(*s, dtype=torch.bfloat16) * 0.1)(D, F)),
            "w_down": _w((lambda *s: torch.randn(*s, dtype=torch.bfloat16) * 0.1)(F, D)),
        }
    _B_in = _B_setup()

    return {
        "A_x": _A_in["x"],
        "A_k_cache": _A_in["k_cache"],
        "A_v_cache": _A_in["v_cache"],
        "A_wq": _A_in["wq"],
        "A_wo": _A_in["wo"],
        "B_x": _B_in["x"],
        "B_w_gate": _B_in["w_gate"],
        "B_w_up": _B_in["w_up"],
        "B_w_down": _B_in["w_down"],
    }

def reference(A_x, A_k_cache, A_v_cache, A_wq, A_wo, B_x, B_w_gate, B_w_up, B_w_down):
    def _A_ref(x, k_cache, v_cache, wq, wo):
        B, Sq, D = x.shape
        Hq, Dh = 32, 128
        Hkv, Sk = k_cache.shape[1], k_cache.shape[2]
        W = min(4096, max(256, Sk // 4))
        rep = Hq // Hkv
        q = (lambda x, *d: x.permute(*d))((x @ wq).reshape(B, Sq, Hq, Dh), 0, 2, 1, 3)
        k = (lambda x, n, axis: torch.repeat_interleave(x, n, dim=axis))(k_cache[:, :, Sk - W:, :], rep, axis=1)
        v = (lambda x, n, axis: torch.repeat_interleave(x, n, dim=axis))(v_cache[:, :, Sk - W:, :], rep, axis=1)
        scores = torch.einsum("bhqd,bhkd->bhqk", q, k) * (Dh ** -0.5)
        p = _softmax(scores, axis=-1)
        o = torch.einsum("bhqk,bhkd->bhqd", p, v)
        return (lambda x, *d: x.permute(*d))(o, 0, 2, 1, 3).reshape(B, Sq, Hq * Dh) @ wo

    def _B_ref(x, w_gate, w_up, w_down):
        g = torch.einsum("bsd,df->bsf", x, w_gate)
        u = torch.einsum("bsd,df->bsf", x, w_up)
        h = _sigmoid(g) * u
        return torch.einsum("bsf,fd->bsd", h, w_down)

    x = A_x
    xn = _layernorm(x, axis=-1)
    s = _A_ref(xn, A_k_cache, A_v_cache, A_wq, A_wo)
    g = _silu(_B_ref(xn, B_w_gate, B_w_up, B_w_down))
    return x + s * g
```

```asm
; @launch grid=(256,1,1) block=(256,1,1) lds=140288
.amdgcn_target "amdgcn-amd-amdhsa--gfx950"
.text
.globl recurrent_scan__sliding_block_cached__glu_gated_glu__prompt_kernel
.p2align 8
.type recurrent_scan__sliding_block_cached__glu_gated_glu__prompt_kernel,@function
recurrent_scan__sliding_block_cached__glu_gated_glu__prompt_kernel:
  s_cmp_ge_u32 s2, 256
  s_cbranch_scc1 L_end
  s_load_dwordx16 s[52:67], s[0:1], 0
  s_load_dwordx8 s[72:79], s[0:1], 64
  s_getpc_b64 s[80:81]
  v_and_b32 v1, 63, v0
  v_lshrrev_b32 v2, 6, v0
  s_and_b32 s45, s2, 7
  v_readfirstlane_b32 s28, v2
  s_mov_b32 s82, 36864
  s_mov_b32 s83, 0x00020000
  v_lshlrev_b32 v4, 7, v0
  buffer_load_dword v5, v4, s[80:83], 0 offen
  s_mov_b32 s44, 32768
  buffer_load_dword v5, v4, s[80:83], s44 offen
  s_bfe_u32 s69, s2, 0x20003
  s_lshl_b32 s29, s45, 2
  s_add_u32 s29, s29, s69
  s_lshr_b32 s30, s2, 5
  s_lshr_b32 s68, s45, 1
  s_and_b32 s45, s45, 1
  s_lshl_b32 s70, s30, 1
  s_add_u32 s70, s70, s45
  s_lshl_b32 s70, s70, 2
  s_add_u32 s70, s70, s28
  s_mul_i32 s44, s29, 2807558
  s_lshr_b32 s31, s44, 20
  v_bfe_u32 v2, v1, 2, 2
  v_lshrrev_b32 v3, 4, v1
  v_lshl_add_u32 v2, v3, 4, v2
  s_lshl_b32 s44, s30, 8
  s_lshl_b32 s45, s28, 6
  s_add_u32 s44, s44, s45
  v_add_u32 v2, s44, v2
  v_lshlrev_b32 v2, 10, v2
  v_and_b32 v4, 3, v1
  v_lshl_add_u32 v17, v4, 4, v2
  v_add_u32 v18, 3056, v17
  v_add_u32 v19, 6112, v17
  v_add_u32 v20, 9168, v17
  s_and_b32 s45, s28, 1
  s_lshl_b32 s46, s45, 3
  v_and_b32 v4, 15, v1
  v_xor_b32 v4, s46, v4
  v_lshlrev_b32 v4, 4, v4
  s_lshr_b32 s44, s28, 1
  s_lshl_b32 s44, s44, 4
  s_lshl_b32 s45, s45, 1
  s_add_u32 s44, s44, s45
  v_lshl_add_u32 v2, v3, 2, s44
  v_lshlrev_b32 v2, 13, v2
  s_lshl_b32 s45, s29, 8
  v_add3_u32 v21, v2, v4, s45
  v_add_u32 v22, 7104, v21
  v_lshrrev_b32 v2, 2, v1
  v_and_b32 v9, 3, v1
  v_bfe_u32 v6, v1, 1, 3
  v_and_b32 v7, 1, v1
  v_add_u32 v7, 4, v7
  v_subrev_u32 v8, 36, v1
  v_cmp_gt_u32 vcc, 32, v1
  v_lshrrev_b32 v4, 1, v8
  s_lshl_b32 s44, s28, 3
  v_cndmask_b32 v9, v7, v9, vcc
  v_cndmask_b32 v6, v6, v2, vcc
  v_cndmask_b32 v4, v4, v2, vcc
  s_mul_i32 s44, s44, 2752
  s_lshl_b32 s45, s31, 5
  s_add_u32 s44, s44, s45
  v_lshl_add_u32 v9, v9, 4, s44
  s_movk_i32 s45, 2752
  v_mad_u32_u24 v6, v6, s45, v9
  v_mad_u32_u24 v4, v4, s45, v9
  v_mov_b32 v2, 0x40000000
  v_cmp_gt_u32 s[46:47], 16, v8
  s_or_b64 s[46:47], s[46:47], vcc
  v_cmp_gt_u32 vcc, 48, v1
  s_mul_i32 s38, s28, 4160
  v_cndmask_b32 v24, v2, v4, s[46:47]
  v_cndmask_b32 v23, v2, v6, vcc
  s_mul_i32 s39, s28, 4352
  s_add_u32 s39, s39, 16640
  s_lshr_b32 s44, s30, 1
  s_lshl_b32 s44, s44, 2
  s_mov_b32 s43, s44
  s_and_b32 s48, s30, 1
  s_lshl_b32 s48, s48, 1
  s_add_u32 s48, s48, 1
  s_mov_b32 s51, 15
  s_mov_b32 s35, 64
  s_mov_b32 s36, 262144
  s_mov_b32 s37, 88064
  s_mov_b32 s42, 0
  s_mov_b32 s49, 34048
  s_mov_b32 s50, 4294865152
  v_lshlrev_b32 v25, 4, v1
  s_waitcnt lgkmcnt(0)
  s_mov_b32 s4, s52
  s_mov_b32 s5, s53
  s_mov_b32 s6, 2097152
  s_mov_b32 s7, 0x00020000
  s_mov_b32 s8, s58
  s_mov_b32 s9, s59
  s_mov_b32 s10, 4194304
  s_mov_b32 s11, 0x00020000
  s_sub_u32 s12, s64, 2176
  s_subb_u32 s13, s65, 0
  s_mov_b32 s14, 1411200
  s_mov_b32 s15, 0x00020000
  s_sub_u32 s16, s66, 3264
  s_subb_u32 s17, s67, 0
  s_mov_b32 s18, 1412288
  s_mov_b32 s19, 0x00020000
  s_add_u32 m0, s38, s42
  s_mul_i32 s32, s43, s35
  buffer_load_dwordx4 v17, s[4:7], s32 offen lds
  buffer_load_dwordx4 v18, s[4:7], s32 offen offset:1040 lds
  buffer_load_dwordx4 v19, s[4:7], s32 offen offset:2080 lds
  buffer_load_dwordx4 v20, s[4:7], s32 offen offset:3120 lds
  s_add_u32 m0, s39, s42
  s_mul_i32 s33, s43, s36
  buffer_load_dwordx4 v21, s[8:11], s33 offen lds
  buffer_load_dwordx4 v22, s[8:11], s33 offen offset:1088 lds
  s_mul_i32 s34, s43, s37
  buffer_load_dwordx4 v23, s[12:15], s34 offen offset:2176 lds
  s_add_u32 s43, s43, 1
  s_and_b32 s43, s43, s51
  buffer_load_dwordx4 v24, s[16:19], s34 offen offset:3264 lds
  s_add_u32 s42, s42, s49
  s_cmp_eq_u32 s42, 136192
  s_cmov_b32 s42, 0
  s_cmp_eq_u32 s42, 68096
  s_cselect_b32 s40, s50, s49
  v_lshrrev_b32 v3, 5, v1
  v_bfe_u32 v4, v1, 2, 2
  v_and_b32 v37, 3, v1
  v_bfe_u32 v6, v1, 4, 1
  s_movk_i32 s45, 1040
  v_mul_u32_u24 v7, s45, v4
  v_lshl_add_u32 v8, v6, 2, v37
  v_lshl_add_u32 v7, v8, 6, v7
  v_lshl_add_u32 v7, v3, 4, v7
  s_mul_i32 s46, s28, 4160
  v_add_u32 v10, s46, v7
  v_and_b32 v7, 15, v1
  v_mul_u32_u24 v7, s45, v7
  v_lshl_add_u32 v7, v6, 8, v7
  v_lshl_add_u32 v15, v3, 4, v7
  v_lshlrev_b32 v9, 5, v6
  v_lshl_add_u32 v9, v37, 3, v9
  v_and_b32 v7, 1, v37
  v_lshlrev_b32 v7, 1, v7
  v_lshrrev_b32 v8, 1, v37
  v_or_b32 v7, v7, v8
  v_lshlrev_b32 v7, 3, v7
  v_lshl_add_u32 v7, v6, 5, v7
  v_lshl_add_u32 v7, v3, 9, v7
  v_and_b32 v8, 1, v4
  s_movk_i32 s45, 1088
  v_mad_u32_u24 v7, v8, s45, v7
  v_lshrrev_b32 v8, 1, v4
  s_movk_i32 s46, 4480
  s_movk_i32 s47, 4224
  v_mad_u32_u24 v11, v8, s46, v7
  v_add_u32 v11, 16640, v11
  v_mad_u32_u24 v12, v8, s47, v7
  v_add_u32 v12, 16768, v12
  s_movk_i32 s46, 4352
  v_mad_u32_u24 v7, v3, s46, v9
  v_lshl_add_u32 v7, v4, 6, v7
  v_add_u32 v13, 18816, v7
  v_lshlrev_b32 v7, 3, v37
  v_lshl_add_u32 v7, v4, 5, v7
  v_mad_u32_u24 v7, v3, s46, v7
  s_movk_i32 s47, 1152
  v_mad_u32_u24 v7, v6, s47, v7
  v_add_u32 v14, 19328, v7
  v_mad_u32_u24 v7, v4, s45, v9
  v_lshl_add_u32 v7, v3, 8, v7
  v_add_u32 v16, 16640, v7
  v_mov_b32 v240, 0x3f803f80
  v_mov_b32 v241, 0x3f803f80
  v_mov_b32 v242, 0x3f803f80
  v_mov_b32 v243, 0x3f803f80
  v_and_b32 v30, 31, v1
  v_lshlrev_b32 v30, 4, v30
  s_lshl_b32 s45, s28, 2
  s_add_u32 s45, s45, 136192
  v_add_u32 v30, s45, v30
  v_lshlrev_b32 v31, 4, v0
  v_add_u32 v31, 136192, v31
  v_lshlrev_b32 v32, 2, v0
  s_add_u32 m0, s38, s42
  s_mul_i32 s32, s43, s35
  buffer_load_dwordx4 v17, s[4:7], s32 offen lds
  buffer_load_dwordx4 v18, s[4:7], s32 offen offset:1040 lds
  buffer_load_dwordx4 v19, s[4:7], s32 offen offset:2080 lds
  buffer_load_dwordx4 v20, s[4:7], s32 offen offset:3120 lds
  s_add_u32 m0, s39, s42
  s_mul_i32 s33, s43, s36
  buffer_load_dwordx4 v21, s[8:11], s33 offen lds
  buffer_load_dwordx4 v22, s[8:11], s33 offen offset:1088 lds
  s_mul_i32 s34, s43, s37
  buffer_load_dwordx4 v23, s[12:15], s34 offen offset:2176 lds
  s_add_u32 s43, s43, 1
  s_and_b32 s43, s43, s51
  buffer_load_dwordx4 v24, s[16:19], s34 offen offset:3264 lds
  s_add_u32 s42, s42, s49
  s_cmp_eq_u32 s42, 136192
  s_cmov_b32 s42, 0
  s_cmp_eq_u32 s42, 68096
  s_cselect_b32 s40, s50, s49
  s_add_u32 m0, s38, s42
  s_mul_i32 s32, s43, s35
  buffer_load_dwordx4 v17, s[4:7], s32 offen lds
  buffer_load_dwordx4 v18, s[4:7], s32 offen offset:1040 lds
  buffer_load_dwordx4 v19, s[4:7], s32 offen offset:2080 lds
  buffer_load_dwordx4 v20, s[4:7], s32 offen offset:3120 lds
  s_add_u32 m0, s39, s42
  s_mul_i32 s33, s43, s36
  buffer_load_dwordx4 v21, s[8:11], s33 offen lds
  buffer_load_dwordx4 v22, s[8:11], s33 offen offset:1088 lds
  s_mul_i32 s34, s43, s37
  buffer_load_dwordx4 v23, s[12:15], s34 offen offset:2176 lds
  s_add_u32 s43, s43, 1
  s_and_b32 s43, s43, s51
  buffer_load_dwordx4 v24, s[16:19], s34 offen offset:3264 lds
  s_add_u32 s42, s42, s49
  s_cmp_eq_u32 s42, 136192
  s_cmov_b32 s42, 0
  s_cmp_eq_u32 s42, 68096
  s_cselect_b32 s40, s50, s49
  s_waitcnt vmcnt(16)
  s_barrier
  ds_read_b128 v[76:79], v10 offset:0
  ds_read_b128 v[80:83], v10 offset:512
  ds_read_b64_tr_b16 v[84:85], v11 offset:0
  ds_read_b64_tr_b16 v[86:87], v11 offset:256
  ds_read_b64_tr_b16 v[88:89], v11 offset:64
  ds_read_b64_tr_b16 v[90:91], v11 offset:320
  ds_read_b64_tr_b16 v[92:93], v12 offset:0
  ds_read_b64_tr_b16 v[94:95], v12 offset:256
  ds_read_b64_tr_b16 v[96:97], v12 offset:64
  ds_read_b64_tr_b16 v[98:99], v12 offset:320
  ds_read_b64_tr_b16 v[100:101], v13 offset:0
  ds_read_b64_tr_b16 v[102:103], v13 offset:256
  ds_read_b64_tr_b16 v[104:105], v13 offset:1088
  ds_read_b64_tr_b16 v[106:107], v13 offset:1344
  ds_read_b64_tr_b16 v[108:109], v14 offset:0
  ds_read_b64_tr_b16 v[110:111], v14 offset:128
  s_waitcnt lgkmcnt(12)
  v_mfma_f32_32x32x16_bf16 v[112:127], v[84:87], v[76:79], 0
  ds_read_b128 v[68:71], v10 offset:32
  ds_read_b128 v[72:75], v10 offset:544
  v_mfma_f32_32x32x16_bf16 v[128:143], v[84:87], v[80:83], 0
  ds_read_b64_tr_b16 v[40:41], v11 offset:8704
  ds_read_b64_tr_b16 v[42:43], v11 offset:8960
  s_waitcnt lgkmcnt(14)
  v_mfma_f32_32x32x16_bf16 v[144:159], v[88:91], v[76:79], 0
  ds_read_b64_tr_b16 v[44:45], v11 offset:8768
  v_mfma_f32_32x32x16_bf16 v[160:175], v[88:91], v[80:83], 0
  ds_read_b64_tr_b16 v[46:47], v11 offset:9024
  s_waitcnt lgkmcnt(14)
  v_mfma_f32_32x32x16_bf16 v[176:191], v[92:95], v[76:79], 0
  ds_read_b64_tr_b16 v[48:49], v12 offset:8704
  ds_read_b64_tr_b16 v[50:51], v12 offset:8960
  v_mfma_f32_32x32x16_bf16 v[192:207], v[92:95], v[80:83], 0
  ds_read_b64_tr_b16 v[52:53], v12 offset:8768
  s_waitcnt lgkmcnt(13)
  v_mfma_f32_32x32x16_bf16 v[208:223], v[96:99], v[76:79], 0
  ds_read_b64_tr_b16 v[54:55], v12 offset:9024
  ds_read_b64_tr_b16 v[56:57], v13 offset:8704
  s_lshl_b32 s45, s30, 5
  s_add_u32 s45, s45, s29
  s_lshl_b32 s45, s45, 2
  s_add_u32 s45, s45, s28
  s_lshl_b32 s45, s45, 11
  buffer_load_dwordx4 v[248:251], v25, s[4:7], s45 offen
  v_mfma_f32_32x32x16_bf16 v[224:239], v[96:99], v[80:83], 0
  ds_read_b64_tr_b16 v[58:59], v13 offset:8960
  ds_read_b64_tr_b16 v[60:61], v13 offset:9792
  buffer_load_dwordx4 v[252:255], v25, s[4:7], s45 offen offset:1024
  v_mfma_f32_32x32x16_bf16 a[128:143], v[100:103], v[76:79], 0
  ds_read_b64_tr_b16 v[62:63], v13 offset:10048
  ds_read_b64_tr_b16 v[64:65], v14 offset:8704
  v_mfma_f32_32x32x16_bf16 a[144:159], v[100:103], v[80:83], 0
  ds_read_b64_tr_b16 v[66:67], v14 offset:8832
  s_waitcnt lgkmcnt(8)
  v_mfma_f32_32x32x16_bf16 a[160:175], v[104:107], v[76:79], 0
  v_mfma_f32_32x32x16_bf16 a[176:191], v[104:107], v[80:83], 0
  v_mfma_f32_32x32x16_bf16 a[192:207], v[108:111], v[76:79], 0
  v_mfma_f32_32x32x16_bf16 a[208:223], v[108:111], v[80:83], 0
  v_mfma_f32_32x32x16_bf16 v[112:127], v[40:43], v[68:71], v[112:127]
  v_add_u32 v10, s49, v10
  v_add_u32 v11, s49, v11
  v_add_u32 v12, s49, v12
  v_add_u32 v13, s49, v13
  v_add_u32 v14, s49, v14
  s_waitcnt vmcnt(10) lgkmcnt(0)
  s_barrier
  v_mfma_f32_32x32x16_bf16 v[128:143], v[40:43], v[72:75], v[128:143]
  ds_read_b128 v[76:79], v10 offset:0
  ds_read_b128 v[80:83], v10 offset:512
  v_mfma_f32_32x32x16_bf16 v[144:159], v[44:47], v[68:71], v[144:159]
  ds_read_b64_tr_b16 v[84:85], v11 offset:0
  s_add_u32 m0, s38, s42
  s_mul_i32 s32, s43, s35
  buffer_load_dwordx4 v17, s[4:7], s32 offen lds
  v_mfma_f32_32x32x16_bf16 v[160:175], v[44:47], v[72:75], v[160:175]
  ds_read_b64_tr_b16 v[86:87], v11 offset:256
  ds_read_b64_tr_b16 v[88:89], v11 offset:64
  ds_read_b64_tr_b16 v[90:91], v11 offset:320
  v_mfma_f32_32x32x16_bf16 v[176:191], v[48:51], v[68:71], v[176:191]
  ds_read_b64_tr_b16 v[92:93], v12 offset:0
  buffer_load_dwordx4 v18, s[4:7], s32 offen offset:1040 lds
  ds_read_b64_tr_b16 v[94:95], v12 offset:256
  v_mfma_f32_32x32x16_bf16 v[192:207], v[48:51], v[72:75], v[192:207]
  ds_read_b64_tr_b16 v[96:97], v12 offset:64
  v_mfma_f32_32x32x16_bf16 v[208:223], v[52:55], v[68:71], v[208:223]
  ds_read_b64_tr_b16 v[98:99], v12 offset:320
  ds_read_b64_tr_b16 v[100:101], v13 offset:0
  v_mfma_f32_32x32x16_bf16 v[224:239], v[52:55], v[72:75], v[224:239]
  ds_read_b64_tr_b16 v[102:103], v13 offset:256
  ds_read_b64_tr_b16 v[104:105], v13 offset:1088
  buffer_load_dwordx4 v19, s[4:7], s32 offen offset:2080 lds
  v_mfma_f32_32x32x16_bf16 a[128:143], v[56:59], v[68:71], a[128:143]
  ds_read_b64_tr_b16 v[106:107], v13 offset:1344
  ds_read_b64_tr_b16 v[108:109], v14 offset:0
  v_mfma_f32_32x32x16_bf16 a[144:159], v[56:59], v[72:75], a[144:159]
  ds_read_b64_tr_b16 v[110:111], v14 offset:128
  v_mfma_f32_32x32x16_bf16 a[160:175], v[60:63], v[68:71], a[160:175]
  buffer_load_dwordx4 v20, s[4:7], s32 offen offset:3120 lds
  v_mfma_f32_32x32x16_bf16 a[176:191], v[60:63], v[72:75], a[176:191]
  v_mfma_f32_32x32x16_bf16 a[192:207], v[64:67], v[68:71], a[192:207]
  v_mfma_f32_32x32x16_bf16 a[208:223], v[64:67], v[72:75], a[208:223]
  s_add_u32 s20, s78, 4194304
  s_addc_u32 s21, s79, 0
  s_mov_b32 s22, 16777216
  s_mov_b32 s23, 0x00020000
  s_add_u32 s24, s78, 20971520
  s_addc_u32 s25, s79, 0
  s_mov_b32 s26, 5636096
  s_mov_b32 s27, 0x00020000
  s_mov_b32 s41, 1
  s_waitcnt lgkmcnt(0)
L_gemm:
  s_waitcnt lgkmcnt(8)
  v_mfma_f32_32x32x16_bf16 v[112:127], v[84:87], v[76:79], v[112:127]
  ds_read_b128 v[68:71], v10 offset:32
  ds_read_b128 v[72:75], v10 offset:544
  v_mfma_f32_32x32x16_bf16 v[128:143], v[84:87], v[80:83], v[128:143]
  ds_read_b64_tr_b16 v[40:41], v11 offset:8704
  s_add_u32 m0, s39, s42
  s_mul_i32 s33, s43, s36
  buffer_load_dwordx4 v21, s[8:11], s33 offen lds
  v_mfma_f32_32x32x16_bf16 v[144:159], v[88:91], v[76:79], v[144:159]
  ds_read_b64_tr_b16 v[42:43], v11 offset:8960
  ds_read_b64_tr_b16 v[44:45], v11 offset:8768
  buffer_load_dwordx4 v22, s[8:11], s33 offen offset:1088 lds
  s_mul_i32 s34, s43, s37
  v_mfma_f32_32x32x16_bf16 v[160:175], v[88:91], v[80:83], v[160:175]
  ds_read_b64_tr_b16 v[46:47], v11 offset:9024
  ds_read_b64_tr_b16 v[48:49], v12 offset:8704
  ds_read_b64_tr_b16 v[50:51], v12 offset:8960
  v_mfma_f32_32x32x16_bf16 v[176:191], v[92:95], v[76:79], v[176:191]
  ds_read_b64_tr_b16 v[52:53], v12 offset:8768
  buffer_load_dwordx4 v23, s[12:15], s34 offen offset:2176 lds
  s_add_u32 s43, s43, 1
  s_and_b32 s43, s43, s51
  v_mfma_f32_32x32x16_bf16 v[192:207], v[92:95], v[80:83], v[192:207]
  ds_read_b64_tr_b16 v[54:55], v12 offset:9024
  ds_read_b64_tr_b16 v[56:57], v13 offset:8704
  s_waitcnt lgkmcnt(8)
  v_mfma_f32_32x32x16_bf16 v[208:223], v[96:99], v[76:79], v[208:223]
  ds_read_b64_tr_b16 v[58:59], v13 offset:8960
  buffer_load_dwordx4 v24, s[16:19], s34 offen offset:3264 lds
  s_add_u32 s42, s42, s49
  s_cmp_eq_u32 s42, 136192
  s_cmov_b32 s42, 0
  s_cmp_eq_u32 s42, 68096
  s_cselect_b32 s40, s50, s49
  v_mfma_f32_32x32x16_bf16 v[224:239], v[96:99], v[80:83], v[224:239]
  ds_read_b64_tr_b16 v[60:61], v13 offset:9792
  ds_read_b64_tr_b16 v[62:63], v13 offset:10048
  v_add_u32 v10, s40, v10
  ds_read_b64_tr_b16 v[64:65], v14 offset:8704
  v_mfma_f32_32x32x16_bf16 a[128:143], v[100:103], v[76:79], a[128:143]
  ds_read_b64_tr_b16 v[66:67], v14 offset:8832
  v_add_u32 v11, s40, v11
  v_mfma_f32_32x32x16_bf16 a[144:159], v[100:103], v[80:83], a[144:159]
  v_add_u32 v12, s40, v12
  v_mfma_f32_32x32x16_bf16 a[160:175], v[104:107], v[76:79], a[160:175]
  v_mfma_f32_32x32x16_bf16 a[176:191], v[104:107], v[80:83], a[176:191]
  v_add_u32 v13, s40, v13
  v_mfma_f32_32x32x16_bf16 a[192:207], v[108:111], v[76:79], a[192:207]
  v_add_u32 v14, s40, v14
  v_mfma_f32_32x32x16_bf16 a[208:223], v[108:111], v[80:83], a[208:223]
  s_waitcnt lgkmcnt(4)
  v_mfma_f32_32x32x16_bf16 v[112:127], v[40:43], v[68:71], v[112:127]
  s_cmp_eq_u32 s41, s48
  s_waitcnt vmcnt(8) lgkmcnt(0)
  s_barrier
  s_cbranch_scc1 L_pre
L_pre_ret:
  v_mfma_f32_32x32x16_bf16 v[128:143], v[40:43], v[72:75], v[128:143]
  ds_read_b128 v[76:79], v10 offset:0
  ds_read_b128 v[80:83], v10 offset:512
  v_mfma_f32_32x32x16_bf16 v[144:159], v[44:47], v[68:71], v[144:159]
  ds_read_b64_tr_b16 v[84:85], v11 offset:0
  ds_read_b64_tr_b16 v[86:87], v11 offset:256
  v_mfma_f32_32x32x16_bf16 v[160:175], v[44:47], v[72:75], v[160:175]
  ds_read_b64_tr_b16 v[88:89], v11 offset:64
  s_add_u32 m0, s38, s42
  s_mul_i32 s32, s43, s35
  buffer_load_dwordx4 v17, s[4:7], s32 offen lds
  v_mfma_f32_32x32x16_bf16 v[176:191], v[48:51], v[68:71], v[176:191]
  ds_read_b64_tr_b16 v[90:91], v11 offset:320
  ds_read_b64_tr_b16 v[92:93], v12 offset:0
  ds_read_b64_tr_b16 v[94:95], v12 offset:256
  v_mfma_f32_32x32x16_bf16 v[192:207], v[48:51], v[72:75], v[192:207]
  ds_read_b64_tr_b16 v[96:97], v12 offset:64
  buffer_load_dwordx4 v18, s[4:7], s32 offen offset:1040 lds
  v_mfma_f32_32x32x16_bf16 v[208:223], v[52:55], v[68:71], v[208:223]
  ds_read_b64_tr_b16 v[98:99], v12 offset:320
  ds_read_b64_tr_b16 v[100:101], v13 offset:0
  v_mfma_f32_32x32x16_bf16 v[224:239], v[52:55], v[72:75], v[224:239]
  ds_read_b64_tr_b16 v[102:103], v13 offset:256
  ds_read_b64_tr_b16 v[104:105], v13 offset:1088
  v_mfma_f32_32x32x16_bf16 a[128:143], v[56:59], v[68:71], a[128:143]
  ds_read_b64_tr_b16 v[106:107], v13 offset:1344
  buffer_load_dwordx4 v19, s[4:7], s32 offen offset:2080 lds
  ds_read_b64_tr_b16 v[108:109], v14 offset:0
  v_mfma_f32_32x32x16_bf16 a[144:159], v[56:59], v[72:75], a[144:159]
  ds_read_b64_tr_b16 v[110:111], v14 offset:128
  v_mfma_f32_32x32x16_bf16 a[160:175], v[60:63], v[68:71], a[160:175]
  v_mfma_f32_32x32x16_bf16 a[176:191], v[60:63], v[72:75], a[176:191]
  buffer_load_dwordx4 v20, s[4:7], s32 offen offset:3120 lds
  v_mfma_f32_32x32x16_bf16 a[192:207], v[64:67], v[68:71], a[192:207]
  v_mfma_f32_32x32x16_bf16 a[208:223], v[64:67], v[72:75], a[208:223]
  s_add_u32 s41, s41, 1
  s_cmp_lt_u32 s41, 14
  s_cbranch_scc1 L_gemm
  s_waitcnt lgkmcnt(8)
  v_mfma_f32_32x32x16_bf16 v[112:127], v[84:87], v[76:79], v[112:127]
  ds_read_b128 v[68:71], v10 offset:32
  v_accvgpr_write_b32 a0, 0
  v_bfe_u32 v3, v1, 1, 4
  s_lshl_b32 s47, s28, 12
  v_lshlrev_b32 v3, 7, v3
  v_and_b32 v4, 1, v1
  v_mfma_f32_32x32x16_bf16 v[128:143], v[84:87], v[80:83], v[128:143]
  ds_read_b128 v[72:75], v10 offset:544
  v_accvgpr_write_b32 a1, 0
  v_lshl_add_u32 v3, v4, 3, v3
  v_add_u32 v3, s47, v3
  ds_read_b64_tr_b16 v[40:41], v11 offset:8704
  v_accvgpr_write_b32 a2, 0
  s_waitcnt vmcnt(20)
  v_readfirstlane_b32 s45, v2
  v_mfma_f32_32x32x16_bf16 v[144:159], v[88:91], v[76:79], v[144:159]
  ds_read_b64_tr_b16 v[42:43], v11 offset:8960
  v_accvgpr_write_b32 a3, 0
  s_lshl_b32 s46, s29, 13
  s_cmp_lt_u32 s45, 256
  s_cbranch_scc1 L_spin
L_spin_ret:
  ds_read_b64_tr_b16 v[44:45], v11 offset:8768
  v_accvgpr_write_b32 a4, 0
  v_mfma_f32_32x32x16_bf16 v[160:175], v[88:91], v[80:83], v[160:175]
  buffer_load_dword v240, v32, s[80:83], s46 offen offset:0 sc1
  ds_read_b64_tr_b16 v[46:47], v11 offset:9024
  v_accvgpr_write_b32 a5, 0
  buffer_load_dword v241, v32, s[80:83], s46 offen offset:1024 sc1
  ds_read_b64_tr_b16 v[48:49], v12 offset:8704
  v_mfma_f32_32x32x16_bf16 v[176:191], v[92:95], v[76:79], v[176:191]
  v_accvgpr_write_b32 a6, 0
  buffer_load_dword v242, v32, s[80:83], s46 offen offset:2048 sc1
  ds_read_b64_tr_b16 v[50:51], v12 offset:8960
  v_accvgpr_write_b32 a7, 0
  buffer_load_dword v243, v32, s[80:83], s46 offen offset:3072 sc1
  v_mfma_f32_32x32x16_bf16 v[192:207], v[92:95], v[80:83], v[192:207]
  ds_read_b64_tr_b16 v[52:53], v12 offset:8768
  v_accvgpr_write_b32 a8, 0
  s_add_u32 s46, s46, 4096
  buffer_load_dword v244, v32, s[80:83], s46 offen offset:0 sc1
  ds_read_b64_tr_b16 v[54:55], v12 offset:9024
  v_accvgpr_write_b32 a9, 0
  s_waitcnt lgkmcnt(5)
  v_mfma_f32_32x32x16_bf16 v[208:223], v[96:99], v[76:79], v[208:223]
  buffer_load_dword v245, v32, s[80:83], s46 offen offset:1024 sc1
  ds_read_b64_tr_b16 v[56:57], v13 offset:8704
  v_accvgpr_write_b32 a10, 0
  buffer_load_dword v246, v32, s[80:83], s46 offen offset:2048 sc1
  ds_read_b64_tr_b16 v[58:59], v13 offset:8960
  v_accvgpr_write_b32 a11, 0
  v_mfma_f32_32x32x16_bf16 v[224:239], v[96:99], v[80:83], v[224:239]
  ds_read_b64_tr_b16 v[60:61], v13 offset:9792
  buffer_load_dword v247, v32, s[80:83], s46 offen offset:3072 sc1
  v_accvgpr_write_b32 a12, 0
  ds_read_b64_tr_b16 v[62:63], v13 offset:10048
  s_sub_u32 s80, s80, 1048576
  s_subb_u32 s81, s81, 0
  s_lshl_b32 s46, s30, 14
  buffer_load_dwordx2 v[26:27], v3, s[80:83], s46 offen sc1
  v_mfma_f32_32x32x16_bf16 a[128:143], v[100:103], v[76:79], a[128:143]
  v_accvgpr_write_b32 a13, 0
  ds_read_b64_tr_b16 v[64:65], v14 offset:8704
  buffer_load_dwordx2 v[28:29], v3, s[80:83], s46 offen offset:2048 sc1
  v_accvgpr_write_b32 a14, 0
  ds_read_b64_tr_b16 v[66:67], v14 offset:8832
  v_mfma_f32_32x32x16_bf16 a[144:159], v[100:103], v[80:83], a[144:159]
  s_add_u32 m0, s39, s42
  s_mul_i32 s33, s43, s36
  buffer_load_dwordx4 v21, s[8:11], s33 offen lds
  v_accvgpr_write_b32 a15, 0
  buffer_load_dwordx4 v22, s[8:11], s33 offen offset:1088 lds
  s_mul_i32 s34, s43, s37
  v_accvgpr_write_b32 a16, 0
  v_mfma_f32_32x32x16_bf16 a[160:175], v[104:107], v[76:79], a[160:175]
  buffer_load_dwordx4 v23, s[12:15], s34 offen offset:2176 lds
  s_add_u32 s43, s43, 1
  s_and_b32 s43, s43, s51
  v_accvgpr_write_b32 a17, 0
  buffer_load_dwordx4 v24, s[16:19], s34 offen offset:3264 lds
  s_add_u32 s42, s42, s49
  s_cmp_eq_u32 s42, 136192
  s_cmov_b32 s42, 0
  s_cmp_eq_u32 s42, 68096
  s_cselect_b32 s40, s50, s49
  v_mfma_f32_32x32x16_bf16 a[176:191], v[104:107], v[80:83], a[176:191]
  v_accvgpr_write_b32 a18, 0
  v_add_u32 v10, s40, v10
  v_accvgpr_write_b32 a19, 0
  v_add_u32 v11, s40, v11
  v_accvgpr_write_b32 a20, 0
  v_mfma_f32_32x32x16_bf16 a[192:207], v[108:111], v[76:79], a[192:207]
  v_add_u32 v12, s40, v12
  v_accvgpr_write_b32 a21, 0
  v_add_u32 v13, s40, v13
  v_accvgpr_write_b32 a22, 0
  v_mfma_f32_32x32x16_bf16 a[208:223], v[108:111], v[80:83], a[208:223]
  v_add_u32 v14, s40, v14
  v_accvgpr_write_b32 a23, 0
  v_mfma_f32_32x32x16_bf16 v[112:127], v[40:43], v[68:71], v[112:127]
  s_waitcnt vmcnt(18) lgkmcnt(0)
  s_barrier
  v_mfma_f32_32x32x16_bf16 v[128:143], v[40:43], v[72:75], v[128:143]
  v_accvgpr_write_b32 a24, 0
  v_accvgpr_write_b32 a25, 0
  ds_read_b128 v[76:79], v10 offset:0
  v_accvgpr_write_b32 a26, 0
  ds_read_b128 v[80:83], v10 offset:512
  v_accvgpr_write_b32 a27, 0
  v_mfma_f32_32x32x16_bf16 v[144:159], v[44:47], v[68:71], v[144:159]
  v_accvgpr_write_b32 a28, 0
  ds_read_b64_tr_b16 v[84:85], v11 offset:0
  v_accvgpr_write_b32 a29, 0
  ds_read_b64_tr_b16 v[86:87], v11 offset:256
  v_accvgpr_write_b32 a30, 0
  v_mfma_f32_32x32x16_bf16 v[160:175], v[44:47], v[72:75], v[160:175]
  v_accvgpr_write_b32 a31, 0
  ds_read_b64_tr_b16 v[88:89], v11 offset:64
  v_accvgpr_write_b32 a32, 0
  v_mfma_f32_32x32x16_bf16 v[176:191], v[48:51], v[68:71], v[176:191]
  v_accvgpr_write_b32 a33, 0
  v_accvgpr_write_b32 a34, 0
  ds_read_b64_tr_b16 v[90:91], v11 offset:320
  v_accvgpr_write_b32 a35, 0
  ds_read_b64_tr_b16 v[92:93], v12 offset:0
  v_mfma_f32_32x32x16_bf16 v[192:207], v[48:51], v[72:75], v[192:207]
  v_accvgpr_write_b32 a36, 0
  v_accvgpr_write_b32 a37, 0
  ds_read_b64_tr_b16 v[94:95], v12 offset:256
  v_accvgpr_write_b32 a38, 0
  s_add_u32 m0, s38, s42
  s_mul_i32 s32, s43, s35
  buffer_load_dwordx4 v17, s[4:7], s32 offen lds
  v_mfma_f32_32x32x16_bf16 v[208:223], v[52:55], v[68:71], v[208:223]
  v_accvgpr_write_b32 a39, 0
  ds_read_b64_tr_b16 v[96:97], v12 offset:64
  v_accvgpr_write_b32 a40, 0
  ds_read_b64_tr_b16 v[98:99], v12 offset:320
  v_accvgpr_write_b32 a41, 0
  ds_read_b64_tr_b16 v[100:101], v13 offset:0
  v_mfma_f32_32x32x16_bf16 v[224:239], v[52:55], v[72:75], v[224:239]
  v_accvgpr_write_b32 a42, 0
  v_accvgpr_write_b32 a43, 0
  v_accvgpr_write_b32 a44, 0
  ds_read_b64_tr_b16 v[102:103], v13 offset:256
  v_mfma_f32_32x32x16_bf16 a[128:143], v[56:59], v[68:71], a[128:143]
  v_accvgpr_write_b32 a45, 0
  v_accvgpr_write_b32 a46, 0
  ds_read_b64_tr_b16 v[104:105], v13 offset:1088
  v_accvgpr_write_b32 a47, 0
  ds_read_b64_tr_b16 v[106:107], v13 offset:1344
  buffer_load_dwordx4 v18, s[4:7], s32 offen offset:1040 lds
  v_mfma_f32_32x32x16_bf16 a[144:159], v[56:59], v[72:75], a[144:159]
  v_accvgpr_write_b32 a48, 0
  v_accvgpr_write_b32 a49, 0
  ds_read_b64_tr_b16 v[108:109], v14 offset:0
  v_accvgpr_write_b32 a50, 0
  ds_read_b64_tr_b16 v[110:111], v14 offset:128
  v_accvgpr_write_b32 a51, 0
  v_mfma_f32_32x32x16_bf16 a[160:175], v[60:63], v[68:71], a[160:175]
  v_accvgpr_write_b32 a52, 0
  v_accvgpr_write_b32 a53, 0
  buffer_load_dwordx4 v19, s[4:7], s32 offen offset:2080 lds
  v_accvgpr_write_b32 a54, 0
  v_mfma_f32_32x32x16_bf16 a[176:191], v[60:63], v[72:75], a[176:191]
  v_accvgpr_write_b32 a55, 0
  v_accvgpr_write_b32 a56, 0
  v_accvgpr_write_b32 a57, 0
  buffer_load_dwordx4 v20, s[4:7], s32 offen offset:3120 lds
  v_mfma_f32_32x32x16_bf16 a[192:207], v[64:67], v[68:71], a[192:207]
  v_accvgpr_write_b32 a58, 0
  v_accvgpr_write_b32 a59, 0
  v_accvgpr_write_b32 a60, 0
  v_mfma_f32_32x32x16_bf16 a[208:223], v[64:67], v[72:75], a[208:223]
  v_accvgpr_write_b32 a61, 0
  v_accvgpr_write_b32 a62, 0
  v_accvgpr_write_b32 a63, 0
  s_waitcnt lgkmcnt(0)
  v_mfma_f32_32x32x16_bf16 v[112:127], v[84:87], v[76:79], v[112:127]
  v_accvgpr_write_b32 a64, 0
  ds_read_b128 v[68:71], v10 offset:32
  s_waitcnt vmcnt(8)
  v_add_f32 v240, v240, v241
  v_accvgpr_write_b32 a65, 0
  ds_read_b128 v[72:75], v10 offset:544
  v_mfma_f32_32x32x16_bf16 v[128:143], v[84:87], v[80:83], v[128:143]
  v_accvgpr_write_b32 a66, 0
  v_add_f32 v242, v242, v243
  v_accvgpr_write_b32 a67, 0
  ds_read_b64_tr_b16 v[40:41], v11 offset:8704
  v_add_f32 v244, v244, v245
  v_accvgpr_write_b32 a68, 0
  v_mfma_f32_32x32x16_bf16 v[144:159], v[88:91], v[76:79], v[144:159]
  ds_read_b64_tr_b16 v[42:43], v11 offset:8960
  v_accvgpr_write_b32 a69, 0
  v_add_f32 v246, v246, v247
  ds_read_b64_tr_b16 v[44:45], v11 offset:8768
  v_accvgpr_write_b32 a70, 0
  v_add_f32 v240, v240, v242
  v_mfma_f32_32x32x16_bf16 v[160:175], v[88:91], v[80:83], v[160:175]
  v_accvgpr_write_b32 a71, 0
  ds_read_b64_tr_b16 v[46:47], v11 offset:9024
  v_accvgpr_write_b32 a72, 0
  ds_read_b64_tr_b16 v[48:49], v12 offset:8704
  v_add_f32 v244, v244, v246
  v_accvgpr_write_b32 a73, 0
  v_mfma_f32_32x32x16_bf16 v[176:191], v[92:95], v[76:79], v[176:191]
  ds_read_b64_tr_b16 v[50:51], v12 offset:8960
  v_add_f32 v240, v240, v244
  v_accvgpr_write_b32 a74, 0
  ds_read_b64_tr_b16 v[52:53], v12 offset:8768
  v_cvt_pk_bf16_f32 v242, v240, v240
  v_accvgpr_write_b32 a75, 0
  v_mfma_f32_32x32x16_bf16 v[192:207], v[92:95], v[80:83], v[192:207]
  v_accvgpr_write_b32 a76, 0
  ds_read_b64_tr_b16 v[54:55], v12 offset:9024
  v_lshlrev_b32 v241, 16, v242
  v_accvgpr_write_b32 a77, 0
  ds_read_b64_tr_b16 v[56:57], v13 offset:8704
  v_mfma_f32_32x32x16_bf16 v[208:223], v[96:99], v[76:79], v[208:223]
  v_accvgpr_write_b32 a78, 0
  v_sub_f32 v241, v240, v241
  ds_read_b64_tr_b16 v[58:59], v13 offset:8960
  v_accvgpr_write_b32 a79, 0
  v_cvt_pk_bf16_f32 v243, v241, 0
  ds_read_b64_tr_b16 v[60:61], v13 offset:9792
  v_mfma_f32_32x32x16_bf16 v[224:239], v[96:99], v[80:83], v[224:239]
  v_accvgpr_write_b32 a80, 0
  v_accvgpr_write_b32 a81, 0
  ds_read_b64_tr_b16 v[62:63], v13 offset:10048
  v_lshrrev_b32 v5, 1, v31
  v_accvgpr_write_b32 a82, 0
  ds_read_b64_tr_b16 v[64:65], v14 offset:8704
  v_mfma_f32_32x32x16_bf16 a[128:143], v[100:103], v[76:79], a[128:143]
  v_accvgpr_write_b32 a83, 0
  v_add_u32 v5, 68096, v5
  ds_read_b64_tr_b16 v[66:67], v14 offset:8832
  v_accvgpr_write_b32 a84, 0
  ds_write_b64 v5, v[242:243]
  v_mfma_f32_32x32x16_bf16 a[144:159], v[100:103], v[80:83], a[144:159]
  v_accvgpr_write_b32 a85, 0
  s_add_u32 m0, s39, s42
  s_mul_i32 s33, s43, s36
  buffer_load_dwordx4 v21, s[8:11], s33 offen lds
  v_mfma_f32_32x32x16_bf16 a[160:175], v[104:107], v[76:79], a[160:175]
  v_accvgpr_write_b32 a86, 0
  v_accvgpr_write_b32 a87, 0
  buffer_load_dwordx4 v22, s[8:11], s33 offen offset:1088 lds
  s_mul_i32 s34, s43, s37
  v_accvgpr_write_b32 a88, 0
  v_mfma_f32_32x32x16_bf16 a[176:191], v[104:107], v[80:83], a[176:191]
  v_accvgpr_write_b32 a89, 0
  buffer_load_dwordx4 v23, s[12:15], s34 offen offset:2176 lds
  s_add_u32 s43, s43, 1
  s_and_b32 s43, s43, s51
  v_accvgpr_write_b32 a90, 0
  buffer_load_dwordx4 v24, s[16:19], s34 offen offset:3264 lds
  s_add_u32 s42, s42, s49
  s_cmp_eq_u32 s42, 136192
  s_cmov_b32 s42, 0
  s_cmp_eq_u32 s42, 68096
  s_cselect_b32 s40, s50, s49
  v_mfma_f32_32x32x16_bf16 a[192:207], v[108:111], v[76:79], a[192:207]
  v_accvgpr_write_b32 a91, 0
  v_accvgpr_write_b32 a92, 0
  v_accvgpr_write_b32 a93, 0
  v_mfma_f32_32x32x16_bf16 a[208:223], v[108:111], v[80:83], a[208:223]
  v_accvgpr_write_b32 a94, 0
  v_accvgpr_write_b32 a95, 0
  s_waitcnt lgkmcnt(0)
  v_mfma_f32_32x32x16_bf16 v[112:127], v[40:43], v[68:71], v[112:127]
  s_waitcnt vmcnt(8) lgkmcnt(0)
  s_barrier
  v_mfma_f32_32x32x16_bf16 v[128:143], v[40:43], v[72:75], v[128:143]
  v_and_b32 v5, 31, v1
  v_lshlrev_b32 v5, 3, v5
  v_add_u32 v5, 136192, v5
  v_cmp_gt_u32 vcc, 32, v1
  v_accvgpr_write_b32 a96, 0
  ds_read_b64 v[240:241], v5 offset:0
  v_accvgpr_write_b32 a97, 0
  v_mfma_f32_32x32x16_bf16 v[144:159], v[44:47], v[68:71], v[144:159]
  ds_read_b64 v[242:243], v5 offset:256
  v_accvgpr_write_b32 a98, 0
  ds_read_b64 v[244:245], v5 offset:512
  v_accvgpr_write_b32 a99, 0
  ds_read_b64 v[246:247], v5 offset:768
  v_accvgpr_write_b32 a100, 0
  v_mfma_f32_32x32x16_bf16 v[160:175], v[44:47], v[72:75], v[160:175]
  ds_read_b64 v[248:249], v5 offset:1024
  ds_read_b64 v[250:251], v5 offset:1280
  v_accvgpr_write_b32 a101, 0
  ds_read_b64 v[252:253], v5 offset:1536
  v_accvgpr_write_b32 a102, 0
  v_mov_b32 v254, 0
  v_mfma_f32_32x32x16_bf16 v[176:191], v[48:51], v[68:71], v[176:191]
  v_accvgpr_write_b32 a103, 0
  v_mov_b32 v255, 0
  v_accvgpr_write_b32 a104, 0
  v_cvt_pk_bf16_f32 v77, v26, 0
  v_accvgpr_write_b32 a105, 0
  v_mfma_f32_32x32x16_bf16 v[192:207], v[48:51], v[72:75], v[192:207]
  v_lshlrev_b32 v2, 16, v77
  v_sub_f32 v2, v26, v2
  v_accvgpr_write_b32 a106, 0
  v_cvt_pk_bf16_f32 v76, v26, v2
  v_accvgpr_write_b32 a107, 0
  s_add_u32 m0, s38, s42
  s_mul_i32 s32, s43, s35
  buffer_load_dwordx4 v17, s[4:7], s32 offen lds
  v_mfma_f32_32x32x16_bf16 v[208:223], v[52:55], v[68:71], v[208:223]
  v_cndmask_b32 v77, 0, v77, vcc
  v_accvgpr_write_b32 a108, 0
  v_cndmask_b32 v76, 0, v76, vcc
  v_accvgpr_write_b32 a109, 0
  v_mov_b32 v78, 0
  v_accvgpr_write_b32 a110, 0
  v_mfma_f32_32x32x16_bf16 v[224:239], v[52:55], v[72:75], v[224:239]
  v_mov_b32 v79, 0
  v_mul_f32 v33, 0x3e0293ee, v27
  v_accvgpr_write_b32 a111, 0
  v_mul_f32 v35, 0xbfb8aa3b, v27
  v_accvgpr_write_b32 a112, 0
  v_mfma_f32_32x32x16_bf16 a[128:143], v[56:59], v[68:71], a[128:143]
  v_cvt_pk_bf16_f32 v81, v28, 0
  v_accvgpr_write_b32 a113, 0
  v_lshlrev_b32 v2, 16, v81
  v_accvgpr_write_b32 a114, 0
  v_sub_f32 v2, v28, v2
  buffer_load_dwordx4 v18, s[4:7], s32 offen offset:1040 lds
  v_mfma_f32_32x32x16_bf16 a[144:159], v[56:59], v[72:75], a[144:159]
  v_cvt_pk_bf16_f32 v80, v28, v2
  v_accvgpr_write_b32 a115, 0
  v_cndmask_b32 v81, 0, v81, vcc
  v_accvgpr_write_b32 a116, 0
  v_cndmask_b32 v80, 0, v80, vcc
  v_accvgpr_write_b32 a117, 0
  v_mfma_f32_32x32x16_bf16 a[160:175], v[60:63], v[68:71], a[160:175]
  v_mov_b32 v82, 0
  v_accvgpr_write_b32 a118, 0
  v_mov_b32 v83, 0
  v_accvgpr_write_b32 a119, 0
  v_mul_f32 v34, 0x3e0293ee, v29
  v_mfma_f32_32x32x16_bf16 a[176:191], v[60:63], v[72:75], a[176:191]
  v_mul_f32 v36, 0xbfb8aa3b, v29
  v_accvgpr_write_b32 a120, 0
  ds_read_b128 a[224:227], v15 offset:0
  v_accvgpr_write_b32 a121, 0
  buffer_load_dwordx4 v19, s[4:7], s32 offen offset:2080 lds
  ds_read_b128 a[228:231], v15 offset:32
  v_accvgpr_write_b32 a122, 0
  v_mfma_f32_32x32x16_bf16 a[192:207], v[64:67], v[68:71], a[192:207]
  ds_read_b128 a[232:235], v15 offset:64
  v_accvgpr_write_b32 a123, 0
  ds_read_b128 a[236:239], v15 offset:96
  v_accvgpr_write_b32 a124, 0
  ds_read_b128 a[240:243], v15 offset:128
  v_mfma_f32_32x32x16_bf16 a[208:223], v[64:67], v[72:75], a[208:223]
  ds_read_b128 a[244:247], v15 offset:160
  v_accvgpr_write_b32 a125, 0
  ds_read_b128 a[248:251], v15 offset:192
  v_accvgpr_write_b32 a126, 0
  ds_read_b128 a[252:255], v15 offset:224
  v_accvgpr_write_b32 a127, 0
  buffer_load_dwordx4 v20, s[4:7], s32 offen offset:3120 lds
  s_nop 0
  s_waitcnt lgkmcnt(7)
  v_mfma_f32_32x32x16_bf16 v[112:127], v[240:243], v[76:79], v[112:127]
  s_mov_b32 s48, 0x47800000
  s_lshl_b32 s44, s30, 3
  s_lshl_b32 s45, s28, 1
  v_mfma_f32_32x32x16_bf16 v[128:143], v[240:243], v[80:83], v[128:143]
  s_add_u32 s44, s44, s45
  s_mul_i32 s45, s44, 86
  v_mfma_f32_32x32x16_bf16 v[144:159], v[242:245], v[76:79], v[144:159]
  s_add_u32 s45, s45, s31
  s_lshl_b32 s45, s45, 10
  v_mfma_f32_32x32x16_bf16 v[160:175], v[242:245], v[80:83], v[160:175]
  s_add_u32 s46, s45, 88064
  s_nop 0
  v_mfma_f32_32x32x16_bf16 v[176:191], v[244:247], v[76:79], v[176:191]
  v_mul_f32 v112, v112, v33
  v_mul_f32 v113, v113, v33
  v_mul_f32 v114, v114, v33
  v_mul_f32 v115, v115, v33
  v_mul_f32 v116, v116, v33
  v_mul_f32 v117, v117, v33
  v_mfma_f32_32x32x16_bf16 v[192:207], v[244:247], v[80:83], v[192:207]
  v_mul_f32 v118, v118, v33
  v_mul_f32 v119, v119, v33
  v_mul_f32 v120, v120, v33
  v_mul_f32 v121, v121, v33
  v_mul_f32 v122, v122, v33
  v_mul_f32 v123, v123, v33
  v_mfma_f32_32x32x16_bf16 v[208:223], v[246:249], v[76:79], v[208:223]
  v_mul_f32 v124, v124, v33
  v_mul_f32 v125, v125, v33
  v_mul_f32 v126, v126, v33
  v_mul_f32 v127, v127, v33
  v_cvt_pk_bf16_f32 v40, v112, v113
  v_cvt_pk_bf16_f32 v41, v114, v115
  v_mfma_f32_32x32x16_bf16 v[224:239], v[246:249], v[80:83], v[224:239]
  v_cvt_pk_bf16_f32 v42, v116, v117
  v_cvt_pk_bf16_f32 v43, v118, v119
  v_cvt_pk_bf16_f32 v44, v120, v121
  v_cvt_pk_bf16_f32 v45, v122, v123
  v_cvt_pk_bf16_f32 v46, v124, v125
  v_cvt_pk_bf16_f32 v47, v126, v127
  v_mfma_f32_32x32x16_bf16 a[128:143], v[248:251], v[76:79], a[128:143]
  v_mul_f32 v128, v128, v34
  v_mul_f32 v129, v129, v34
  v_mul_f32 v130, v130, v34
  v_mul_f32 v131, v131, v34
  v_mul_f32 v132, v132, v34
  v_mul_f32 v133, v133, v34
  v_mfma_f32_32x32x16_bf16 a[144:159], v[248:251], v[80:83], a[144:159]
  v_mul_f32 v134, v134, v34
  v_mul_f32 v135, v135, v34
  v_mul_f32 v136, v136, v34
  v_mul_f32 v137, v137, v34
  v_mul_f32 v138, v138, v34
  v_mul_f32 v139, v139, v34
  v_mfma_f32_32x32x16_bf16 a[160:175], v[250:253], v[76:79], a[160:175]
  v_mul_f32 v140, v140, v34
  v_mul_f32 v141, v141, v34
  v_mul_f32 v142, v142, v34
  v_mul_f32 v143, v143, v34
  v_cvt_pk_bf16_f32 v48, v128, v129
  v_cvt_pk_bf16_f32 v49, v130, v131
  v_mfma_f32_32x32x16_bf16 a[176:191], v[250:253], v[80:83], a[176:191]
  v_cvt_pk_bf16_f32 v50, v132, v133
  v_cvt_pk_bf16_f32 v51, v134, v135
  v_cvt_pk_bf16_f32 v52, v136, v137
  v_cvt_pk_bf16_f32 v53, v138, v139
  v_cvt_pk_bf16_f32 v54, v140, v141
  v_cvt_pk_bf16_f32 v55, v142, v143
  v_mfma_f32_32x32x16_bf16 a[192:207], v[252:255], v[76:79], a[192:207]
  v_mul_f32 v144, v144, v33
  v_mul_f32 v145, v145, v33
  v_mul_f32 v146, v146, v33
  v_mul_f32 v147, v147, v33
  v_mul_f32 v148, v148, v33
  v_mul_f32 v149, v149, v33
  v_mfma_f32_32x32x16_bf16 a[208:223], v[252:255], v[80:83], a[208:223]
  v_mul_f32 v150, v150, v33
  v_mul_f32 v151, v151, v33
  v_mul_f32 v152, v152, v33
  v_mul_f32 v153, v153, v33
  v_mul_f32 v154, v154, v33
  v_mul_f32 v155, v155, v33
  v_mfma_f32_32x32x16_bf16 v[112:127], a[224:227], v[40:43], 0
  v_mul_f32 v156, v156, v33
  v_mul_f32 v157, v157, v33
  v_mul_f32 v158, v158, v33
  v_mul_f32 v159, v159, v33
  v_cvt_pk_bf16_f32 v56, v144, v145
  v_cvt_pk_bf16_f32 v57, v146, v147
  v_cvt_pk_bf16_f32 v58, v148, v149
  v_cvt_pk_bf16_f32 v59, v150, v151
  v_cvt_pk_bf16_f32 v60, v152, v153
  v_cvt_pk_bf16_f32 v61, v154, v155
  v_cvt_pk_bf16_f32 v62, v156, v157
  v_cvt_pk_bf16_f32 v63, v158, v159
  v_mfma_f32_32x32x16_bf16 v[128:143], a[224:227], v[48:51], 0
  v_mul_f32 v160, v160, v34
  v_mul_f32 v161, v161, v34
  v_mul_f32 v162, v162, v34
  v_mul_f32 v163, v163, v34
  v_mul_f32 v164, v164, v34
  v_mul_f32 v165, v165, v34
  v_mul_f32 v166, v166, v34
  v_mul_f32 v167, v167, v34
  v_mul_f32 v168, v168, v34
  v_mul_f32 v169, v169, v34
  v_mul_f32 v170, v170, v34
  v_mul_f32 v171, v171, v34
  s_waitcnt lgkmcnt(0)
  v_mfma_f32_32x32x16_bf16 v[112:127], a[228:231], v[44:47], v[112:127]
  v_mul_f32 v172, v172, v34
  v_mul_f32 v173, v173, v34
  v_mul_f32 v174, v174, v34
  v_mul_f32 v175, v175, v34
  v_cvt_pk_bf16_f32 v64, v160, v161
  v_cvt_pk_bf16_f32 v65, v162, v163
  v_cvt_pk_bf16_f32 v66, v164, v165
  v_cvt_pk_bf16_f32 v67, v166, v167
  v_cvt_pk_bf16_f32 v68, v168, v169
  v_cvt_pk_bf16_f32 v69, v170, v171
  v_cvt_pk_bf16_f32 v70, v172, v173
  v_cvt_pk_bf16_f32 v71, v174, v175
  v_mfma_f32_32x32x16_bf16 v[128:143], a[228:231], v[52:55], v[128:143]
  s_nop 0
  v_mfma_f32_32x32x16_bf16 v[112:127], a[232:235], v[56:59], v[112:127]
  v_mul_f32 v176, v176, v33
  v_mul_f32 v177, v177, v33
  v_mul_f32 v178, v178, v33
  v_mul_f32 v179, v179, v33
  v_mul_f32 v180, v180, v33
  v_mul_f32 v181, v181, v33
  v_mul_f32 v182, v182, v33
  v_mul_f32 v183, v183, v33
  v_mul_f32 v184, v184, v33
  v_mul_f32 v185, v185, v33
  v_mul_f32 v186, v186, v33
  v_mul_f32 v187, v187, v33
  v_mul_f32 v188, v188, v33
  v_mul_f32 v189, v189, v33
  v_mul_f32 v190, v190, v33
  v_mul_f32 v191, v191, v33
  v_mfma_f32_32x32x16_bf16 v[128:143], a[232:235], v[64:67], v[128:143]
  v_cvt_pk_bf16_f32 v72, v176, v177
  v_cvt_pk_bf16_f32 v73, v178, v179
  v_cvt_pk_bf16_f32 v74, v180, v181
  v_cvt_pk_bf16_f32 v75, v182, v183
  v_cvt_pk_bf16_f32 v76, v184, v185
  v_cvt_pk_bf16_f32 v77, v186, v187
  v_cvt_pk_bf16_f32 v78, v188, v189
  v_cvt_pk_bf16_f32 v79, v190, v191
  v_mul_f32 v192, v192, v34
  v_mul_f32 v193, v193, v34
  v_mul_f32 v194, v194, v34
  v_mul_f32 v195, v195, v34
  v_mul_f32 v196, v196, v34
  v_mul_f32 v197, v197, v34
  v_mul_f32 v198, v198, v34
  v_mul_f32 v199, v199, v34
  v_mfma_f32_32x32x16_bf16 v[112:127], a[236:239], v[60:63], v[112:127]
  v_mul_f32 v200, v200, v34
  v_mul_f32 v201, v201, v34
  v_mul_f32 v202, v202, v34
  v_mul_f32 v203, v203, v34
  v_mul_f32 v204, v204, v34
  v_mul_f32 v205, v205, v34
  v_mul_f32 v206, v206, v34
  v_mul_f32 v207, v207, v34
  v_cvt_pk_bf16_f32 v80, v192, v193
  v_cvt_pk_bf16_f32 v81, v194, v195
  v_cvt_pk_bf16_f32 v82, v196, v197
  v_cvt_pk_bf16_f32 v83, v198, v199
  v_cvt_pk_bf16_f32 v84, v200, v201
  v_cvt_pk_bf16_f32 v85, v202, v203
  v_cvt_pk_bf16_f32 v86, v204, v205
  v_cvt_pk_bf16_f32 v87, v206, v207
  v_mfma_f32_32x32x16_bf16 v[128:143], a[236:239], v[68:71], v[128:143]
  ds_read_b128 a[224:227], v15 offset:512
  ds_read_b128 a[228:231], v15 offset:544
  s_nop 0
  v_mfma_f32_32x32x16_bf16 v[112:127], a[240:243], v[72:75], v[112:127]
  v_mul_f32 v208, v208, v33
  v_mul_f32 v209, v209, v33
  v_mul_f32 v210, v210, v33
  v_mul_f32 v211, v211, v33
  v_mul_f32 v212, v212, v33
  v_mul_f32 v213, v213, v33
  v_mul_f32 v214, v214, v33
  v_mul_f32 v215, v215, v33
  v_mul_f32 v216, v216, v33
  v_mul_f32 v217, v217, v33
  v_mul_f32 v218, v218, v33
  v_mul_f32 v219, v219, v33
  v_mul_f32 v220, v220, v33
  v_mul_f32 v221, v221, v33
  v_mul_f32 v222, v222, v33
  v_mul_f32 v223, v223, v33
  v_mfma_f32_32x32x16_bf16 v[128:143], a[240:243], v[80:83], v[128:143]
  v_cvt_pk_bf16_f32 v88, v208, v209
  v_cvt_pk_bf16_f32 v89, v210, v211
  v_cvt_pk_bf16_f32 v90, v212, v213
  v_cvt_pk_bf16_f32 v91, v214, v215
  v_cvt_pk_bf16_f32 v92, v216, v217
  v_cvt_pk_bf16_f32 v93, v218, v219
  v_cvt_pk_bf16_f32 v94, v220, v221
  v_cvt_pk_bf16_f32 v95, v222, v223
  v_mul_f32 v224, v224, v34
  v_mul_f32 v225, v225, v34
  v_mul_f32 v226, v226, v34
  v_mul_f32 v227, v227, v34
  v_mul_f32 v228, v228, v34
  v_mul_f32 v229, v229, v34
  v_mul_f32 v230, v230, v34
  v_mul_f32 v231, v231, v34
  v_mfma_f32_32x32x16_bf16 v[112:127], a[244:247], v[76:79], v[112:127]
  v_mul_f32 v232, v232, v34
  v_mul_f32 v233, v233, v34
  v_mul_f32 v234, v234, v34
  v_mul_f32 v235, v235, v34
  v_mul_f32 v236, v236, v34
  v_mul_f32 v237, v237, v34
  v_mul_f32 v238, v238, v34
  v_mul_f32 v239, v239, v34
  v_cvt_pk_bf16_f32 v96, v224, v225
  v_cvt_pk_bf16_f32 v97, v226, v227
  v_cvt_pk_bf16_f32 v98, v228, v229
  v_cvt_pk_bf16_f32 v99, v230, v231
  v_cvt_pk_bf16_f32 v100, v232, v233
  v_cvt_pk_bf16_f32 v101, v234, v235
  v_cvt_pk_bf16_f32 v102, v236, v237
  v_cvt_pk_bf16_f32 v103, v238, v239
  v_mfma_f32_32x32x16_bf16 v[128:143], a[244:247], v[84:87], v[128:143]
  ds_read_b128 a[232:235], v15 offset:576
  ds_read_b128 a[236:239], v15 offset:608
  s_nop 0
  v_mfma_f32_32x32x16_bf16 v[112:127], a[248:251], v[88:91], v[112:127]
  v_accvgpr_read_b32 v240, a128
  v_accvgpr_read_b32 v241, a129
  v_accvgpr_read_b32 v242, a130
  v_accvgpr_read_b32 v243, a131
  v_accvgpr_read_b32 v244, a132
  v_accvgpr_read_b32 v245, a133
  v_mfma_f32_32x32x16_bf16 v[128:143], a[248:251], v[96:99], v[128:143]
  v_accvgpr_read_b32 v246, a134
  v_accvgpr_read_b32 v247, a135
  v_mul_f32 v240, v240, v35
  v_mul_f32 v241, v241, v35
  v_mul_f32 v242, v242, v35
  v_mul_f32 v243, v243, v35
  ds_read_b128 a[240:243], v15 offset:640
  v_mfma_f32_32x32x16_bf16 v[112:127], a[252:255], v[92:95], v[112:127]
  v_mul_f32 v244, v244, v35
  v_mul_f32 v245, v245, v35
  v_mul_f32 v246, v246, v35
  v_mul_f32 v247, v247, v35
  v_exp_f32 v240, v240
  v_accvgpr_read_b32 v248, a160
  v_mfma_f32_32x32x16_bf16 v[128:143], a[252:255], v[100:103], v[128:143]
  v_exp_f32 v241, v241
  v_accvgpr_read_b32 v249, a161
  v_exp_f32 v242, v242
  v_accvgpr_read_b32 v250, a162
  v_exp_f32 v243, v243
  v_accvgpr_read_b32 v251, a163
  ds_read_b128 a[244:247], v15 offset:672
  ds_read_b128 a[248:251], v15 offset:704
  ds_read_b128 a[252:255], v15 offset:736
  s_add_u32 m0, s39, s42
  s_mul_i32 s33, s43, s36
  buffer_load_dwordx4 v21, s[8:11], s33 offen lds
  buffer_load_dwordx4 v22, s[8:11], s33 offen offset:1088 lds
  s_mul_i32 s34, s43, s37
  buffer_load_dwordx4 v23, s[12:15], s34 offen offset:2176 lds
  s_add_u32 s43, s43, 1
  s_and_b32 s43, s43, s51
  buffer_load_dwordx4 v24, s[16:19], s34 offen offset:3264 lds
  s_add_u32 s42, s42, s49
  s_cmp_eq_u32 s42, 136192
  s_cmov_b32 s42, 0
  v_exp_f32 v244, v244
  v_accvgpr_read_b32 v252, a164
  v_exp_f32 v245, v245
  v_accvgpr_read_b32 v253, a165
  v_exp_f32 v246, v246
  v_accvgpr_read_b32 v254, a166
  v_exp_f32 v247, v247
  v_accvgpr_read_b32 v255, a167
  v_add_f32 v240, 1.0, v240
  v_add_f32 v241, 1.0, v241
  v_add_f32 v242, 1.0, v242
  v_add_f32 v243, 1.0, v243
  v_add_f32 v244, 1.0, v244
  v_add_f32 v245, 1.0, v245
  v_add_f32 v246, 1.0, v246
  v_add_f32 v247, 1.0, v247
  v_rcp_f32 v240, v240
  v_mul_f32 v248, v248, v27
  v_rcp_f32 v241, v241
  v_mul_f32 v249, v249, v27
  v_rcp_f32 v242, v242
  v_mul_f32 v250, v250, v27
  v_rcp_f32 v243, v243
  v_mul_f32 v251, v251, v27
  v_rcp_f32 v244, v244
  v_mul_f32 v252, v252, v27
  v_rcp_f32 v245, v245
  v_mul_f32 v253, v253, v27
  v_rcp_f32 v246, v246
  v_mul_f32 v254, v254, v27
  v_rcp_f32 v247, v247
  v_mul_f32 v255, v255, v27
  v_mul_f32 v240, v240, v248
  v_mul_f32 v241, v241, v249
  v_mul_f32 v242, v242, v250
  v_mul_f32 v243, v243, v251
  v_mul_f32 v244, v244, v252
  v_mul_f32 v245, v245, v253
  v_mul_f32 v246, v246, v254
  v_mul_f32 v247, v247, v255
  v_cvt_pk_bf16_f32 v104, v240, v241
  v_cvt_pk_bf16_f32 v105, v242, v243
  v_cvt_pk_bf16_f32 v106, v244, v245
  v_cvt_pk_bf16_f32 v107, v246, v247
  buffer_store_dwordx4 v[104:107], v25, s[24:27], s45 offen offset:0 sc1
  v_accvgpr_read_b32 v240, a144
  v_accvgpr_read_b32 v241, a145
  v_accvgpr_read_b32 v242, a146
  v_accvgpr_read_b32 v243, a147
  v_accvgpr_read_b32 v244, a148
  v_accvgpr_read_b32 v245, a149
  v_accvgpr_read_b32 v246, a150
  v_accvgpr_read_b32 v247, a151
  v_mul_f32 v240, v240, v36
  v_mul_f32 v241, v241, v36
  v_mul_f32 v242, v242, v36
  v_mul_f32 v243, v243, v36
  v_mul_f32 v244, v244, v36
  v_mul_f32 v245, v245, v36
  v_mul_f32 v246, v246, v36
  v_mul_f32 v247, v247, v36
  v_exp_f32 v240, v240
  v_accvgpr_read_b32 v248, a176
  v_exp_f32 v241, v241
  v_accvgpr_read_b32 v249, a177
  v_exp_f32 v242, v242
  v_accvgpr_read_b32 v250, a178
  v_exp_f32 v243, v243
  v_accvgpr_read_b32 v251, a179
  v_exp_f32 v244, v244
  v_accvgpr_read_b32 v252, a180
  v_exp_f32 v245, v245
  v_accvgpr_read_b32 v253, a181
  v_exp_f32 v246, v246
  v_accvgpr_read_b32 v254, a182
  v_exp_f32 v247, v247
  v_accvgpr_read_b32 v255, a183
  v_add_f32 v240, 1.0, v240
  v_add_f32 v241, 1.0, v241
  v_add_f32 v242, 1.0, v242
  v_add_f32 v243, 1.0, v243
  v_add_f32 v244, 1.0, v244
  v_add_f32 v245, 1.0, v245
  v_add_f32 v246, 1.0, v246
  v_add_f32 v247, 1.0, v247
  v_rcp_f32 v240, v240
  v_mul_f32 v248, v248, v29
  v_rcp_f32 v241, v241
  v_mul_f32 v249, v249, v29
  v_rcp_f32 v242, v242
  v_mul_f32 v250, v250, v29
  v_rcp_f32 v243, v243
  v_mul_f32 v251, v251, v29
  v_rcp_f32 v244, v244
  v_mul_f32 v252, v252, v29
  v_rcp_f32 v245, v245
  v_mul_f32 v253, v253, v29
  v_rcp_f32 v246, v246
  v_mul_f32 v254, v254, v29
  v_rcp_f32 v247, v247
  v_mul_f32 v255, v255, v29
  v_mul_f32 v240, v240, v248
  v_mul_f32 v241, v241, v249
  v_mul_f32 v242, v242, v250
  v_mul_f32 v243, v243, v251
  v_mul_f32 v244, v244, v252
  v_mul_f32 v245, v245, v253
  v_mul_f32 v246, v246, v254
  v_mul_f32 v247, v247, v255
  v_cvt_pk_bf16_f32 v108, v240, v241
  v_cvt_pk_bf16_f32 v109, v242, v243
  v_cvt_pk_bf16_f32 v110, v244, v245
  v_cvt_pk_bf16_f32 v111, v246, v247
  buffer_store_dwordx4 v[108:111], v25, s[24:27], s46 offen offset:0 sc1
  v_accvgpr_read_b32 v240, a136
  v_accvgpr_read_b32 v241, a137
  v_accvgpr_read_b32 v242, a138
  v_accvgpr_read_b32 v243, a139
  v_accvgpr_read_b32 v244, a140
  v_accvgpr_read_b32 v245, a141
  v_accvgpr_read_b32 v246, a142
  v_accvgpr_read_b32 v247, a143
  v_mul_f32 v240, v240, v35
  v_mul_f32 v241, v241, v35
  v_mul_f32 v242, v242, v35
  v_mul_f32 v243, v243, v35
  v_mul_f32 v244, v244, v35
  v_mul_f32 v245, v245, v35
  v_mul_f32 v246, v246, v35
  v_mul_f32 v247, v247, v35
  v_exp_f32 v240, v240
  v_accvgpr_read_b32 v248, a168
  v_exp_f32 v241, v241
  v_accvgpr_read_b32 v249, a169
  v_exp_f32 v242, v242
  v_accvgpr_read_b32 v250, a170
  v_exp_f32 v243, v243
  v_accvgpr_read_b32 v251, a171
  v_exp_f32 v244, v244
  v_accvgpr_read_b32 v252, a172
  v_exp_f32 v245, v245
  v_accvgpr_read_b32 v253, a173
  v_exp_f32 v246, v246
  v_accvgpr_read_b32 v254, a174
  v_exp_f32 v247, v247
  v_accvgpr_read_b32 v255, a175
  v_add_f32 v240, 1.0, v240
  v_add_f32 v241, 1.0, v241
  v_add_f32 v242, 1.0, v242
  v_add_f32 v243, 1.0, v243
  v_add_f32 v244, 1.0, v244
  v_add_f32 v245, 1.0, v245
  v_add_f32 v246, 1.0, v246
  v_add_f32 v247, 1.0, v247
  v_rcp_f32 v240, v240
  v_mul_f32 v248, v248, v27
  v_rcp_f32 v241, v241
  v_mul_f32 v249, v249, v27
  v_rcp_f32 v242, v242
  v_mul_f32 v250, v250, v27
  v_rcp_f32 v243, v243
  v_mul_f32 v251, v251, v27
  v_rcp_f32 v244, v244
  v_mul_f32 v252, v252, v27
  v_rcp_f32 v245, v245
  v_mul_f32 v253, v253, v27
  v_rcp_f32 v246, v246
  v_mul_f32 v254, v254, v27
  v_rcp_f32 v247, v247
  v_mul_f32 v255, v255, v27
  v_mul_f32 v240, v240, v248
  v_mul_f32 v241, v241, v249
  v_mul_f32 v242, v242, v250
  v_mul_f32 v243, v243, v251
  v_mul_f32 v244, v244, v252
  v_mul_f32 v245, v245, v253
  v_mul_f32 v246, v246, v254
  v_mul_f32 v247, v247, v255
  v_cvt_pk_bf16_f32 v104, v240, v241
  v_cvt_pk_bf16_f32 v105, v242, v243
  v_cvt_pk_bf16_f32 v106, v244, v245
  v_cvt_pk_bf16_f32 v107, v246, v247
  buffer_store_dwordx4 v[104:107], v25, s[24:27], s45 offen offset:1024 sc1
  v_accvgpr_read_b32 v240, a152
  v_accvgpr_read_b32 v241, a153
  v_accvgpr_read_b32 v242, a154
  v_accvgpr_read_b32 v243, a155
  v_accvgpr_read_b32 v244, a156
  v_accvgpr_read_b32 v245, a157
  v_accvgpr_read_b32 v246, a158
  v_accvgpr_read_b32 v247, a159
  v_mul_f32 v240, v240, v36
  v_mul_f32 v241, v241, v36
  v_mul_f32 v242, v242, v36
  v_mul_f32 v243, v243, v36
  v_mul_f32 v244, v244, v36
  v_mul_f32 v245, v245, v36
  v_mul_f32 v246, v246, v36
  v_mul_f32 v247, v247, v36
  v_exp_f32 v240, v240
  v_accvgpr_read_b32 v248, a184
  v_exp_f32 v241, v241
  v_accvgpr_read_b32 v249, a185
  v_exp_f32 v242, v242
  v_accvgpr_read_b32 v250, a186
  v_exp_f32 v243, v243
  v_accvgpr_read_b32 v251, a187
  v_exp_f32 v244, v244
  v_accvgpr_read_b32 v252, a188
  v_exp_f32 v245, v245
  v_accvgpr_read_b32 v253, a189
  v_exp_f32 v246, v246
  v_accvgpr_read_b32 v254, a190
  v_exp_f32 v247, v247
  v_accvgpr_read_b32 v255, a191
  v_add_f32 v240, 1.0, v240
  v_add_f32 v241, 1.0, v241
  v_add_f32 v242, 1.0, v242
  v_add_f32 v243, 1.0, v243
  v_add_f32 v244, 1.0, v244
  v_add_f32 v245, 1.0, v245
  v_add_f32 v246, 1.0, v246
  v_add_f32 v247, 1.0, v247
  v_rcp_f32 v240, v240
  v_mul_f32 v248, v248, v29
  v_rcp_f32 v241, v241
  v_mul_f32 v249, v249, v29
  v_rcp_f32 v242, v242
  v_mul_f32 v250, v250, v29
  v_rcp_f32 v243, v243
  v_mul_f32 v251, v251, v29
  v_rcp_f32 v244, v244
  v_mul_f32 v252, v252, v29
  v_rcp_f32 v245, v245
  v_mul_f32 v253, v253, v29
  v_rcp_f32 v246, v246
  v_mul_f32 v254, v254, v29
  v_rcp_f32 v247, v247
  v_mul_f32 v255, v255, v29
  v_mul_f32 v240, v240, v248
  v_mul_f32 v241, v241, v249
  v_mul_f32 v242, v242, v250
  v_mul_f32 v243, v243, v251
  v_mul_f32 v244, v244, v252
  v_mul_f32 v245, v245, v253
  v_mul_f32 v246, v246, v254
  v_mul_f32 v247, v247, v255
  v_cvt_pk_bf16_f32 v108, v240, v241
  v_cvt_pk_bf16_f32 v109, v242, v243
  v_cvt_pk_bf16_f32 v110, v244, v245
  v_cvt_pk_bf16_f32 v111, v246, v247
  buffer_store_dwordx4 v[108:111], v25, s[24:27], s46 offen offset:1024 sc1
  v_max3_f32 v38, v112, v113, v114
  v_max3_f32 v38, v38, v115, v116
  v_max3_f32 v38, v38, v117, v118
  v_max3_f32 v38, v38, v119, v120
  v_max3_f32 v38, v38, v121, v122
  v_max3_f32 v38, v38, v123, v124
  v_max3_f32 v38, v38, v125, v126
  v_max_f32 v38, v38, v127
  v_mov_b32 v39, v38
  s_nop 1
  v_permlane32_swap_b32 v39, v38
  s_nop 1
  v_max_f32 v38, v38, v39
  v_sub_f32 v176, 0, v38
  v_sub_f32 v177, 0, v38
  v_sub_f32 v178, 0, v38
  v_sub_f32 v179, 0, v38
  v_sub_f32 v180, 0, v38
  v_sub_f32 v181, 0, v38
  v_sub_f32 v182, 0, v38
  v_sub_f32 v183, 0, v38
  v_sub_f32 v184, 0, v38
  v_sub_f32 v185, 0, v38
  v_sub_f32 v186, 0, v38
  v_sub_f32 v187, 0, v38
  v_sub_f32 v188, 0, v38
  v_sub_f32 v189, 0, v38
  v_sub_f32 v190, 0, v38
  v_sub_f32 v191, 0, v38
  v_max3_f32 v39, v128, v129, v130
  v_max3_f32 v39, v39, v131, v132
  v_max3_f32 v39, v39, v133, v134
  v_max3_f32 v39, v39, v135, v136
  v_max3_f32 v39, v39, v137, v138
  v_max3_f32 v39, v39, v139, v140
  v_max3_f32 v39, v39, v141, v142
  v_max_f32 v39, v39, v143
  v_mov_b32 v37, v39
  s_nop 1
  v_permlane32_swap_b32 v37, v39
  s_nop 1
  v_max_f32 v39, v39, v37
  v_sub_f32 v192, 0, v39
  v_sub_f32 v193, 0, v39
  v_sub_f32 v194, 0, v39
  v_sub_f32 v195, 0, v39
  v_sub_f32 v196, 0, v39
  v_sub_f32 v197, 0, v39
  v_sub_f32 v198, 0, v39
  v_sub_f32 v199, 0, v39
  v_sub_f32 v200, 0, v39
  v_sub_f32 v201, 0, v39
  v_sub_f32 v202, 0, v39
  v_sub_f32 v203, 0, v39
  v_sub_f32 v204, 0, v39
  v_sub_f32 v205, 0, v39
  v_sub_f32 v206, 0, v39
  v_sub_f32 v207, 0, v39
  v_sub_f32 v112, v112, v38
  v_sub_f32 v113, v113, v38
  s_waitcnt lgkmcnt(0)
  v_mfma_f32_32x32x16_bf16 v[144:159], a[224:227], v[40:43], v[176:191]
  v_sub_f32 v114, v114, v38
  v_sub_f32 v115, v115, v38
  v_sub_f32 v116, v116, v38
  v_sub_f32 v117, v117, v38
  v_sub_f32 v118, v118, v38
  v_sub_f32 v119, v119, v38
  v_sub_f32 v120, v120, v38
  v_sub_f32 v121, v121, v38
  v_sub_f32 v122, v122, v38
  v_sub_f32 v123, v123, v38
  v_sub_f32 v124, v124, v38
  v_sub_f32 v125, v125, v38
  v_sub_f32 v126, v126, v38
  v_sub_f32 v127, v127, v38
  ds_read_b64_tr_b16 a[128:129], v16 offset:0
  v_exp_f32 v2, v112
  ds_read_b64_tr_b16 a[130:131], v16 offset:512
  v_mfma_f32_32x32x16_bf16 v[160:175], a[224:227], v[48:51], v[192:207]
  v_exp_f32 v3, v113
  v_exp_f32 v4, v114
  v_add_f32 v30, v2, v3
  v_cvt_pk_bf16_f32 v208, v2, v3
  v_exp_f32 v5, v115
  v_exp_f32 v6, v116
  v_add_f32 v30, v30, v4
  v_cvt_pk_bf16_f32 v209, v4, v5
  v_exp_f32 v7, v117
  v_add_f32 v30, v30, v5
  v_exp_f32 v8, v118
  v_add_f32 v30, v30, v6
  v_cvt_pk_bf16_f32 v210, v6, v7
  v_exp_f32 v9, v119
  ds_read_b64_tr_b16 a[136:137], v16 offset:64
  v_add_f32 v30, v30, v7
  ds_read_b64_tr_b16 a[138:139], v16 offset:576
  v_mfma_f32_32x32x16_bf16 v[144:159], a[228:231], v[44:47], v[144:159]
  v_exp_f32 v2, v120
  v_add_f32 v30, v30, v8
  v_cvt_pk_bf16_f32 v211, v8, v9
  v_exp_f32 v3, v121
  v_add_f32 v30, v30, v9
  v_exp_f32 v4, v122
  v_add_f32 v30, v30, v2
  v_cvt_pk_bf16_f32 v212, v2, v3
  v_exp_f32 v5, v123
  v_add_f32 v30, v30, v3
  v_exp_f32 v6, v124
  v_add_f32 v30, v30, v4
  v_cvt_pk_bf16_f32 v213, v4, v5
  v_exp_f32 v7, v125
  v_add_f32 v30, v30, v5
  ds_read_b64_tr_b16 a[144:145], v16 offset:128
  v_exp_f32 v8, v126
  ds_read_b64_tr_b16 a[146:147], v16 offset:640
  v_mfma_f32_32x32x16_bf16 v[160:175], a[228:231], v[52:55], v[160:175]
  v_add_f32 v30, v30, v6
  v_cvt_pk_bf16_f32 v214, v6, v7
  v_exp_f32 v9, v127
  v_add_f32 v30, v30, v7
  v_add_f32 v30, v30, v8
  v_cvt_pk_bf16_f32 v215, v8, v9
  v_add_f32 v30, v30, v9
  v_sub_f32 v128, v128, v39
  v_sub_f32 v129, v129, v39
  v_sub_f32 v130, v130, v39
  v_sub_f32 v131, v131, v39
  v_sub_f32 v132, v132, v39
  v_sub_f32 v133, v133, v39
  v_sub_f32 v134, v134, v39
  ds_read_b64_tr_b16 a[152:153], v16 offset:192
  v_sub_f32 v135, v135, v39
  ds_read_b64_tr_b16 a[154:155], v16 offset:704
  v_mfma_f32_32x32x16_bf16 v[144:159], a[232:235], v[56:59], v[144:159]
  v_sub_f32 v136, v136, v39
  v_sub_f32 v137, v137, v39
  v_sub_f32 v138, v138, v39
  v_sub_f32 v139, v139, v39
  v_sub_f32 v140, v140, v39
  v_sub_f32 v141, v141, v39
  v_sub_f32 v142, v142, v39
  v_sub_f32 v143, v143, v39
  v_exp_f32 v2, v128
  v_exp_f32 v3, v129
  v_exp_f32 v4, v130
  v_add_f32 v31, v2, v3
  v_cvt_pk_bf16_f32 v216, v2, v3
  v_exp_f32 v5, v131
  ds_read_b64_tr_b16 a[132:133], v16 offset:4352
  v_exp_f32 v6, v132
  ds_read_b64_tr_b16 a[134:135], v16 offset:4864
  v_mfma_f32_32x32x16_bf16 v[160:175], a[232:235], v[64:67], v[160:175]
  v_add_f32 v31, v31, v4
  v_cvt_pk_bf16_f32 v217, v4, v5
  v_exp_f32 v7, v133
  v_add_f32 v31, v31, v5
  v_exp_f32 v8, v134
  v_add_f32 v31, v31, v6
  v_cvt_pk_bf16_f32 v218, v6, v7
  v_exp_f32 v9, v135
  v_add_f32 v31, v31, v7
  v_exp_f32 v2, v136
  v_add_f32 v31, v31, v8
  v_cvt_pk_bf16_f32 v219, v8, v9
  v_exp_f32 v3, v137
  v_add_f32 v31, v31, v9
  v_exp_f32 v4, v138
  ds_read_b64_tr_b16 a[140:141], v16 offset:4416
  v_add_f32 v31, v31, v2
  ds_read_b64_tr_b16 a[142:143], v16 offset:4928
  v_mfma_f32_32x32x16_bf16 v[144:159], a[236:239], v[60:63], v[144:159]
  v_cvt_pk_bf16_f32 v220, v2, v3
  v_exp_f32 v5, v139
  v_add_f32 v31, v31, v3
  v_exp_f32 v6, v140
  v_add_f32 v31, v31, v4
  v_cvt_pk_bf16_f32 v221, v4, v5
  v_exp_f32 v7, v141
  v_add_f32 v31, v31, v5
  v_exp_f32 v8, v142
  v_add_f32 v31, v31, v6
  v_cvt_pk_bf16_f32 v222, v6, v7
  v_exp_f32 v9, v143
  v_add_f32 v31, v31, v7
  v_add_f32 v31, v31, v8
  ds_read_b64_tr_b16 a[148:149], v16 offset:4480
  v_cvt_pk_bf16_f32 v223, v8, v9
  ds_read_b64_tr_b16 a[150:151], v16 offset:4992
  v_mfma_f32_32x32x16_bf16 v[160:175], a[236:239], v[68:71], v[160:175]
  v_add_f32 v31, v31, v9
  v_accvgpr_read_b32 v240, a192
  v_accvgpr_read_b32 v241, a193
  v_accvgpr_read_b32 v242, a194
  v_accvgpr_read_b32 v243, a195
  v_accvgpr_read_b32 v244, a196
  v_accvgpr_read_b32 v245, a197
  v_accvgpr_read_b32 v246, a198
  v_accvgpr_read_b32 v247, a199
  v_mul_f32 v240, v240, v35
  v_mul_f32 v241, v241, v35
  v_mul_f32 v242, v242, v35
  v_mul_f32 v243, v243, v35
  v_mul_f32 v244, v244, v35
  v_mul_f32 v245, v245, v35
  ds_read_b64_tr_b16 a[156:157], v16 offset:4544
  v_mul_f32 v246, v246, v35
  ds_read_b64_tr_b16 a[158:159], v16 offset:5056
  v_mfma_f32_32x32x16_bf16 v[144:159], a[240:243], v[72:75], v[144:159]
  v_mul_f32 v247, v247, v35
  v_exp_f32 v240, v240
  v_accvgpr_read_b32 v248, a200
  v_exp_f32 v241, v241
  v_accvgpr_read_b32 v249, a201
  v_exp_f32 v242, v242
  v_accvgpr_read_b32 v250, a202
  v_exp_f32 v243, v243
  v_accvgpr_read_b32 v251, a203
  v_exp_f32 v244, v244
  v_accvgpr_read_b32 v252, a204
  v_exp_f32 v245, v245
  v_accvgpr_read_b32 v253, a205
  v_exp_f32 v246, v246
  v_accvgpr_read_b32 v254, a206
  v_mfma_f32_32x32x16_bf16 v[160:175], a[240:243], v[80:83], v[160:175]
  v_exp_f32 v247, v247
  v_accvgpr_read_b32 v255, a207
  v_add_f32 v240, 1.0, v240
  v_add_f32 v241, 1.0, v241
  v_add_f32 v242, 1.0, v242
  v_add_f32 v243, 1.0, v243
  v_add_f32 v244, 1.0, v244
  v_add_f32 v245, 1.0, v245
  v_add_f32 v246, 1.0, v246
  v_add_f32 v247, 1.0, v247
  v_rcp_f32 v240, v240
  v_mul_f32 v248, v248, v27
  v_rcp_f32 v241, v241
  v_mul_f32 v249, v249, v27
  v_rcp_f32 v242, v242
  v_mfma_f32_32x32x16_bf16 v[144:159], a[244:247], v[76:79], v[144:159]
  v_mul_f32 v250, v250, v27
  v_rcp_f32 v243, v243
  v_mul_f32 v251, v251, v27
  v_rcp_f32 v244, v244
  v_mul_f32 v252, v252, v27
  v_rcp_f32 v245, v245
  v_mul_f32 v253, v253, v27
  v_rcp_f32 v246, v246
  v_mul_f32 v254, v254, v27
  v_rcp_f32 v247, v247
  v_mul_f32 v255, v255, v27
  v_mul_f32 v240, v240, v248
  v_mul_f32 v241, v241, v249
  v_mul_f32 v242, v242, v250
  v_mul_f32 v243, v243, v251
  v_mul_f32 v244, v244, v252
  v_mfma_f32_32x32x16_bf16 v[160:175], a[244:247], v[84:87], v[160:175]
  v_mul_f32 v245, v245, v253
  v_mul_f32 v246, v246, v254
  v_mul_f32 v247, v247, v255
  v_cvt_pk_bf16_f32 v104, v240, v241
  v_cvt_pk_bf16_f32 v105, v242, v243
  v_cvt_pk_bf16_f32 v106, v244, v245
  v_cvt_pk_bf16_f32 v107, v246, v247
  buffer_store_dwordx4 v[104:107], v25, s[24:27], s45 offen offset:2048 sc1
  v_accvgpr_read_b32 v240, a208
  v_accvgpr_read_b32 v241, a209
  v_accvgpr_read_b32 v242, a210
  v_accvgpr_read_b32 v243, a211
  v_accvgpr_read_b32 v244, a212
  v_accvgpr_read_b32 v245, a213
  v_accvgpr_read_b32 v246, a214
  v_mfma_f32_32x32x16_bf16 v[144:159], a[248:251], v[88:91], v[144:159]
  v_accvgpr_read_b32 v247, a215
  v_mul_f32 v240, v240, v36
  v_mul_f32 v241, v241, v36
  v_mul_f32 v242, v242, v36
  v_mul_f32 v243, v243, v36
  v_mul_f32 v244, v244, v36
  v_mul_f32 v245, v245, v36
  v_mul_f32 v246, v246, v36
  v_mul_f32 v247, v247, v36
  v_exp_f32 v240, v240
  v_accvgpr_read_b32 v248, a216
  v_exp_f32 v241, v241
  v_accvgpr_read_b32 v249, a217
  v_exp_f32 v242, v242
  v_accvgpr_read_b32 v250, a218
  v_mfma_f32_32x32x16_bf16 v[160:175], a[248:251], v[96:99], v[160:175]
  v_exp_f32 v243, v243
  v_accvgpr_read_b32 v251, a219
  v_exp_f32 v244, v244
  v_accvgpr_read_b32 v252, a220
  v_exp_f32 v245, v245
  v_accvgpr_read_b32 v253, a221
  v_exp_f32 v246, v246
  v_accvgpr_read_b32 v254, a222
  v_exp_f32 v247, v247
  v_accvgpr_read_b32 v255, a223
  v_add_f32 v240, 1.0, v240
  v_add_f32 v241, 1.0, v241
  v_add_f32 v242, 1.0, v242
  v_add_f32 v243, 1.0, v243
  v_add_f32 v244, 1.0, v244
  v_add_f32 v245, 1.0, v245
  v_mfma_f32_32x32x16_bf16 v[144:159], a[252:255], v[92:95], v[144:159]
  v_add_f32 v246, 1.0, v246
  v_add_f32 v247, 1.0, v247
  v_rcp_f32 v240, v240
  v_mul_f32 v248, v248, v29
  v_rcp_f32 v241, v241
  v_mul_f32 v249, v249, v29
  v_rcp_f32 v242, v242
  v_mul_f32 v250, v250, v29
  v_rcp_f32 v243, v243
  v_mul_f32 v251, v251, v29
  v_rcp_f32 v244, v244
  v_mul_f32 v252, v252, v29
  v_rcp_f32 v245, v245
  v_mul_f32 v253, v253, v29
  v_rcp_f32 v246, v246
  v_mfma_f32_32x32x16_bf16 v[160:175], a[252:255], v[100:103], v[160:175]
  v_mul_f32 v254, v254, v29
  v_rcp_f32 v247, v247
  v_mul_f32 v255, v255, v29
  v_mul_f32 v240, v240, v248
  v_mul_f32 v241, v241, v249
  v_mul_f32 v242, v242, v250
  v_mul_f32 v243, v243, v251
  v_mul_f32 v244, v244, v252
  v_mul_f32 v245, v245, v253
  v_mul_f32 v246, v246, v254
  v_mul_f32 v247, v247, v255
  v_cvt_pk_bf16_f32 v108, v240, v241
  v_cvt_pk_bf16_f32 v109, v242, v243
  v_cvt_pk_bf16_f32 v110, v244, v245
  v_cvt_pk_bf16_f32 v111, v246, v247
  buffer_store_dwordx4 v[108:111], v25, s[24:27], s46 offen offset:2048 sc1
  v_mov_b32 v10, v30
  v_mov_b32 v11, v31
  s_lshr_b32 s44, s2, 3
  s_mul_i32 s45, s44, 11264
  s_lshl_b32 s44, s44, 15
  s_lshl_b32 s46, s68, 20
  s_add_u32 s44, s44, s46
  s_mul_i32 s46, s68, 352256
  s_add_u32 s45, s45, s46
  v_lshlrev_b32 v248, 7, v0
  v_mov_b32 v249, 0x40000000
  v_cmp_gt_u32 vcc, 88, v0
  s_mov_b32 s80, s60
  s_mov_b32 s81, s61
  s_mov_b32 s82, 4194304
  s_mov_b32 s83, 0x00020000
  v_cndmask_b32 v249, v249, v248, vcc
  buffer_load_dword v250, v248, s[80:83], s44 offen
  s_mov_b32 s80, s72
  s_mov_b32 s81, s73
  s_mov_b32 s82, 1409024
  s_mov_b32 s83, 0x00020000
  buffer_load_dword v250, v249, s[80:83], s45 offen
  v_lshrrev_b32 v248, 4, v1
  v_lshlrev_b32 v248, 12, v248
  s_lshl_b32 s45, s68, 2
  v_add_u32 v249, s45, v1
  v_and_b32 v249, 15, v249
  v_lshl_add_u32 v248, v249, 4, v248
  s_lshl_b32 s44, s69, 8
  s_lshl_b32 s45, s28, 14
  s_add_u32 s44, s44, s45
  s_add_u32 s44, s44, 256
  v_add_u32 v240, s44, v248
  v_subrev_u32 v241, 64, v240
  v_subrev_u32 v242, 128, v240
  v_subrev_u32 v243, 192, v240
  v_subrev_u32 v244, 16640, v16
  v_add_u32 v245, 35584, v16
  v_and_b32 v248, 31, v1
  v_lshrrev_b32 v249, 5, v1
  s_lshl_b32 s44, s70, 5
  v_add_u32 v248, s44, v248
  v_lshlrev_b32 v248, 10, v248
  v_lshl_add_u32 v248, v249, 3, v248
  s_lshl_b32 s44, s68, 6
  s_lshl_b32 s45, s69, 8
  s_add_u32 s44, s44, s45
  v_add_u32 v246, s44, v248
  v_and_b32 v12, 31, v1
  v_lshlrev_b32 v12, 9, v12
  s_add_u32 s80, s78, 83886080
  s_addc_u32 s81, s79, 0
  s_mov_b32 s82, 131072
  s_mov_b32 s83, 0x00020000
  s_lshl_b32 s44, s2, 16
  s_lshl_b32 s45, s28, 11
  s_add_u32 s44, s44, s45
  s_add_u32 s44, s44, 67141632
  s_add_u32 s24, s78, s44
  s_addc_u32 s25, s79, 0
  s_mov_b32 s26, 26624
  v_mov_b32 v252, -1
  v_mov_b32 v253, -1
  v_mov_b32 v254, -1
  v_mov_b32 v255, -1
  s_mov_b32 s41, 0
  s_waitcnt lgkmcnt(0)
L_att:
  s_waitcnt lgkmcnt(2)
  v_mfma_f32_32x32x16_bf16 a[0:15], a[128:131], v[208:211], a[0:15]
  s_cmp_eq_u32 s42, 68096
  s_cselect_b32 s40, s50, s49
  v_add_u32 v15, s40, v15
  s_waitcnt vmcnt(10)
  s_barrier
  v_mfma_f32_32x32x16_bf16 a[16:31], a[128:131], v[216:219], a[16:31]
  ds_read_b128 a[224:227], v15 offset:0
  v_mfma_f32_32x32x16_bf16 a[32:47], a[136:139], v[208:211], a[32:47]
  v_exp_f32 v2, v144
  v_exp_f32 v3, v145
  v_exp_f32 v4, v146
  v_mfma_f32_32x32x16_bf16 a[48:63], a[136:139], v[216:219], a[48:63]
  v_add_f32 v30, v2, v3
  v_cvt_pk_bf16_f32 v224, v2, v3
  ds_read_b128 a[228:231], v15 offset:32
  v_exp_f32 v5, v147
  v_mfma_f32_32x32x16_bf16 a[64:79], a[144:147], v[208:211], a[64:79]
  v_exp_f32 v6, v148
  v_add_f32 v30, v30, v4
  s_cmp_eq_u32 s41, 1
  s_cbranch_scc1 L_hflag
L_ret4:
  ds_read_b128 a[232:235], v15 offset:64
  v_mfma_f32_32x32x16_bf16 a[80:95], a[144:147], v[216:219], a[80:95]
  v_cvt_pk_bf16_f32 v225, v4, v5
  v_exp_f32 v7, v149
  v_add_f32 v30, v30, v5
  ds_read_b128 a[236:239], v15 offset:96
  v_mfma_f32_32x32x16_bf16 a[96:111], a[152:155], v[208:211], a[96:111]
  v_exp_f32 v8, v150
  v_add_f32 v30, v30, v6
  v_cvt_pk_bf16_f32 v226, v6, v7
  v_mfma_f32_32x32x16_bf16 a[112:127], a[152:155], v[216:219], a[112:127]
  v_exp_f32 v9, v151
  v_add_f32 v30, v30, v7
  s_add_u32 m0, s38, s42
  s_mul_i32 s32, s43, s35
  buffer_load_dwordx4 v17, s[4:7], s32 offen lds
  v_mfma_f32_32x32x16_bf16 a[0:15], a[132:135], v[212:215], a[0:15]
  v_exp_f32 v2, v152
  v_add_f32 v30, v30, v8
  v_cvt_pk_bf16_f32 v227, v8, v9
  ds_read_b128 a[240:243], v15 offset:128
  v_mfma_f32_32x32x16_bf16 a[16:31], a[132:135], v[220:223], a[16:31]
  v_exp_f32 v3, v153
  v_add_f32 v30, v30, v9
  v_exp_f32 v4, v154
  ds_read_b128 a[244:247], v15 offset:160
  v_mfma_f32_32x32x16_bf16 a[32:47], a[140:143], v[212:215], a[32:47]
  v_add_f32 v30, v30, v2
  v_cvt_pk_bf16_f32 v228, v2, v3
  buffer_load_dwordx4 v18, s[4:7], s32 offen offset:1040 lds
  v_exp_f32 v5, v155
  v_mfma_f32_32x32x16_bf16 a[48:63], a[140:143], v[220:223], a[48:63]
  v_add_f32 v30, v30, v3
  v_exp_f32 v6, v156
  ds_read_b128 a[248:251], v15 offset:192
  v_add_f32 v30, v30, v4
  v_mfma_f32_32x32x16_bf16 a[64:79], a[148:151], v[212:215], a[64:79]
  v_cvt_pk_bf16_f32 v229, v4, v5
  v_exp_f32 v7, v157
  buffer_load_dwordx4 v19, s[4:7], s32 offen offset:2080 lds
  ds_read_b128 a[252:255], v15 offset:224
  v_mfma_f32_32x32x16_bf16 a[80:95], a[148:151], v[220:223], a[80:95]
  v_add_f32 v30, v30, v5
  v_exp_f32 v8, v158
  v_add_f32 v30, v30, v6
  s_waitcnt lgkmcnt(2)
  v_mfma_f32_32x32x16_bf16 a[96:111], a[156:159], v[212:215], a[96:111]
  v_cvt_pk_bf16_f32 v230, v6, v7
  v_exp_f32 v9, v159
  v_add_f32 v30, v30, v7
  buffer_load_dwordx4 v20, s[4:7], s32 offen offset:3120 lds
  v_mfma_f32_32x32x16_bf16 a[112:127], a[156:159], v[220:223], a[112:127]
  v_add_f32 v30, v30, v8
  v_cvt_pk_bf16_f32 v231, v8, v9
  v_add_f32 v30, v30, v9
  v_mfma_f32_32x32x16_bf16 v[112:127], a[224:227], v[40:43], v[176:191]
  v_exp_f32 v2, v160
  v_exp_f32 v3, v161
  ds_read_b64_tr_b16 a[128:129], v16 offset:8704
  v_mfma_f32_32x32x16_bf16 v[128:143], a[224:227], v[48:51], v[192:207]
  v_exp_f32 v4, v162
  v_add_f32 v31, v2, v3
  ds_read_b64_tr_b16 a[130:131], v16 offset:9216
  v_cvt_pk_bf16_f32 v232, v2, v3
  ds_read_b64_tr_b16 a[136:137], v16 offset:8768
  v_mfma_f32_32x32x16_bf16 v[112:127], a[228:231], v[44:47], v[112:127]
  v_exp_f32 v5, v163
  v_exp_f32 v6, v164
  v_add_f32 v31, v31, v4
  ds_read_b64_tr_b16 a[138:139], v16 offset:9280
  v_mfma_f32_32x32x16_bf16 v[128:143], a[228:231], v[52:55], v[128:143]
  v_cvt_pk_bf16_f32 v233, v4, v5
  v_exp_f32 v7, v165
  ds_read_b64_tr_b16 a[144:145], v16 offset:8832
  v_mfma_f32_32x32x16_bf16 v[112:127], a[232:235], v[56:59], v[112:127]
  v_add_f32 v31, v31, v5
  v_exp_f32 v8, v166
  ds_read_b64_tr_b16 a[146:147], v16 offset:9344
  s_add_u32 m0, s39, s42
  s_mul_i32 s33, s43, s36
  buffer_load_dwordx4 v21, s[8:11], s33 offen lds
  v_mfma_f32_32x32x16_bf16 v[128:143], a[232:235], v[64:67], v[128:143]
  v_add_f32 v31, v31, v6
  v_cvt_pk_bf16_f32 v234, v6, v7
  v_exp_f32 v9, v167
  ds_read_b64_tr_b16 a[152:153], v16 offset:8896
  v_add_f32 v31, v31, v7
  v_mfma_f32_32x32x16_bf16 v[112:127], a[236:239], v[60:63], v[112:127]
  v_exp_f32 v2, v168
  ds_read_b64_tr_b16 a[154:155], v16 offset:9408
  v_add_f32 v31, v31, v8
  v_mfma_f32_32x32x16_bf16 v[128:143], a[236:239], v[68:71], v[128:143]
  v_cvt_pk_bf16_f32 v235, v8, v9
  ds_read_b64_tr_b16 a[132:133], v16 offset:13056
  v_exp_f32 v3, v169
  buffer_load_dwordx4 v22, s[8:11], s33 offen offset:1088 lds
  s_mul_i32 s34, s43, s37
  v_mfma_f32_32x32x16_bf16 v[112:127], a[240:243], v[72:75], v[112:127]
  v_add_f32 v31, v31, v9
  v_exp_f32 v4, v170
  ds_read_b64_tr_b16 a[134:135], v16 offset:13568
  v_add_f32 v31, v31, v2
  ds_read_b64_tr_b16 a[140:141], v16 offset:13120
  v_mfma_f32_32x32x16_bf16 v[128:143], a[240:243], v[80:83], v[128:143]
  v_cvt_pk_bf16_f32 v236, v2, v3
  v_exp_f32 v5, v171
  ds_read_b64_tr_b16 a[142:143], v16 offset:13632
  v_mfma_f32_32x32x16_bf16 v[112:127], a[244:247], v[76:79], v[112:127]
  v_add_f32 v31, v31, v3
  v_exp_f32 v6, v172
  ds_read_b64_tr_b16 a[148:149], v16 offset:13184
  v_add_f32 v31, v31, v4
  buffer_load_dwordx4 v23, s[12:15], s34 offen offset:2176 lds
  s_add_u32 s43, s43, 1
  s_and_b32 s43, s43, s51
  v_mfma_f32_32x32x16_bf16 v[128:143], a[244:247], v[84:87], v[128:143]
  v_cvt_pk_bf16_f32 v237, v4, v5
  v_exp_f32 v7, v173
  ds_read_b64_tr_b16 a[150:151], v16 offset:13696
  v_add_f32 v31, v31, v5
  ds_read_b64_tr_b16 a[156:157], v16 offset:13248
  s_waitcnt lgkmcnt(5)
  v_mfma_f32_32x32x16_bf16 v[112:127], a[248:251], v[88:91], v[112:127]
  v_exp_f32 v8, v174
  v_add_f32 v31, v31, v6
  ds_read_b64_tr_b16 a[158:159], v16 offset:13760
  v_mfma_f32_32x32x16_bf16 v[128:143], a[248:251], v[96:99], v[128:143]
  v_cvt_pk_bf16_f32 v238, v6, v7
  v_exp_f32 v9, v175
  v_add_u32 v16, s40, v16
  buffer_load_dwordx4 v24, s[16:19], s34 offen offset:3264 lds
  s_add_u32 s42, s42, s49
  s_cmp_eq_u32 s42, 136192
  s_cmov_b32 s42, 0
  v_mfma_f32_32x32x16_bf16 v[112:127], a[252:255], v[92:95], v[112:127]
  v_add_f32 v31, v31, v7
  v_add_f32 v31, v31, v8
  v_cvt_pk_bf16_f32 v239, v8, v9
  v_add_f32 v31, v31, v9
  v_mfma_f32_32x32x16_bf16 v[128:143], a[252:255], v[100:103], v[128:143]
  v_add_f32 v37, v30, v31
  v_cmp_nle_f32 vcc, v37, s48
  s_nop 0
  s_cbranch_vccnz L_fb_b1
L_ret_b1:
  v_add_f32 v10, v10, v30
  v_add_f32 v11, v11, v31
  v_mfma_f32_32x32x16_bf16 a[0:15], a[128:131], v[224:227], a[0:15]
  ds_read_b128 a[224:227], v15 offset:512
  v_mfma_f32_32x32x16_bf16 a[16:31], a[128:131], v[232:235], a[16:31]
  ds_read_b128 a[228:231], v15 offset:544
  v_mfma_f32_32x32x16_bf16 a[32:47], a[136:139], v[224:227], a[32:47]
  v_exp_f32 v2, v112
  v_exp_f32 v3, v113
  v_exp_f32 v4, v114
  v_mfma_f32_32x32x16_bf16 a[48:63], a[136:139], v[232:235], a[48:63]
  v_add_f32 v30, v2, v3
  v_cvt_pk_bf16_f32 v208, v2, v3
  ds_read_b128 a[232:235], v15 offset:576
  v_mfma_f32_32x32x16_bf16 a[64:79], a[144:147], v[224:227], a[64:79]
  v_exp_f32 v5, v115
  v_exp_f32 v6, v116
  v_add_f32 v30, v30, v4
  v_mfma_f32_32x32x16_bf16 a[80:95], a[144:147], v[232:235], a[80:95]
  v_cvt_pk_bf16_f32 v209, v4, v5
  v_exp_f32 v7, v117
  v_add_f32 v30, v30, v5
  s_add_u32 s31, s68, s41
  s_add_u32 s31, s31, 1
  s_and_b32 s31, s31, 3
  s_lshl_b32 s31, s31, 13
  s_cmp_ge_u32 s41, 3
  s_cmov_b32 s31, 0x40000000
  ds_read_b128 a[236:239], v15 offset:608
  v_mfma_f32_32x32x16_bf16 a[96:111], a[152:155], v[224:227], a[96:111]
  v_exp_f32 v8, v118
  v_add_f32 v30, v30, v6
  v_cvt_pk_bf16_f32 v210, v6, v7
  ds_read_b128 a[240:243], v15 offset:640
  v_mfma_f32_32x32x16_bf16 a[112:127], a[152:155], v[232:235], a[112:127]
  v_exp_f32 v9, v119
  v_add_f32 v30, v30, v7
  v_exp_f32 v2, v120
  v_mfma_f32_32x32x16_bf16 a[0:15], a[132:135], v[228:231], a[0:15]
  v_add_f32 v30, v30, v8
  v_cvt_pk_bf16_f32 v211, v8, v9
  ds_read_b128 a[244:247], v15 offset:672
  buffer_store_dwordx4 v[252:255], v25, s[24:27], s31 offen sc1
  v_mfma_f32_32x32x16_bf16 a[16:31], a[132:135], v[236:239], a[16:31]
  v_exp_f32 v3, v121
  v_add_f32 v30, v30, v9
  v_exp_f32 v4, v122
  ds_read_b128 a[248:251], v15 offset:704
  s_waitcnt lgkmcnt(3)
  v_mfma_f32_32x32x16_bf16 a[32:47], a[140:143], v[228:231], a[32:47]
  v_add_f32 v30, v30, v2
  v_cvt_pk_bf16_f32 v212, v2, v3
  v_exp_f32 v5, v123
  ds_read_b128 a[252:255], v15 offset:736
  v_mfma_f32_32x32x16_bf16 a[48:63], a[140:143], v[236:239], a[48:63]
  v_add_f32 v30, v30, v3
  v_exp_f32 v6, v124
  v_add_f32 v30, v30, v4
  v_mfma_f32_32x32x16_bf16 a[64:79], a[148:151], v[228:231], a[64:79]
  v_cvt_pk_bf16_f32 v213, v4, v5
  v_exp_f32 v7, v125
  v_add_f32 v30, v30, v5
  v_mfma_f32_32x32x16_bf16 a[80:95], a[148:151], v[236:239], a[80:95]
  v_exp_f32 v8, v126
  v_add_f32 v30, v30, v6
  buffer_store_dwordx4 v[252:255], v25, s[24:27], s31 offen offset:1024 sc1
  v_mfma_f32_32x32x16_bf16 a[96:111], a[156:159], v[228:231], a[96:111]
  v_cvt_pk_bf16_f32 v214, v6, v7
  v_exp_f32 v9, v127
  v_add_f32 v30, v30, v7
  v_add_f32 v30, v30, v8
  v_mfma_f32_32x32x16_bf16 a[112:127], a[156:159], v[236:239], a[112:127]
  v_cvt_pk_bf16_f32 v215, v8, v9
  v_add_f32 v30, v30, v9
  v_mfma_f32_32x32x16_bf16 v[144:159], a[224:227], v[40:43], v[176:191]
  v_exp_f32 v2, v128
  v_exp_f32 v3, v129
  ds_read_b64_tr_b16 a[128:129], v16 offset:0
  v_mfma_f32_32x32x16_bf16 v[160:175], a[224:227], v[48:51], v[192:207]
  v_exp_f32 v4, v130
  v_add_f32 v31, v2, v3
  ds_read_b64_tr_b16 a[130:131], v16 offset:512
  v_cvt_pk_bf16_f32 v216, v2, v3
  ds_read_b64_tr_b16 a[136:137], v16 offset:64
  v_mfma_f32_32x32x16_bf16 v[144:159], a[228:231], v[44:47], v[144:159]
  v_exp_f32 v5, v131
  v_exp_f32 v6, v132
  v_add_f32 v31, v31, v4
  ds_read_b64_tr_b16 a[138:139], v16 offset:576
  v_mfma_f32_32x32x16_bf16 v[160:175], a[228:231], v[52:55], v[160:175]
  v_cvt_pk_bf16_f32 v217, v4, v5
  v_exp_f32 v7, v133
  ds_read_b64_tr_b16 a[144:145], v16 offset:128
  v_add_f32 v31, v31, v5
  v_mfma_f32_32x32x16_bf16 v[144:159], a[232:235], v[56:59], v[144:159]
  v_exp_f32 v8, v134
  v_add_f32 v31, v31, v6
  ds_read_b64_tr_b16 a[146:147], v16 offset:640
  v_mfma_f32_32x32x16_bf16 v[160:175], a[232:235], v[64:67], v[160:175]
  v_cvt_pk_bf16_f32 v218, v6, v7
  v_exp_f32 v9, v135
  ds_read_b64_tr_b16 a[152:153], v16 offset:192
  v_add_f32 v31, v31, v7
  v_mfma_f32_32x32x16_bf16 v[144:159], a[236:239], v[60:63], v[144:159]
  v_exp_f32 v2, v136
  ds_read_b64_tr_b16 a[154:155], v16 offset:704
  v_add_f32 v31, v31, v8
  v_mfma_f32_32x32x16_bf16 v[160:175], a[236:239], v[68:71], v[160:175]
  v_cvt_pk_bf16_f32 v219, v8, v9
  v_exp_f32 v3, v137
  ds_read_b64_tr_b16 a[132:133], v16 offset:4352
  v_add_f32 v31, v31, v9
  ds_read_b64_tr_b16 a[134:135], v16 offset:4864
  s_waitcnt lgkmcnt(5)
  v_mfma_f32_32x32x16_bf16 v[144:159], a[240:243], v[72:75], v[144:159]
  v_exp_f32 v4, v138
  v_add_f32 v31, v31, v2
  ds_read_b64_tr_b16 a[140:141], v16 offset:4416
  v_cvt_pk_bf16_f32 v220, v2, v3
  v_mfma_f32_32x32x16_bf16 v[160:175], a[240:243], v[80:83], v[160:175]
  v_exp_f32 v5, v139
  v_add_f32 v31, v31, v3
  ds_read_b64_tr_b16 a[142:143], v16 offset:4928
  v_mfma_f32_32x32x16_bf16 v[144:159], a[244:247], v[76:79], v[144:159]
  v_exp_f32 v6, v140
  v_add_f32 v31, v31, v4
  ds_read_b64_tr_b16 a[148:149], v16 offset:4480
  v_cvt_pk_bf16_f32 v221, v4, v5
  v_mfma_f32_32x32x16_bf16 v[160:175], a[244:247], v[84:87], v[160:175]
  v_exp_f32 v7, v141
  v_add_f32 v31, v31, v5
  ds_read_b64_tr_b16 a[150:151], v16 offset:4992
  v_mfma_f32_32x32x16_bf16 v[144:159], a[248:251], v[88:91], v[144:159]
  v_exp_f32 v8, v142
  v_add_f32 v31, v31, v6
  ds_read_b64_tr_b16 a[156:157], v16 offset:4544
  v_cvt_pk_bf16_f32 v222, v6, v7
  v_mfma_f32_32x32x16_bf16 v[160:175], a[248:251], v[96:99], v[160:175]
  v_exp_f32 v9, v143
  ds_read_b64_tr_b16 a[158:159], v16 offset:5056
  v_add_f32 v31, v31, v7
  v_mfma_f32_32x32x16_bf16 v[144:159], a[252:255], v[92:95], v[144:159]
  v_add_f32 v31, v31, v8
  v_cvt_pk_bf16_f32 v223, v8, v9
  v_add_f32 v31, v31, v9
  v_mfma_f32_32x32x16_bf16 v[160:175], a[252:255], v[100:103], v[160:175]
  v_add_f32 v37, v30, v31
  v_cmp_nle_f32 vcc, v37, s48
  s_nop 0
  s_cbranch_vccnz L_fb_b0
L_ret_b0:
  v_add_f32 v10, v10, v30
  v_add_f32 v11, v11, v31
  s_add_u32 s41, s41, 1
  s_cmp_lt_u32 s41, 5
  s_cbranch_scc1 L_att
  v_mfma_f32_32x32x16_bf16 a[0:15], a[128:131], v[208:211], a[0:15]
  v_add_u32 v15, s49, v15
  s_waitcnt vmcnt(12)
  s_barrier
  v_mfma_f32_32x32x16_bf16 a[16:31], a[128:131], v[216:219], a[16:31]
  ds_read_b128 a[224:227], v15 offset:0
  v_mfma_f32_32x32x16_bf16 a[32:47], a[136:139], v[208:211], a[32:47]
  v_exp_f32 v2, v144
  v_exp_f32 v3, v145
  v_exp_f32 v4, v146
  v_mfma_f32_32x32x16_bf16 a[48:63], a[136:139], v[216:219], a[48:63]
  v_add_f32 v30, v2, v3
  v_cvt_pk_bf16_f32 v224, v2, v3
  ds_read_b128 a[228:231], v15 offset:32
  v_exp_f32 v5, v147
  s_waitcnt lgkmcnt(2)
  v_mfma_f32_32x32x16_bf16 a[64:79], a[144:147], v[208:211], a[64:79]
  v_exp_f32 v6, v148
  v_add_f32 v30, v30, v4
  v_mfma_f32_32x32x16_bf16 a[80:95], a[144:147], v[216:219], a[80:95]
  v_cvt_pk_bf16_f32 v225, v4, v5
  v_exp_f32 v7, v149
  ds_read_b128 a[232:235], v15 offset:64
  s_mul_i32 s45, s68, 22
  s_mov_b32 s46, 22
  s_cmp_eq_u32 s68, 3
  s_cmov_b32 s45, 65
  s_cmp_ge_u32 s68, 2
  s_cmov_b32 s46, 21
  s_lshl_b32 s33, s45, 14
  s_add_u32 s47, s45, s46
  s_lshl_b32 s47, s47, 14
  s_sub_u32 s8, s72, 256
  s_subb_u32 s9, s73, 0
  s_add_u32 s10, s47, 256
  s_mul_i32 s47, s70, 86
  s_add_u32 s47, s47, s45
  s_lshl_b32 s47, s47, 10
  s_add_u32 s47, s47, 20971520
  s_add_u32 s4, s78, s47
  s_addc_u32 s5, s79, 0
  s_lshl_b32 s6, s46, 10
  s_mov_b32 s32, 0
  s_mul_i32 s34, s28, 4352
  s_lshl_b32 s45, s30, 14
  buffer_load_dword v250, v12, s[80:83], s45 offen sc1
  v_add_f32 v30, v30, v5
  v_mfma_f32_32x32x16_bf16 a[96:111], a[152:155], v[208:211], a[96:111]
  v_exp_f32 v8, v150
  v_add_f32 v30, v30, v6
  ds_read_b128 a[236:239], v15 offset:96
  v_cvt_pk_bf16_f32 v226, v6, v7
  v_mfma_f32_32x32x16_bf16 a[112:127], a[152:155], v[216:219], a[112:127]
  v_exp_f32 v9, v151
  v_add_f32 v30, v30, v7
  s_add_u32 m0, s34, 0
  s_nop 0
  buffer_load_dwordx4 v240, s[8:11], s33 offen lds
  v_mfma_f32_32x32x16_bf16 a[0:15], a[132:135], v[212:215], a[0:15]
  v_exp_f32 v2, v152
  v_add_f32 v30, v30, v8
  v_cvt_pk_bf16_f32 v227, v8, v9
  ds_read_b128 a[240:243], v15 offset:128
  v_mfma_f32_32x32x16_bf16 a[16:31], a[132:135], v[220:223], a[16:31]
  v_exp_f32 v3, v153
  v_add_f32 v30, v30, v9
  v_exp_f32 v4, v154
  ds_read_b128 a[244:247], v15 offset:160
  v_mfma_f32_32x32x16_bf16 a[32:47], a[140:143], v[212:215], a[32:47]
  v_add_f32 v30, v30, v2
  v_cvt_pk_bf16_f32 v228, v2, v3
  buffer_load_dwordx4 v241, s[8:11], s33 offen offset:1088 lds
  v_exp_f32 v5, v155
  v_mfma_f32_32x32x16_bf16 a[48:63], a[140:143], v[220:223], a[48:63]
  v_add_f32 v30, v30, v3
  v_exp_f32 v6, v156
  ds_read_b128 a[248:251], v15 offset:192
  v_add_f32 v30, v30, v4
  v_mfma_f32_32x32x16_bf16 a[64:79], a[148:151], v[212:215], a[64:79]
  v_cvt_pk_bf16_f32 v229, v4, v5
  v_exp_f32 v7, v157
  buffer_load_dwordx4 v242, s[8:11], s33 offen offset:2176 lds
  ds_read_b128 a[252:255], v15 offset:224
  v_mfma_f32_32x32x16_bf16 a[80:95], a[148:151], v[220:223], a[80:95]
  v_add_f32 v30, v30, v5
  v_exp_f32 v8, v158
  v_add_f32 v30, v30, v6
  v_mfma_f32_32x32x16_bf16 a[96:111], a[156:159], v[212:215], a[96:111]
  v_cvt_pk_bf16_f32 v230, v6, v7
  v_exp_f32 v9, v159
  v_add_f32 v30, v30, v7
  buffer_load_dwordx4 v243, s[8:11], s33 offen offset:3264 lds
  s_add_u32 s33, s33, 65536
  v_mfma_f32_32x32x16_bf16 a[112:127], a[156:159], v[220:223], a[112:127]
  v_add_f32 v30, v30, v8
  v_cvt_pk_bf16_f32 v231, v8, v9
  v_add_f32 v30, v30, v9
  s_waitcnt lgkmcnt(1)
  v_mfma_f32_32x32x16_bf16 v[112:127], a[224:227], v[40:43], v[176:191]
  v_exp_f32 v2, v160
  v_exp_f32 v3, v161
  ds_read_b64_tr_b16 a[128:129], v16 offset:8704
  v_mfma_f32_32x32x16_bf16 v[128:143], a[224:227], v[48:51], v[192:207]
  v_exp_f32 v4, v162
  v_add_f32 v31, v2, v3
  ds_read_b64_tr_b16 a[130:131], v16 offset:9216
  v_cvt_pk_bf16_f32 v232, v2, v3
  ds_read_b64_tr_b16 a[136:137], v16 offset:8768
  v_mfma_f32_32x32x16_bf16 v[112:127], a[228:231], v[44:47], v[112:127]
  v_exp_f32 v5, v163
  v_exp_f32 v6, v164
  v_add_f32 v31, v31, v4
  ds_read_b64_tr_b16 a[138:139], v16 offset:9280
  v_mfma_f32_32x32x16_bf16 v[128:143], a[228:231], v[52:55], v[128:143]
  v_cvt_pk_bf16_f32 v233, v4, v5
  v_exp_f32 v7, v165
  ds_read_b64_tr_b16 a[144:145], v16 offset:8832
  v_mfma_f32_32x32x16_bf16 v[112:127], a[232:235], v[56:59], v[112:127]
  v_add_f32 v31, v31, v5
  v_exp_f32 v8, v166
  ds_read_b64_tr_b16 a[146:147], v16 offset:9344
  s_add_u32 m0, s34, 17408
  s_nop 0
  buffer_load_dwordx4 v240, s[8:11], s33 offen lds
  v_mfma_f32_32x32x16_bf16 v[128:143], a[232:235], v[64:67], v[128:143]
  v_add_f32 v31, v31, v6
  v_cvt_pk_bf16_f32 v234, v6, v7
  v_exp_f32 v9, v167
  ds_read_b64_tr_b16 a[152:153], v16 offset:8896
  v_add_f32 v31, v31, v7
  v_mfma_f32_32x32x16_bf16 v[112:127], a[236:239], v[60:63], v[112:127]
  v_exp_f32 v2, v168
  ds_read_b64_tr_b16 a[154:155], v16 offset:9408
  v_add_f32 v31, v31, v8
  v_mfma_f32_32x32x16_bf16 v[128:143], a[236:239], v[68:71], v[128:143]
  v_cvt_pk_bf16_f32 v235, v8, v9
  ds_read_b64_tr_b16 a[132:133], v16 offset:13056
  v_exp_f32 v3, v169
  buffer_load_dwordx4 v241, s[8:11], s33 offen offset:1088 lds
  v_mfma_f32_32x32x16_bf16 v[112:127], a[240:243], v[72:75], v[112:127]
  v_add_f32 v31, v31, v9
  v_exp_f32 v4, v170
  ds_read_b64_tr_b16 a[134:135], v16 offset:13568
  v_add_f32 v31, v31, v2
  ds_read_b64_tr_b16 a[140:141], v16 offset:13120
  v_mfma_f32_32x32x16_bf16 v[128:143], a[240:243], v[80:83], v[128:143]
  v_cvt_pk_bf16_f32 v236, v2, v3
  v_exp_f32 v5, v171
  ds_read_b64_tr_b16 a[142:143], v16 offset:13632
  v_mfma_f32_32x32x16_bf16 v[112:127], a[244:247], v[76:79], v[112:127]
  v_add_f32 v31, v31, v3
  v_exp_f32 v6, v172
  ds_read_b64_tr_b16 a[148:149], v16 offset:13184
  v_add_f32 v31, v31, v4
  buffer_load_dwordx4 v242, s[8:11], s33 offen offset:2176 lds
  v_mfma_f32_32x32x16_bf16 v[128:143], a[244:247], v[84:87], v[128:143]
  v_cvt_pk_bf16_f32 v237, v4, v5
  v_exp_f32 v7, v173
  ds_read_b64_tr_b16 a[150:151], v16 offset:13696
  v_add_f32 v31, v31, v5
  ds_read_b64_tr_b16 a[156:157], v16 offset:13248
  v_mfma_f32_32x32x16_bf16 v[112:127], a[248:251], v[88:91], v[112:127]
  v_exp_f32 v8, v174
  v_add_f32 v31, v31, v6
  ds_read_b64_tr_b16 a[158:159], v16 offset:13760
  v_mfma_f32_32x32x16_bf16 v[128:143], a[248:251], v[96:99], v[128:143]
  v_cvt_pk_bf16_f32 v238, v6, v7
  v_exp_f32 v9, v175
  v_add_u32 v16, s49, v16
  buffer_load_dwordx4 v243, s[8:11], s33 offen offset:3264 lds
  s_add_u32 s33, s33, 65536
  s_waitcnt lgkmcnt(4)
  v_mfma_f32_32x32x16_bf16 v[112:127], a[252:255], v[92:95], v[112:127]
  v_add_f32 v31, v31, v7
  v_add_f32 v31, v31, v8
  v_cvt_pk_bf16_f32 v239, v8, v9
  v_add_f32 v31, v31, v9
  v_mfma_f32_32x32x16_bf16 v[128:143], a[252:255], v[100:103], v[128:143]
  v_add_f32 v37, v30, v31
  v_cmp_nle_f32 vcc, v37, s48
  s_nop 0
  s_cbranch_vccnz L_fb_c1
L_ret_c1:
  v_add_f32 v10, v10, v30
  v_add_f32 v11, v11, v31
  v_mfma_f32_32x32x16_bf16 a[0:15], a[128:131], v[224:227], a[0:15]
  ds_read_b128 a[224:227], v15 offset:512
  v_mfma_f32_32x32x16_bf16 a[16:31], a[128:131], v[232:235], a[16:31]
  s_waitcnt vmcnt(8)
  v_cmp_ne_u32 vcc, 1, v250
  ds_read_b128 a[228:231], v15 offset:544
  v_mfma_f32_32x32x16_bf16 a[32:47], a[136:139], v[224:227], a[32:47]
  v_exp_f32 v2, v112
  v_exp_f32 v3, v113
  v_exp_f32 v4, v114
  v_mfma_f32_32x32x16_bf16 a[48:63], a[136:139], v[232:235], a[48:63]
  v_add_f32 v30, v2, v3
  v_cvt_pk_bf16_f32 v208, v2, v3
  ds_read_b128 a[232:235], v15 offset:576
  v_exp_f32 v5, v115
  v_mfma_f32_32x32x16_bf16 a[64:79], a[144:147], v[224:227], a[64:79]
  v_exp_f32 v6, v116
  v_add_f32 v30, v30, v4
  s_nop 0
  s_cbranch_vccnz L_hspin
L_hspin_ret:
  v_cvt_pk_bf16_f32 v209, v4, v5
  v_mfma_f32_32x32x16_bf16 a[80:95], a[144:147], v[232:235], a[80:95]
  v_exp_f32 v7, v117
  v_add_f32 v30, v30, v5
  ds_read_b128 a[236:239], v15 offset:608
  v_mfma_f32_32x32x16_bf16 a[96:111], a[152:155], v[224:227], a[96:111]
  v_exp_f32 v8, v118
  v_add_f32 v30, v30, v6
  v_cvt_pk_bf16_f32 v210, v6, v7
  ds_read_b128 a[240:243], v15 offset:640
  v_mfma_f32_32x32x16_bf16 a[112:127], a[152:155], v[232:235], a[112:127]
  v_exp_f32 v9, v119
  v_add_f32 v30, v30, v7
  buffer_load_dwordx4 a[160:163], v25, s[4:7], s32 offen offset:0 sc1
  v_mfma_f32_32x32x16_bf16 a[0:15], a[132:135], v[228:231], a[0:15]
  v_exp_f32 v2, v120
  v_add_f32 v30, v30, v8
  v_cvt_pk_bf16_f32 v211, v8, v9
  ds_read_b128 a[244:247], v15 offset:672
  v_mfma_f32_32x32x16_bf16 a[16:31], a[132:135], v[236:239], a[16:31]
  v_exp_f32 v3, v121
  v_add_f32 v30, v30, v9
  v_exp_f32 v4, v122
  v_mfma_f32_32x32x16_bf16 a[32:47], a[140:143], v[228:231], a[32:47]
  v_add_f32 v30, v30, v2
  v_cvt_pk_bf16_f32 v212, v2, v3
  ds_read_b128 a[248:251], v15 offset:704
  buffer_load_dwordx4 a[164:167], v25, s[4:7], s32 offen offset:1024 sc1
  v_exp_f32 v5, v123
  v_mfma_f32_32x32x16_bf16 a[48:63], a[140:143], v[236:239], a[48:63]
  v_add_f32 v30, v30, v3
  v_exp_f32 v6, v124
  ds_read_b128 a[252:255], v15 offset:736
  v_add_f32 v30, v30, v4
  s_waitcnt lgkmcnt(3)
  v_mfma_f32_32x32x16_bf16 a[64:79], a[148:151], v[228:231], a[64:79]
  v_cvt_pk_bf16_f32 v213, v4, v5
  v_exp_f32 v7, v125
  buffer_load_dwordx4 a[168:171], v25, s[4:7], s32 offen offset:2048 sc1
  v_mfma_f32_32x32x16_bf16 a[80:95], a[148:151], v[236:239], a[80:95]
  v_add_f32 v30, v30, v5
  v_exp_f32 v8, v126
  v_add_f32 v30, v30, v6
  v_mfma_f32_32x32x16_bf16 a[96:111], a[156:159], v[228:231], a[96:111]
  v_cvt_pk_bf16_f32 v214, v6, v7
  v_exp_f32 v9, v127
  v_add_f32 v30, v30, v7
  buffer_load_dwordx4 a[172:175], v25, s[4:7], s32 offen offset:3072 sc1
  s_add_u32 s32, s32, 4096
  v_mfma_f32_32x32x16_bf16 a[112:127], a[156:159], v[236:239], a[112:127]
  v_add_f32 v30, v30, v8
  v_cvt_pk_bf16_f32 v215, v8, v9
  v_add_f32 v30, v30, v9
  v_mfma_f32_32x32x16_bf16 v[144:159], a[224:227], v[40:43], v[176:191]
  v_exp_f32 v2, v128
  v_exp_f32 v3, v129
  ds_read_b64_tr_b16 a[128:129], v16 offset:0
  v_mfma_f32_32x32x16_bf16 v[160:175], a[224:227], v[48:51], v[192:207]
  v_exp_f32 v4, v130
  v_add_f32 v31, v2, v3
  ds_read_b64_tr_b16 a[130:131], v16 offset:512
  v_cvt_pk_bf16_f32 v216, v2, v3
  ds_read_b64_tr_b16 a[136:137], v16 offset:64
  v_mfma_f32_32x32x16_bf16 v[144:159], a[228:231], v[44:47], v[144:159]
  v_exp_f32 v5, v131
  v_exp_f32 v6, v132
  v_add_f32 v31, v31, v4
  ds_read_b64_tr_b16 a[138:139], v16 offset:576
  v_mfma_f32_32x32x16_bf16 v[160:175], a[228:231], v[52:55], v[160:175]
  v_cvt_pk_bf16_f32 v217, v4, v5
  v_exp_f32 v7, v133
  buffer_load_dwordx4 a[176:179], v25, s[4:7], s32 offen offset:0 sc1
  v_mfma_f32_32x32x16_bf16 v[144:159], a[232:235], v[56:59], v[144:159]
  v_add_f32 v31, v31, v5
  v_exp_f32 v8, v134
  ds_read_b64_tr_b16 a[144:145], v16 offset:128
  v_add_f32 v31, v31, v6
  ds_read_b64_tr_b16 a[146:147], v16 offset:640
  v_mfma_f32_32x32x16_bf16 v[160:175], a[232:235], v[64:67], v[160:175]
  v_cvt_pk_bf16_f32 v218, v6, v7
  v_exp_f32 v9, v135
  ds_read_b64_tr_b16 a[152:153], v16 offset:192
  v_add_f32 v31, v31, v7
  v_mfma_f32_32x32x16_bf16 v[144:159], a[236:239], v[60:63], v[144:159]
  v_exp_f32 v2, v136
  ds_read_b64_tr_b16 a[154:155], v16 offset:704
  v_add_f32 v31, v31, v8
  v_mfma_f32_32x32x16_bf16 v[160:175], a[236:239], v[68:71], v[160:175]
  v_cvt_pk_bf16_f32 v219, v8, v9
  v_exp_f32 v3, v137
  ds_read_b64_tr_b16 a[132:133], v16 offset:4352
  buffer_load_dwordx4 a[180:183], v25, s[4:7], s32 offen offset:1024 sc1
  v_mfma_f32_32x32x16_bf16 v[144:159], a[240:243], v[72:75], v[144:159]
  v_add_f32 v31, v31, v9
  v_exp_f32 v4, v138
  ds_read_b64_tr_b16 a[134:135], v16 offset:4864
  v_add_f32 v31, v31, v2
  v_mfma_f32_32x32x16_bf16 v[160:175], a[240:243], v[80:83], v[160:175]
  v_cvt_pk_bf16_f32 v220, v2, v3
  v_exp_f32 v5, v139
  ds_read_b64_tr_b16 a[140:141], v16 offset:4416
  s_waitcnt lgkmcnt(4)
  v_mfma_f32_32x32x16_bf16 v[144:159], a[244:247], v[76:79], v[144:159]
  v_add_f32 v31, v31, v3
  v_exp_f32 v6, v140
  ds_read_b64_tr_b16 a[142:143], v16 offset:4928
  v_add_f32 v31, v31, v4
  buffer_load_dwordx4 a[184:187], v25, s[4:7], s32 offen offset:2048 sc1
  v_mfma_f32_32x32x16_bf16 v[160:175], a[244:247], v[84:87], v[160:175]
  v_cvt_pk_bf16_f32 v221, v4, v5
  v_exp_f32 v7, v141
  ds_read_b64_tr_b16 a[148:149], v16 offset:4480
  v_add_f32 v31, v31, v5
  ds_read_b64_tr_b16 a[150:151], v16 offset:4992
  v_mfma_f32_32x32x16_bf16 v[144:159], a[248:251], v[88:91], v[144:159]
  v_exp_f32 v8, v142
  v_add_f32 v31, v31, v6
  ds_read_b64_tr_b16 a[156:157], v16 offset:4544
  v_mfma_f32_32x32x16_bf16 v[160:175], a[248:251], v[96:99], v[160:175]
  v_cvt_pk_bf16_f32 v222, v6, v7
  v_exp_f32 v9, v143
  ds_read_b64_tr_b16 a[158:159], v16 offset:5056
  buffer_load_dwordx4 a[188:191], v25, s[4:7], s32 offen offset:3072 sc1
  s_add_u32 s32, s32, 4096
  v_mfma_f32_32x32x16_bf16 v[144:159], a[252:255], v[92:95], v[144:159]
  v_add_f32 v31, v31, v7
  v_add_f32 v31, v31, v8
  v_cvt_pk_bf16_f32 v223, v8, v9
  v_add_f32 v31, v31, v9
  v_mfma_f32_32x32x16_bf16 v[160:175], a[252:255], v[100:103], v[160:175]
  v_add_f32 v37, v30, v31
  v_cmp_nle_f32 vcc, v37, s48
  s_nop 0
  s_cbranch_vccnz L_fb_c0
L_ret_c0:
  v_add_f32 v10, v10, v30
  v_add_f32 v11, v11, v31
  v_mfma_f32_32x32x16_bf16 a[0:15], a[128:131], v[208:211], a[0:15]
  v_add_u32 v15, s49, v15
  s_waitcnt vmcnt(19)
  s_barrier
  v_mfma_f32_32x32x16_bf16 a[16:31], a[128:131], v[216:219], a[16:31]
  ds_read_b128 a[224:227], v15 offset:0
  v_mfma_f32_32x32x16_bf16 a[32:47], a[136:139], v[208:211], a[32:47]
  v_exp_f32 v2, v144
  v_exp_f32 v3, v145
  v_exp_f32 v4, v146
  v_mfma_f32_32x32x16_bf16 a[48:63], a[136:139], v[216:219], a[48:63]
  v_add_f32 v30, v2, v3
  v_cvt_pk_bf16_f32 v224, v2, v3
  ds_read_b128 a[228:231], v15 offset:32
  v_exp_f32 v5, v147
  v_mfma_f32_32x32x16_bf16 a[64:79], a[144:147], v[208:211], a[64:79]
  v_exp_f32 v6, v148
  v_add_f32 v30, v30, v4
  v_mfma_f32_32x32x16_bf16 a[80:95], a[144:147], v[216:219], a[80:95]
  v_cvt_pk_bf16_f32 v225, v4, v5
  v_exp_f32 v7, v149
  ds_read_b128 a[232:235], v15 offset:64
  v_add_f32 v30, v30, v5
  s_add_u32 m0, s34, 34816
  s_nop 0
  buffer_load_dwordx4 v240, s[8:11], s33 offen lds
  s_waitcnt lgkmcnt(2)
  v_mfma_f32_32x32x16_bf16 a[96:111], a[152:155], v[208:211], a[96:111]
  v_exp_f32 v8, v150
  v_add_f32 v30, v30, v6
  ds_read_b128 a[236:239], v15 offset:96
  v_cvt_pk_bf16_f32 v226, v6, v7
  v_mfma_f32_32x32x16_bf16 a[112:127], a[152:155], v[216:219], a[112:127]
  v_exp_f32 v9, v151
  v_add_f32 v30, v30, v7
  v_exp_f32 v2, v152
  ds_read_b128 a[240:243], v15 offset:128
  v_mfma_f32_32x32x16_bf16 a[0:15], a[132:135], v[212:215], a[0:15]
  v_add_f32 v30, v30, v8
  v_cvt_pk_bf16_f32 v227, v8, v9
  buffer_load_dwordx4 v241, s[8:11], s33 offen offset:1088 lds
  v_mfma_f32_32x32x16_bf16 a[16:31], a[132:135], v[220:223], a[16:31]
  v_exp_f32 v3, v153
  v_add_f32 v30, v30, v9
  v_exp_f32 v4, v154
  ds_read_b128 a[244:247], v15 offset:160
  v_mfma_f32_32x32x16_bf16 a[32:47], a[140:143], v[212:215], a[32:47]
  v_add_f32 v30, v30, v2
  v_cvt_pk_bf16_f32 v228, v2, v3
  v_exp_f32 v5, v155
  ds_read_b128 a[248:251], v15 offset:192
  v_mfma_f32_32x32x16_bf16 a[48:63], a[140:143], v[220:223], a[48:63]
  v_add_f32 v30, v30, v3
  v_exp_f32 v6, v156
  buffer_load_dwordx4 v242, s[8:11], s33 offen offset:2176 lds
  v_mfma_f32_32x32x16_bf16 a[64:79], a[148:151], v[212:215], a[64:79]
  v_add_f32 v30, v30, v4
  v_cvt_pk_bf16_f32 v229, v4, v5
  v_exp_f32 v7, v157
  ds_read_b128 a[252:255], v15 offset:224
  v_add_f32 v30, v30, v5
  v_mfma_f32_32x32x16_bf16 a[80:95], a[148:151], v[220:223], a[80:95]
  v_exp_f32 v8, v158
  v_add_f32 v30, v30, v6
  v_mfma_f32_32x32x16_bf16 a[96:111], a[156:159], v[212:215], a[96:111]
  v_cvt_pk_bf16_f32 v230, v6, v7
  v_exp_f32 v9, v159
  v_add_f32 v30, v30, v7
  buffer_load_dwordx4 v243, s[8:11], s33 offen offset:3264 lds
  s_add_u32 s33, s33, 65536
  v_mfma_f32_32x32x16_bf16 a[112:127], a[156:159], v[220:223], a[112:127]
  v_add_f32 v30, v30, v8
  v_cvt_pk_bf16_f32 v231, v8, v9
  v_add_f32 v30, v30, v9
  v_mfma_f32_32x32x16_bf16 v[112:127], a[224:227], v[40:43], v[176:191]
  v_exp_f32 v2, v160
  v_exp_f32 v3, v161
  ds_read_b64_tr_b16 a[128:129], v16 offset:8704
  v_mfma_f32_32x32x16_bf16 v[128:143], a[224:227], v[48:51], v[192:207]
  v_exp_f32 v4, v162
  v_add_f32 v31, v2, v3
  ds_read_b64_tr_b16 a[130:131], v16 offset:9216
  v_cvt_pk_bf16_f32 v232, v2, v3
  ds_read_b64_tr_b16 a[136:137], v16 offset:8768
  s_waitcnt lgkmcnt(3)
  v_mfma_f32_32x32x16_bf16 v[112:127], a[228:231], v[44:47], v[112:127]
  v_exp_f32 v5, v163
  v_exp_f32 v6, v164
  v_add_f32 v31, v31, v4
  ds_read_b64_tr_b16 a[138:139], v16 offset:9280
  v_mfma_f32_32x32x16_bf16 v[128:143], a[228:231], v[52:55], v[128:143]
  v_cvt_pk_bf16_f32 v233, v4, v5
  v_exp_f32 v7, v165
  ds_read_b64_tr_b16 a[144:145], v16 offset:8832
  v_mfma_f32_32x32x16_bf16 v[112:127], a[232:235], v[56:59], v[112:127]
  v_add_f32 v31, v31, v5
  v_exp_f32 v8, v166
  ds_read_b64_tr_b16 a[146:147], v16 offset:9344
  s_add_u32 m0, s34, 52224
  s_nop 0
  buffer_load_dwordx4 v240, s[8:11], s33 offen lds
  v_mfma_f32_32x32x16_bf16 v[128:143], a[232:235], v[64:67], v[128:143]
  v_add_f32 v31, v31, v6
  v_cvt_pk_bf16_f32 v234, v6, v7
  v_exp_f32 v9, v167
  ds_read_b64_tr_b16 a[152:153], v16 offset:8896
  v_add_f32 v31, v31, v7
  v_mfma_f32_32x32x16_bf16 v[112:127], a[236:239], v[60:63], v[112:127]
  v_exp_f32 v2, v168
  ds_read_b64_tr_b16 a[154:155], v16 offset:9408
  v_add_f32 v31, v31, v8
  v_mfma_f32_32x32x16_bf16 v[128:143], a[236:239], v[68:71], v[128:143]
  v_cvt_pk_bf16_f32 v235, v8, v9
  ds_read_b64_tr_b16 a[132:133], v16 offset:13056
  v_exp_f32 v3, v169
  buffer_load_dwordx4 v241, s[8:11], s33 offen offset:1088 lds
  v_mfma_f32_32x32x16_bf16 v[112:127], a[240:243], v[72:75], v[112:127]
  v_add_f32 v31, v31, v9
  v_exp_f32 v4, v170
  ds_read_b64_tr_b16 a[134:135], v16 offset:13568
  v_add_f32 v31, v31, v2
  ds_read_b64_tr_b16 a[140:141], v16 offset:13120
  v_mfma_f32_32x32x16_bf16 v[128:143], a[240:243], v[80:83], v[128:143]
  v_cvt_pk_bf16_f32 v236, v2, v3
  v_exp_f32 v5, v171
  ds_read_b64_tr_b16 a[142:143], v16 offset:13632
  v_mfma_f32_32x32x16_bf16 v[112:127], a[244:247], v[76:79], v[112:127]
  v_add_f32 v31, v31, v3
  v_exp_f32 v6, v172
  ds_read_b64_tr_b16 a[148:149], v16 offset:13184
  v_add_f32 v31, v31, v4
  buffer_load_dwordx4 v242, s[8:11], s33 offen offset:2176 lds
  v_mfma_f32_32x32x16_bf16 v[128:143], a[244:247], v[84:87], v[128:143]
  v_cvt_pk_bf16_f32 v237, v4, v5
  v_exp_f32 v7, v173
  ds_read_b64_tr_b16 a[150:151], v16 offset:13696
  v_add_f32 v31, v31, v5
  ds_read_b64_tr_b16 a[156:157], v16 offset:13248
  v_mfma_f32_32x32x16_bf16 v[112:127], a[248:251], v[88:91], v[112:127]
  v_exp_f32 v8, v174
  v_add_f32 v31, v31, v6
  ds_read_b64_tr_b16 a[158:159], v16 offset:13760
  v_mfma_f32_32x32x16_bf16 v[128:143], a[248:251], v[96:99], v[128:143]
  v_cvt_pk_bf16_f32 v238, v6, v7
  v_exp_f32 v9, v175
  v_add_u32 v16, s49, v16
  buffer_load_dwordx4 v243, s[8:11], s33 offen offset:3264 lds
  s_add_u32 s33, s33, 65536
  v_mfma_f32_32x32x16_bf16 v[112:127], a[252:255], v[92:95], v[112:127]
  v_add_f32 v31, v31, v7
  v_add_f32 v31, v31, v8
  v_cvt_pk_bf16_f32 v239, v8, v9
  v_add_f32 v31, v31, v9
  v_mfma_f32_32x32x16_bf16 v[128:143], a[252:255], v[100:103], v[128:143]
  v_add_f32 v37, v30, v31
  v_cmp_nle_f32 vcc, v37, s48
  s_nop 0
  s_cbranch_vccnz L_fb_d1
L_ret_d1:
  v_add_f32 v10, v10, v30
  v_add_f32 v11, v11, v31
  s_waitcnt lgkmcnt(0)
  v_mfma_f32_32x32x16_bf16 a[0:15], a[128:131], v[224:227], a[0:15]
  ds_read_b128 a[224:227], v15 offset:512
  v_mfma_f32_32x32x16_bf16 a[16:31], a[128:131], v[232:235], a[16:31]
  ds_read_b128 a[228:231], v15 offset:544
  buffer_load_dwordx4 a[192:195], v25, s[4:7], s32 offen offset:0 sc1
  v_mfma_f32_32x32x16_bf16 a[32:47], a[136:139], v[224:227], a[32:47]
  v_exp_f32 v2, v112
  v_exp_f32 v3, v113
  v_exp_f32 v4, v114
  v_mfma_f32_32x32x16_bf16 a[48:63], a[136:139], v[232:235], a[48:63]
  v_add_f32 v30, v2, v3
  v_cvt_pk_bf16_f32 v208, v2, v3
  ds_read_b128 a[232:235], v15 offset:576
  v_exp_f32 v5, v115
  v_mfma_f32_32x32x16_bf16 a[64:79], a[144:147], v[224:227], a[64:79]
  v_exp_f32 v6, v116
  v_add_f32 v30, v30, v4
  v_cvt_pk_bf16_f32 v209, v4, v5
  ds_read_b128 a[236:239], v15 offset:608
  v_mfma_f32_32x32x16_bf16 a[80:95], a[144:147], v[232:235], a[80:95]
  v_exp_f32 v7, v117
  v_add_f32 v30, v30, v5
  buffer_load_dwordx4 a[196:199], v25, s[4:7], s32 offen offset:1024 sc1
  v_mfma_f32_32x32x16_bf16 a[96:111], a[152:155], v[224:227], a[96:111]
  v_exp_f32 v8, v118
  v_add_f32 v30, v30, v6
  v_cvt_pk_bf16_f32 v210, v6, v7
  ds_read_b128 a[240:243], v15 offset:640
  v_mfma_f32_32x32x16_bf16 a[112:127], a[152:155], v[232:235], a[112:127]
  v_exp_f32 v9, v119
  v_add_f32 v30, v30, v7
  v_exp_f32 v2, v120
  ds_read_b128 a[244:247], v15 offset:672
  v_mfma_f32_32x32x16_bf16 a[0:15], a[132:135], v[228:231], a[0:15]
  v_add_f32 v30, v30, v8
  v_cvt_pk_bf16_f32 v211, v8, v9
  v_exp_f32 v3, v121
  v_mfma_f32_32x32x16_bf16 a[16:31], a[132:135], v[236:239], a[16:31]
  v_add_f32 v30, v30, v9
  v_exp_f32 v4, v122
  ds_read_b128 a[248:251], v15 offset:704
  v_mfma_f32_32x32x16_bf16 a[32:47], a[140:143], v[228:231], a[32:47]
  v_add_f32 v30, v30, v2
  v_cvt_pk_bf16_f32 v212, v2, v3
  v_exp_f32 v5, v123
  v_mfma_f32_32x32x16_bf16 a[48:63], a[140:143], v[236:239], a[48:63]
  v_add_f32 v30, v30, v3
  v_exp_f32 v6, v124
  buffer_load_dwordx4 a[200:203], v25, s[4:7], s32 offen offset:2048 sc1
  ds_read_b128 a[252:255], v15 offset:736
  v_mfma_f32_32x32x16_bf16 a[64:79], a[148:151], v[228:231], a[64:79]
  v_add_f32 v30, v30, v4
  v_cvt_pk_bf16_f32 v213, v4, v5
  v_exp_f32 v7, v125
  v_add_f32 v30, v30, v5
  v_mfma_f32_32x32x16_bf16 a[80:95], a[148:151], v[236:239], a[80:95]
  v_exp_f32 v8, v126
  v_add_f32 v30, v30, v6
  v_mfma_f32_32x32x16_bf16 a[96:111], a[156:159], v[228:231], a[96:111]
  v_cvt_pk_bf16_f32 v214, v6, v7
  v_exp_f32 v9, v127
  v_add_f32 v30, v30, v7
  buffer_load_dwordx4 a[204:207], v25, s[4:7], s32 offen offset:3072 sc1
  s_add_u32 s32, s32, 4096
  v_mfma_f32_32x32x16_bf16 a[112:127], a[156:159], v[236:239], a[112:127]
  v_add_f32 v30, v30, v8
  v_cvt_pk_bf16_f32 v215, v8, v9
  v_add_f32 v30, v30, v9
  s_waitcnt lgkmcnt(1)
  v_mfma_f32_32x32x16_bf16 v[144:159], a[224:227], v[40:43], v[176:191]
  v_exp_f32 v2, v128
  v_exp_f32 v3, v129
  ds_read_b64_tr_b16 a[128:129], v16 offset:0
  v_mfma_f32_32x32x16_bf16 v[160:175], a[224:227], v[48:51], v[192:207]
  v_exp_f32 v4, v130
  v_add_f32 v31, v2, v3
  ds_read_b64_tr_b16 a[130:131], v16 offset:512
  v_cvt_pk_bf16_f32 v216, v2, v3
  ds_read_b64_tr_b16 a[136:137], v16 offset:64
  v_mfma_f32_32x32x16_bf16 v[144:159], a[228:231], v[44:47], v[144:159]
  v_exp_f32 v5, v131
  v_exp_f32 v6, v132
  v_add_f32 v31, v31, v4
  ds_read_b64_tr_b16 a[138:139], v16 offset:576
  v_mfma_f32_32x32x16_bf16 v[160:175], a[228:231], v[52:55], v[160:175]
  v_cvt_pk_bf16_f32 v217, v4, v5
  v_exp_f32 v7, v133
  buffer_load_dwordx4 a[208:211], v25, s[4:7], s32 offen offset:0 sc1
  v_mfma_f32_32x32x16_bf16 v[144:159], a[232:235], v[56:59], v[144:159]
  v_add_f32 v31, v31, v5
  v_exp_f32 v8, v134
  ds_read_b64_tr_b16 a[144:145], v16 offset:128
  v_add_f32 v31, v31, v6
  ds_read_b64_tr_b16 a[146:147], v16 offset:640
  v_mfma_f32_32x32x16_bf16 v[160:175], a[232:235], v[64:67], v[160:175]
  v_cvt_pk_bf16_f32 v218, v6, v7
  v_exp_f32 v9, v135
  ds_read_b64_tr_b16 a[152:153], v16 offset:192
  v_add_f32 v31, v31, v7
  v_mfma_f32_32x32x16_bf16 v[144:159], a[236:239], v[60:63], v[144:159]
  v_exp_f32 v2, v136
  ds_read_b64_tr_b16 a[154:155], v16 offset:704
  v_add_f32 v31, v31, v8
  v_mfma_f32_32x32x16_bf16 v[160:175], a[236:239], v[68:71], v[160:175]
  v_cvt_pk_bf16_f32 v219, v8, v9
  v_exp_f32 v3, v137
  ds_read_b64_tr_b16 a[132:133], v16 offset:4352
  buffer_load_dwordx4 a[212:215], v25, s[4:7], s32 offen offset:1024 sc1
  v_mfma_f32_32x32x16_bf16 v[144:159], a[240:243], v[72:75], v[144:159]
  v_add_f32 v31, v31, v9
  v_exp_f32 v4, v138
  ds_read_b64_tr_b16 a[134:135], v16 offset:4864
  v_add_f32 v31, v31, v2
  v_mfma_f32_32x32x16_bf16 v[160:175], a[240:243], v[80:83], v[160:175]
  v_cvt_pk_bf16_f32 v220, v2, v3
  v_exp_f32 v5, v139
  ds_read_b64_tr_b16 a[140:141], v16 offset:4416
  v_mfma_f32_32x32x16_bf16 v[144:159], a[244:247], v[76:79], v[144:159]
  v_add_f32 v31, v31, v3
  v_exp_f32 v6, v140
  ds_read_b64_tr_b16 a[142:143], v16 offset:4928
  v_add_f32 v31, v31, v4
  buffer_load_dwordx4 a[216:219], v25, s[4:7], s32 offen offset:2048 sc1
  v_mfma_f32_32x32x16_bf16 v[160:175], a[244:247], v[84:87], v[160:175]
  v_cvt_pk_bf16_f32 v221, v4, v5
  v_exp_f32 v7, v141
  ds_read_b64_tr_b16 a[148:149], v16 offset:4480
  v_add_f32 v31, v31, v5
  ds_read_b64_tr_b16 a[150:151], v16 offset:4992
  v_mfma_f32_32x32x16_bf16 v[144:159], a[248:251], v[88:91], v[144:159]
  v_exp_f32 v8, v142
  v_add_f32 v31, v31, v6
  ds_read_b64_tr_b16 a[156:157], v16 offset:4544
  v_mfma_f32_32x32x16_bf16 v[160:175], a[248:251], v[96:99], v[160:175]
  v_cvt_pk_bf16_f32 v222, v6, v7
  v_exp_f32 v9, v143
  ds_read_b64_tr_b16 a[158:159], v16 offset:5056
  buffer_load_dwordx4 a[220:223], v25, s[4:7], s32 offen offset:3072 sc1
  s_add_u32 s32, s32, 4096
  s_waitcnt lgkmcnt(5)
  v_mfma_f32_32x32x16_bf16 v[144:159], a[252:255], v[92:95], v[144:159]
  v_add_f32 v31, v31, v7
  v_add_f32 v31, v31, v8
  v_cvt_pk_bf16_f32 v223, v8, v9
  v_add_f32 v31, v31, v9
  v_mfma_f32_32x32x16_bf16 v[160:175], a[252:255], v[100:103], v[160:175]
  v_add_f32 v37, v30, v31
  v_cmp_nle_f32 vcc, v37, s48
  s_nop 0
  s_cbranch_vccnz L_fb_d0
L_ret_d0:
  v_add_f32 v10, v10, v30
  v_add_f32 v11, v11, v31
  v_mfma_f32_32x32x16_bf16 a[0:15], a[128:131], v[208:211], a[0:15]
  v_mfma_f32_32x32x16_bf16 a[16:31], a[128:131], v[216:219], a[16:31]
  s_mov_b32 s12, s52
  s_mov_b32 s13, s53
  s_mov_b32 s14, 2097152
  s_mov_b32 s15, 0x00020000
  v_mfma_f32_32x32x16_bf16 a[32:47], a[136:139], v[208:211], a[32:47]
  v_exp_f32 v2, v144
  v_exp_f32 v3, v145
  v_exp_f32 v4, v146
  v_mfma_f32_32x32x16_bf16 a[48:63], a[136:139], v[216:219], a[48:63]
  v_add_f32 v30, v2, v3
  v_cvt_pk_bf16_f32 v224, v2, v3
  v_exp_f32 v5, v147
  v_mfma_f32_32x32x16_bf16 a[64:79], a[144:147], v[208:211], a[64:79]
  v_exp_f32 v6, v148
  v_add_f32 v30, v30, v4
  buffer_load_dwordx2 v[104:105], v246, s[12:15], 0 offen offset:0
  v_mfma_f32_32x32x16_bf16 a[80:95], a[144:147], v[216:219], a[80:95]
  v_cvt_pk_bf16_f32 v225, v4, v5
  v_exp_f32 v7, v149
  v_add_f32 v30, v30, v5
  v_exp_f32 v8, v150
  v_mfma_f32_32x32x16_bf16 a[96:111], a[152:155], v[208:211], a[96:111]
  v_add_f32 v30, v30, v6
  v_cvt_pk_bf16_f32 v226, v6, v7
  buffer_load_dwordx2 v[106:107], v246, s[12:15], 0 offen offset:16
  v_mfma_f32_32x32x16_bf16 a[112:127], a[152:155], v[216:219], a[112:127]
  v_exp_f32 v9, v151
  v_add_f32 v30, v30, v7
  v_exp_f32 v2, v152
  v_mfma_f32_32x32x16_bf16 a[0:15], a[132:135], v[212:215], a[0:15]
  v_add_f32 v30, v30, v8
  v_cvt_pk_bf16_f32 v227, v8, v9
  v_exp_f32 v3, v153
  v_mfma_f32_32x32x16_bf16 a[16:31], a[132:135], v[220:223], a[16:31]
  v_add_f32 v30, v30, v9
  v_exp_f32 v4, v154
  v_add_f32 v30, v30, v2
  s_waitcnt lgkmcnt(0)
  v_mfma_f32_32x32x16_bf16 a[32:47], a[140:143], v[212:215], a[32:47]
  v_cvt_pk_bf16_f32 v228, v2, v3
  v_exp_f32 v5, v155
  buffer_load_dwordx2 v[108:109], v246, s[12:15], 0 offen offset:32
  v_mfma_f32_32x32x16_bf16 a[48:63], a[140:143], v[220:223], a[48:63]
  v_add_f32 v30, v30, v3
  v_exp_f32 v6, v156
  v_add_f32 v30, v30, v4
  v_mfma_f32_32x32x16_bf16 a[64:79], a[148:151], v[212:215], a[64:79]
  v_cvt_pk_bf16_f32 v229, v4, v5
  v_exp_f32 v7, v157
  v_add_f32 v30, v30, v5
  v_mfma_f32_32x32x16_bf16 a[80:95], a[148:151], v[220:223], a[80:95]
  v_exp_f32 v8, v158
  v_add_f32 v30, v30, v6
  buffer_load_dwordx2 v[110:111], v246, s[12:15], 0 offen offset:48
  v_mfma_f32_32x32x16_bf16 a[96:111], a[156:159], v[212:215], a[96:111]
  v_cvt_pk_bf16_f32 v230, v6, v7
  v_exp_f32 v9, v159
  v_add_f32 v30, v30, v7
  v_add_f32 v30, v30, v8
  v_mfma_f32_32x32x16_bf16 a[112:127], a[156:159], v[220:223], a[112:127]
  v_cvt_pk_bf16_f32 v231, v8, v9
  v_add_f32 v30, v30, v9
  ds_read_b64_tr_b16 a[128:129], v16 offset:8704
  ds_read_b64_tr_b16 a[130:131], v16 offset:9216
  ds_read_b64_tr_b16 a[136:137], v16 offset:8768
  ds_read_b64_tr_b16 a[138:139], v16 offset:9280
  ds_read_b64_tr_b16 a[144:145], v16 offset:8832
  ds_read_b64_tr_b16 a[146:147], v16 offset:9344
  ds_read_b64_tr_b16 a[152:153], v16 offset:8896
  ds_read_b64_tr_b16 a[154:155], v16 offset:9408
  ds_read_b64_tr_b16 a[132:133], v16 offset:13056
  ds_read_b64_tr_b16 a[134:135], v16 offset:13568
  ds_read_b64_tr_b16 a[140:141], v16 offset:13120
  ds_read_b64_tr_b16 a[142:143], v16 offset:13632
  ds_read_b64_tr_b16 a[148:149], v16 offset:13184
  ds_read_b64_tr_b16 a[150:151], v16 offset:13696
  ds_read_b64_tr_b16 a[156:157], v16 offset:13248
  ds_read_b64_tr_b16 a[158:159], v16 offset:13760
  v_exp_f32 v2, v160
  v_exp_f32 v3, v161
  v_exp_f32 v4, v162
  v_add_f32 v31, v2, v3
  v_cvt_pk_bf16_f32 v232, v2, v3
  v_exp_f32 v5, v163
  v_exp_f32 v6, v164
  v_add_f32 v31, v31, v4
  v_cvt_pk_bf16_f32 v233, v4, v5
  v_exp_f32 v7, v165
  v_add_f32 v31, v31, v5
  v_exp_f32 v8, v166
  v_add_f32 v31, v31, v6
  v_cvt_pk_bf16_f32 v234, v6, v7
  v_exp_f32 v9, v167
  v_add_f32 v31, v31, v7
  v_exp_f32 v2, v168
  v_add_f32 v31, v31, v8
  v_cvt_pk_bf16_f32 v235, v8, v9
  v_exp_f32 v3, v169
  v_add_f32 v31, v31, v9
  v_exp_f32 v4, v170
  v_add_f32 v31, v31, v2
  v_cvt_pk_bf16_f32 v236, v2, v3
  v_exp_f32 v5, v171
  v_add_f32 v31, v31, v3
  v_exp_f32 v6, v172
  v_add_f32 v31, v31, v4
  v_cvt_pk_bf16_f32 v237, v4, v5
  v_exp_f32 v7, v173
  v_add_f32 v31, v31, v5
  v_exp_f32 v8, v174
  v_add_f32 v31, v31, v6
  v_cvt_pk_bf16_f32 v238, v6, v7
  v_exp_f32 v9, v175
  v_add_f32 v31, v31, v7
  v_add_f32 v31, v31, v8
  v_cvt_pk_bf16_f32 v239, v8, v9
  v_add_f32 v31, v31, v9
  v_add_f32 v37, v30, v31
  v_cmp_nle_f32 vcc, v37, s48
  s_nop 0
  s_cbranch_vccnz L_fb_t1
L_ret_t1:
  v_add_f32 v10, v10, v30
  v_add_f32 v11, v11, v31
  s_waitcnt lgkmcnt(0)
  v_mfma_f32_32x32x16_bf16 a[0:15], a[128:131], v[224:227], a[0:15]
  v_mov_b32 v2, v10
  v_mov_b32 v3, v11
  s_nop 0
  v_permlane32_swap_b32 v2, v10
  v_mfma_f32_32x32x16_bf16 a[16:31], a[128:131], v[232:235], a[16:31]
  v_permlane32_swap_b32 v3, v11
  s_nop 0
  v_add_f32 v10, v10, v2
  v_mfma_f32_32x32x16_bf16 a[0:15], a[132:135], v[228:231], a[0:15]
  v_add_f32 v11, v11, v3
  v_rcp_f32 v10, v10
  v_rcp_f32 v11, v11
  v_mfma_f32_32x32x16_bf16 a[16:31], a[132:135], v[236:239], a[16:31]
  s_lshl_b32 s44, s30, 3
  s_lshl_b32 s45, s28, 1
  s_add_u32 s44, s44, s45
  v_mfma_f32_32x32x16_bf16 a[32:47], a[136:139], v[224:227], a[32:47]
  s_lshl_b32 s44, s44, 18
  s_lshl_b32 s45, s29, 13
  s_add_u32 s45, s44, s45
  v_mfma_f32_32x32x16_bf16 a[48:63], a[136:139], v[232:235], a[48:63]
  s_add_u32 s46, s45, 262144
  s_add_u32 s44, s45, 4096
  s_add_u32 s47, s46, 4096
  v_mfma_f32_32x32x16_bf16 a[32:47], a[140:143], v[228:231], a[32:47]
  v_mfma_f32_32x32x16_bf16 a[48:63], a[140:143], v[236:239], a[48:63]
  v_accvgpr_read_b32 v112, a0
  v_accvgpr_read_b32 v113, a1
  v_accvgpr_read_b32 v114, a2
  v_accvgpr_read_b32 v115, a3
  v_accvgpr_read_b32 v116, a4
  v_accvgpr_read_b32 v117, a5
  v_accvgpr_read_b32 v118, a6
  v_mfma_f32_32x32x16_bf16 a[64:79], a[144:147], v[224:227], a[64:79]
  v_accvgpr_read_b32 v119, a7
  v_accvgpr_read_b32 v120, a8
  v_accvgpr_read_b32 v121, a9
  v_accvgpr_read_b32 v122, a10
  v_accvgpr_read_b32 v123, a11
  v_accvgpr_read_b32 v124, a12
  v_accvgpr_read_b32 v125, a13
  v_mfma_f32_32x32x16_bf16 a[80:95], a[144:147], v[232:235], a[80:95]
  v_accvgpr_read_b32 v126, a14
  v_accvgpr_read_b32 v127, a15
  v_mul_f32 v112, v112, v10
  v_mul_f32 v113, v113, v10
  v_mul_f32 v114, v114, v10
  v_mul_f32 v115, v115, v10
  v_mfma_f32_32x32x16_bf16 a[64:79], a[148:151], v[228:231], a[64:79]
  v_mul_f32 v116, v116, v10
  v_mul_f32 v117, v117, v10
  v_mul_f32 v118, v118, v10
  v_mul_f32 v119, v119, v10
  v_mul_f32 v120, v120, v10
  v_mul_f32 v121, v121, v10
  v_mul_f32 v122, v122, v10
  v_mfma_f32_32x32x16_bf16 a[80:95], a[148:151], v[236:239], a[80:95]
  v_mul_f32 v123, v123, v10
  v_mul_f32 v124, v124, v10
  v_mul_f32 v125, v125, v10
  v_mul_f32 v126, v126, v10
  v_mul_f32 v127, v127, v10
  v_cvt_pk_bf16_f32 v128, v112, v113
  v_cvt_pk_bf16_f32 v129, v114, v115
  v_mfma_f32_32x32x16_bf16 a[96:111], a[152:155], v[224:227], a[96:111]
  v_cvt_pk_bf16_f32 v130, v116, v117
  v_cvt_pk_bf16_f32 v131, v118, v119
  v_cvt_pk_bf16_f32 v132, v120, v121
  v_cvt_pk_bf16_f32 v133, v122, v123
  v_cvt_pk_bf16_f32 v134, v124, v125
  v_cvt_pk_bf16_f32 v135, v126, v127
  v_mfma_f32_32x32x16_bf16 a[112:127], a[152:155], v[232:235], a[112:127]
  buffer_store_dwordx4 v[128:131], v25, s[20:23], s45 offen offset:0 sc1
  buffer_store_dwordx4 v[132:135], v25, s[20:23], s45 offen offset:1024 sc1
  v_accvgpr_read_b32 v144, a16
  v_accvgpr_read_b32 v145, a17
  v_accvgpr_read_b32 v146, a18
  v_accvgpr_read_b32 v147, a19
  v_mfma_f32_32x32x16_bf16 a[96:111], a[156:159], v[228:231], a[96:111]
  v_accvgpr_read_b32 v148, a20
  v_accvgpr_read_b32 v149, a21
  v_accvgpr_read_b32 v150, a22
  v_accvgpr_read_b32 v151, a23
  v_accvgpr_read_b32 v152, a24
  v_accvgpr_read_b32 v153, a25
  v_accvgpr_read_b32 v154, a26
  v_mfma_f32_32x32x16_bf16 a[112:127], a[156:159], v[236:239], a[112:127]
  v_accvgpr_read_b32 v155, a27
  v_accvgpr_read_b32 v156, a28
  v_accvgpr_read_b32 v157, a29
  v_accvgpr_read_b32 v158, a30
  v_accvgpr_read_b32 v159, a31
  v_mul_f32 v144, v144, v11
  v_mul_f32 v145, v145, v11
  v_mul_f32 v146, v146, v11
  v_mul_f32 v147, v147, v11
  v_mul_f32 v148, v148, v11
  v_mul_f32 v149, v149, v11
  v_mul_f32 v150, v150, v11
  v_mul_f32 v151, v151, v11
  v_mul_f32 v152, v152, v11
  v_mul_f32 v153, v153, v11
  v_mul_f32 v154, v154, v11
  v_mul_f32 v155, v155, v11
  v_mul_f32 v156, v156, v11
  v_mul_f32 v157, v157, v11
  v_mul_f32 v158, v158, v11
  v_mul_f32 v159, v159, v11
  v_cvt_pk_bf16_f32 v160, v144, v145
  v_cvt_pk_bf16_f32 v161, v146, v147
  v_cvt_pk_bf16_f32 v162, v148, v149
  v_cvt_pk_bf16_f32 v163, v150, v151
  v_cvt_pk_bf16_f32 v164, v152, v153
  v_cvt_pk_bf16_f32 v165, v154, v155
  v_cvt_pk_bf16_f32 v166, v156, v157
  v_cvt_pk_bf16_f32 v167, v158, v159
  buffer_store_dwordx4 v[160:163], v25, s[20:23], s46 offen offset:0 sc1
  buffer_store_dwordx4 v[164:167], v25, s[20:23], s46 offen offset:1024 sc1
  s_waitcnt vmcnt(28) lgkmcnt(0)
  s_barrier
  ds_read_b64_tr_b16 v[176:177], v244 offset:0
  ds_read_b64_tr_b16 v[178:179], v244 offset:512
  ds_read_b64_tr_b16 v[184:185], v244 offset:64
  ds_read_b64_tr_b16 v[186:187], v244 offset:576
  ds_read_b64_tr_b16 v[192:193], v244 offset:128
  ds_read_b64_tr_b16 v[194:195], v244 offset:640
  ds_read_b64_tr_b16 v[200:201], v244 offset:192
  ds_read_b64_tr_b16 v[202:203], v244 offset:704
  ds_read_b64_tr_b16 v[180:181], v244 offset:4352
  ds_read_b64_tr_b16 v[182:183], v244 offset:4864
  ds_read_b64_tr_b16 v[188:189], v244 offset:4416
  ds_read_b64_tr_b16 v[190:191], v244 offset:4928
  ds_read_b64_tr_b16 v[196:197], v244 offset:4480
  ds_read_b64_tr_b16 v[198:199], v244 offset:4992
  ds_read_b64_tr_b16 v[204:205], v244 offset:4544
  ds_read_b64_tr_b16 v[206:207], v244 offset:5056
  v_accvgpr_read_b32 v112, a32
  v_accvgpr_read_b32 v113, a33
  v_accvgpr_read_b32 v114, a34
  v_accvgpr_read_b32 v115, a35
  s_add_u32 m0, s34, 69632
  s_nop 0
  buffer_load_dwordx4 v240, s[8:11], s33 offen lds
  v_accvgpr_read_b32 v116, a36
  v_accvgpr_read_b32 v117, a37
  v_accvgpr_read_b32 v118, a38
  v_accvgpr_read_b32 v119, a39
  buffer_load_dwordx4 v241, s[8:11], s33 offen offset:1088 lds
  v_accvgpr_read_b32 v120, a40
  v_accvgpr_read_b32 v121, a41
  v_accvgpr_read_b32 v122, a42
  v_accvgpr_read_b32 v123, a43
  buffer_load_dwordx4 v242, s[8:11], s33 offen offset:2176 lds
  v_accvgpr_read_b32 v124, a44
  v_accvgpr_read_b32 v125, a45
  v_accvgpr_read_b32 v126, a46
  v_accvgpr_read_b32 v127, a47
  buffer_load_dwordx4 v243, s[8:11], s33 offen offset:3264 lds
  s_add_u32 s33, s33, 65536
  v_mul_f32 v112, v112, v10
  v_mul_f32 v113, v113, v10
  v_mul_f32 v114, v114, v10
  v_mul_f32 v115, v115, v10
  buffer_load_dwordx4 a[224:227], v25, s[4:7], s32 offen offset:0 sc1
  v_mul_f32 v116, v116, v10
  v_mul_f32 v117, v117, v10
  v_mul_f32 v118, v118, v10
  v_mul_f32 v119, v119, v10
  buffer_load_dwordx4 a[228:231], v25, s[4:7], s32 offen offset:1024 sc1
  v_mul_f32 v120, v120, v10
  v_mul_f32 v121, v121, v10
  v_mul_f32 v122, v122, v10
  v_mul_f32 v123, v123, v10
  buffer_load_dwordx4 a[232:235], v25, s[4:7], s32 offen offset:2048 sc1
  v_mul_f32 v124, v124, v10
  v_mul_f32 v125, v125, v10
  v_mul_f32 v126, v126, v10
  v_mul_f32 v127, v127, v10
  buffer_load_dwordx4 a[236:239], v25, s[4:7], s32 offen offset:3072 sc1
  s_add_u32 s32, s32, 4096
  v_cvt_pk_bf16_f32 v128, v112, v113
  v_cvt_pk_bf16_f32 v129, v114, v115
  v_cvt_pk_bf16_f32 v130, v116, v117
  v_cvt_pk_bf16_f32 v131, v118, v119
  s_add_u32 m0, s34, 87040
  s_nop 0
  buffer_load_dwordx4 v240, s[8:11], s33 offen lds
  v_cvt_pk_bf16_f32 v132, v120, v121
  v_cvt_pk_bf16_f32 v133, v122, v123
  v_cvt_pk_bf16_f32 v134, v124, v125
  v_cvt_pk_bf16_f32 v135, v126, v127
  buffer_load_dwordx4 v241, s[8:11], s33 offen offset:1088 lds
  buffer_store_dwordx4 v[128:131], v25, s[20:23], s45 offen offset:2048 sc1
  buffer_store_dwordx4 v[132:135], v25, s[20:23], s45 offen offset:3072 sc1
  v_accvgpr_read_b32 v144, a48
  v_accvgpr_read_b32 v145, a49
  v_accvgpr_read_b32 v146, a50
  v_accvgpr_read_b32 v147, a51
  buffer_load_dwordx4 v242, s[8:11], s33 offen offset:2176 lds
  v_accvgpr_read_b32 v148, a52
  v_accvgpr_read_b32 v149, a53
  v_accvgpr_read_b32 v150, a54
  v_accvgpr_read_b32 v151, a55
  buffer_load_dwordx4 v243, s[8:11], s33 offen offset:3264 lds
  s_add_u32 s33, s33, 65536
  v_accvgpr_read_b32 v152, a56
  v_accvgpr_read_b32 v153, a57
  v_accvgpr_read_b32 v154, a58
  v_accvgpr_read_b32 v155, a59
  buffer_load_dwordx4 a[240:243], v25, s[4:7], s32 offen offset:0 sc1
  v_accvgpr_read_b32 v156, a60
  v_accvgpr_read_b32 v157, a61
  v_accvgpr_read_b32 v158, a62
  v_accvgpr_read_b32 v159, a63
  buffer_load_dwordx4 a[244:247], v25, s[4:7], s32 offen offset:1024 sc1
  v_mul_f32 v144, v144, v11
  v_mul_f32 v145, v145, v11
  v_mul_f32 v146, v146, v11
  v_mul_f32 v147, v147, v11
  v_mul_f32 v148, v148, v11
  v_mul_f32 v149, v149, v11
  v_mul_f32 v150, v150, v11
  v_mul_f32 v151, v151, v11
  v_mul_f32 v152, v152, v11
  v_mul_f32 v153, v153, v11
  v_mul_f32 v154, v154, v11
  v_mul_f32 v155, v155, v11
  v_mul_f32 v156, v156, v11
  v_mul_f32 v157, v157, v11
  v_mul_f32 v158, v158, v11
  v_mul_f32 v159, v159, v11
  v_cvt_pk_bf16_f32 v160, v144, v145
  v_cvt_pk_bf16_f32 v161, v146, v147
  v_cvt_pk_bf16_f32 v162, v148, v149
  v_cvt_pk_bf16_f32 v163, v150, v151
  v_cvt_pk_bf16_f32 v164, v152, v153
  v_cvt_pk_bf16_f32 v165, v154, v155
  v_cvt_pk_bf16_f32 v166, v156, v157
  v_cvt_pk_bf16_f32 v167, v158, v159
  buffer_store_dwordx4 v[160:163], v25, s[20:23], s46 offen offset:2048 sc1
  buffer_store_dwordx4 v[164:167], v25, s[20:23], s46 offen offset:3072 sc1
  v_accvgpr_read_b32 v112, a64
  v_accvgpr_read_b32 v113, a65
  v_accvgpr_read_b32 v114, a66
  v_accvgpr_read_b32 v115, a67
  v_accvgpr_read_b32 v116, a68
  v_accvgpr_read_b32 v117, a69
  v_accvgpr_read_b32 v118, a70
  v_accvgpr_read_b32 v119, a71
  v_accvgpr_read_b32 v120, a72
  v_accvgpr_read_b32 v121, a73
  v_accvgpr_read_b32 v122, a74
  v_accvgpr_read_b32 v123, a75
  v_accvgpr_read_b32 v124, a76
  v_accvgpr_read_b32 v125, a77
  v_accvgpr_read_b32 v126, a78
  v_accvgpr_read_b32 v127, a79
  v_mul_f32 v112, v112, v10
  v_mul_f32 v113, v113, v10
  v_mul_f32 v114, v114, v10
  v_mul_f32 v115, v115, v10
  v_mul_f32 v116, v116, v10
  v_mul_f32 v117, v117, v10
  v_mul_f32 v118, v118, v10
  v_mul_f32 v119, v119, v10
  v_mul_f32 v120, v120, v10
  v_mul_f32 v121, v121, v10
  v_mul_f32 v122, v122, v10
  v_mul_f32 v123, v123, v10
  v_mul_f32 v124, v124, v10
  v_mul_f32 v125, v125, v10
  v_mul_f32 v126, v126, v10
  v_mul_f32 v127, v127, v10
  v_cvt_pk_bf16_f32 v128, v112, v113
  v_cvt_pk_bf16_f32 v129, v114, v115
  v_cvt_pk_bf16_f32 v130, v116, v117
  v_cvt_pk_bf16_f32 v131, v118, v119
  v_cvt_pk_bf16_f32 v132, v120, v121
  v_cvt_pk_bf16_f32 v133, v122, v123
  v_cvt_pk_bf16_f32 v134, v124, v125
  v_cvt_pk_bf16_f32 v135, v126, v127
  buffer_store_dwordx4 v[128:131], v25, s[20:23], s44 offen offset:0 sc1
  buffer_store_dwordx4 v[132:135], v25, s[20:23], s44 offen offset:1024 sc1
  v_accvgpr_read_b32 v144, a80
  v_accvgpr_read_b32 v145, a81
  v_accvgpr_read_b32 v146, a82
  v_accvgpr_read_b32 v147, a83
  v_accvgpr_read_b32 v148, a84
  v_accvgpr_read_b32 v149, a85
  v_accvgpr_read_b32 v150, a86
  v_accvgpr_read_b32 v151, a87
  v_accvgpr_read_b32 v152, a88
  v_accvgpr_read_b32 v153, a89
  v_accvgpr_read_b32 v154, a90
  v_accvgpr_read_b32 v155, a91
  v_accvgpr_read_b32 v156, a92
  v_accvgpr_read_b32 v157, a93
  v_accvgpr_read_b32 v158, a94
  v_accvgpr_read_b32 v159, a95
  v_mul_f32 v144, v144, v11
  v_mul_f32 v145, v145, v11
  v_mul_f32 v146, v146, v11
  v_mul_f32 v147, v147, v11
  v_mul_f32 v148, v148, v11
  v_mul_f32 v149, v149, v11
  v_mul_f32 v150, v150, v11
  v_mul_f32 v151, v151, v11
  v_mul_f32 v152, v152, v11
  v_mul_f32 v153, v153, v11
  v_mul_f32 v154, v154, v11
  v_mul_f32 v155, v155, v11
  v_mul_f32 v156, v156, v11
  v_mul_f32 v157, v157, v11
  v_mul_f32 v158, v158, v11
  v_mul_f32 v159, v159, v11
  v_cvt_pk_bf16_f32 v160, v144, v145
  v_cvt_pk_bf16_f32 v161, v146, v147
  v_cvt_pk_bf16_f32 v162, v148, v149
  v_cvt_pk_bf16_f32 v163, v150, v151
  v_cvt_pk_bf16_f32 v164, v152, v153
  v_cvt_pk_bf16_f32 v165, v154, v155
  v_cvt_pk_bf16_f32 v166, v156, v157
  v_cvt_pk_bf16_f32 v167, v158, v159
  buffer_store_dwordx4 v[160:163], v25, s[20:23], s47 offen offset:0 sc1
  buffer_store_dwordx4 v[164:167], v25, s[20:23], s47 offen offset:1024 sc1
  v_accvgpr_read_b32 v112, a96
  v_accvgpr_read_b32 v113, a97
  v_accvgpr_read_b32 v114, a98
  v_accvgpr_read_b32 v115, a99
  v_accvgpr_read_b32 v116, a100
  v_accvgpr_read_b32 v117, a101
  v_accvgpr_read_b32 v118, a102
  v_accvgpr_read_b32 v119, a103
  v_accvgpr_read_b32 v120, a104
  v_accvgpr_read_b32 v121, a105
  v_accvgpr_read_b32 v122, a106
  v_accvgpr_read_b32 v123, a107
  v_accvgpr_read_b32 v124, a108
  v_accvgpr_read_b32 v125, a109
  v_accvgpr_read_b32 v126, a110
  v_accvgpr_read_b32 v127, a111
  v_mul_f32 v112, v112, v10
  v_mul_f32 v113, v113, v10
  v_mul_f32 v114, v114, v10
  v_mul_f32 v115, v115, v10
  v_mul_f32 v116, v116, v10
  v_mul_f32 v117, v117, v10
  v_mul_f32 v118, v118, v10
  v_mul_f32 v119, v119, v10
  v_mul_f32 v120, v120, v10
  v_mul_f32 v121, v121, v10
  v_mul_f32 v122, v122, v10
  v_mul_f32 v123, v123, v10
  v_mul_f32 v124, v124, v10
  v_mul_f32 v125, v125, v10
  v_mul_f32 v126, v126, v10
  v_mul_f32 v127, v127, v10
  v_cvt_pk_bf16_f32 v128, v112, v113
  v_cvt_pk_bf16_f32 v129, v114, v115
  v_cvt_pk_bf16_f32 v130, v116, v117
  v_cvt_pk_bf16_f32 v131, v118, v119
  v_cvt_pk_bf16_f32 v132, v120, v121
  v_cvt_pk_bf16_f32 v133, v122, v123
  v_cvt_pk_bf16_f32 v134, v124, v125
  v_cvt_pk_bf16_f32 v135, v126, v127
  buffer_store_dwordx4 v[128:131], v25, s[20:23], s44 offen offset:2048 sc1
  buffer_store_dwordx4 v[132:135], v25, s[20:23], s44 offen offset:3072 sc1
  v_accvgpr_read_b32 v144, a112
  v_accvgpr_read_b32 v145, a113
  v_accvgpr_read_b32 v146, a114
  v_accvgpr_read_b32 v147, a115
  v_accvgpr_read_b32 v148, a116
  v_accvgpr_read_b32 v149, a117
  v_accvgpr_read_b32 v150, a118
  v_accvgpr_read_b32 v151, a119
  v_accvgpr_read_b32 v152, a120
  v_accvgpr_read_b32 v153, a121
  v_accvgpr_read_b32 v154, a122
  v_accvgpr_read_b32 v155, a123
  v_accvgpr_read_b32 v156, a124
  v_accvgpr_read_b32 v157, a125
  v_accvgpr_read_b32 v158, a126
  v_accvgpr_read_b32 v159, a127
  v_mul_f32 v144, v144, v11
  v_mul_f32 v145, v145, v11
  v_mul_f32 v146, v146, v11
  v_mul_f32 v147, v147, v11
  v_mul_f32 v148, v148, v11
  v_mul_f32 v149, v149, v11
  v_mul_f32 v150, v150, v11
  v_mul_f32 v151, v151, v11
  v_mul_f32 v152, v152, v11
  v_mul_f32 v153, v153, v11
  v_mul_f32 v154, v154, v11
  v_mul_f32 v155, v155, v11
  v_mul_f32 v156, v156, v11
  v_mul_f32 v157, v157, v11
  v_mul_f32 v158, v158, v11
  v_mul_f32 v159, v159, v11
  v_cvt_pk_bf16_f32 v160, v144, v145
  v_cvt_pk_bf16_f32 v161, v146, v147
  v_cvt_pk_bf16_f32 v162, v148, v149
  v_cvt_pk_bf16_f32 v163, v150, v151
  v_cvt_pk_bf16_f32 v164, v152, v153
  v_cvt_pk_bf16_f32 v165, v154, v155
  v_cvt_pk_bf16_f32 v166, v156, v157
  v_cvt_pk_bf16_f32 v167, v158, v159
  buffer_store_dwordx4 v[160:163], v25, s[20:23], s47 offen offset:2048 sc1
  buffer_store_dwordx4 v[164:167], v25, s[20:23], s47 offen offset:3072 sc1
  s_waitcnt lgkmcnt(0)
  v_mfma_f32_32x32x16_bf16 v[40:55], v[176:179], a[160:163], 0
  ds_read_b64_tr_b16 v[208:209], v244 offset:8704
  ds_read_b64_tr_b16 v[210:211], v244 offset:9216
  ds_read_b64_tr_b16 v[216:217], v244 offset:8768
  v_mfma_f32_32x32x16_bf16 v[56:71], v[184:187], a[160:163], 0
  ds_read_b64_tr_b16 v[218:219], v244 offset:9280
  ds_read_b64_tr_b16 v[224:225], v244 offset:8832
  v_mfma_f32_32x32x16_bf16 v[72:87], v[192:195], a[160:163], 0
  ds_read_b64_tr_b16 v[226:227], v244 offset:9344
  ds_read_b64_tr_b16 v[232:233], v244 offset:8896
  v_mfma_f32_32x32x16_bf16 v[88:103], v[200:203], a[160:163], 0
  ds_read_b64_tr_b16 v[234:235], v244 offset:9408
  ds_read_b64_tr_b16 v[212:213], v244 offset:13056
  ds_read_b64_tr_b16 v[214:215], v244 offset:13568
  v_mfma_f32_32x32x16_bf16 v[40:55], v[180:183], a[164:167], v[40:55]
  ds_read_b64_tr_b16 v[220:221], v244 offset:13120
  ds_read_b64_tr_b16 v[222:223], v244 offset:13632
  v_mfma_f32_32x32x16_bf16 v[56:71], v[188:191], a[164:167], v[56:71]
  ds_read_b64_tr_b16 v[228:229], v244 offset:13184
  ds_read_b64_tr_b16 v[230:231], v244 offset:13696
  v_mfma_f32_32x32x16_bf16 v[72:87], v[196:199], a[164:167], v[72:87]
  ds_read_b64_tr_b16 v[236:237], v244 offset:13248
  ds_read_b64_tr_b16 v[238:239], v244 offset:13760
  v_mfma_f32_32x32x16_bf16 v[88:103], v[204:207], a[164:167], v[88:103]
  s_waitcnt lgkmcnt(13)
  v_mfma_f32_32x32x16_bf16 v[40:55], v[208:211], a[168:171], v[40:55]
  s_waitcnt vmcnt(50) lgkmcnt(0)
  s_barrier
  v_mfma_f32_32x32x16_bf16 v[56:71], v[216:219], a[168:171], v[56:71]
  ds_read_b64_tr_b16 v[176:177], v244 offset:17408
  ds_read_b64_tr_b16 v[178:179], v244 offset:17920
  v_mfma_f32_32x32x16_bf16 v[72:87], v[224:227], a[168:171], v[72:87]
  ds_read_b64_tr_b16 v[184:185], v244 offset:17472
  ds_read_b64_tr_b16 v[186:187], v244 offset:17984
  s_lshl_b32 s31, s68, 20
  s_sub_u32 s8, s60, 256
  s_subb_u32 s9, s61, 0
  s_add_u32 s8, s8, s31
  s_addc_u32 s9, s9, 0
  s_mov_b32 s10, 1048832
  s_and_b32 s33, s29, 7
  s_lshl_b32 s33, s33, 17
  ds_read_b64_tr_b16 v[192:193], v244 offset:17536
  v_mfma_f32_32x32x16_bf16 v[88:103], v[232:235], a[168:171], v[88:103]
  ds_read_b64_tr_b16 v[194:195], v244 offset:18048
  ds_read_b64_tr_b16 v[200:201], v244 offset:17600
  s_add_u32 m0, s34, 0
  s_nop 0
  buffer_load_dwordx4 v240, s[8:11], s33 offen lds
  ds_read_b64_tr_b16 v[202:203], v244 offset:18112
  v_mfma_f32_32x32x16_bf16 v[40:55], v[212:215], a[172:175], v[40:55]
  ds_read_b64_tr_b16 v[180:181], v244 offset:21760
  ds_read_b64_tr_b16 v[182:183], v244 offset:22272
  buffer_load_dwordx4 v241, s[8:11], s33 offen offset:1088 lds
  ds_read_b64_tr_b16 v[188:189], v244 offset:21824
  v_mfma_f32_32x32x16_bf16 v[56:71], v[220:223], a[172:175], v[56:71]
  ds_read_b64_tr_b16 v[190:191], v244 offset:22336
  ds_read_b64_tr_b16 v[196:197], v244 offset:21888
  buffer_load_dwordx4 v242, s[8:11], s33 offen offset:2176 lds
  ds_read_b64_tr_b16 v[198:199], v244 offset:22400
  v_mfma_f32_32x32x16_bf16 v[72:87], v[228:231], a[172:175], v[72:87]
  ds_read_b64_tr_b16 v[204:205], v244 offset:21952
  ds_read_b64_tr_b16 v[206:207], v244 offset:22464
  v_mfma_f32_32x32x16_bf16 v[88:103], v[236:239], a[172:175], v[88:103]
  buffer_load_dwordx4 v243, s[8:11], s33 offen offset:3264 lds
  s_add_u32 s33, s33, 65536
  s_and_b32 s33, s33, 0xfffff
  s_waitcnt lgkmcnt(9)
  v_mfma_f32_32x32x16_bf16 v[40:55], v[176:179], a[176:179], v[40:55]
  ds_read_b64_tr_b16 v[208:209], v244 offset:26112
  ds_read_b64_tr_b16 v[210:211], v244 offset:26624
  ds_read_b64_tr_b16 v[216:217], v244 offset:26176
  v_mfma_f32_32x32x16_bf16 v[56:71], v[184:187], a[176:179], v[56:71]
  ds_read_b64_tr_b16 v[218:219], v244 offset:26688
  ds_read_b64_tr_b16 v[224:225], v244 offset:26240
  v_mfma_f32_32x32x16_bf16 v[72:87], v[192:195], a[176:179], v[72:87]
  ds_read_b64_tr_b16 v[226:227], v244 offset:26752
  ds_read_b64_tr_b16 v[232:233], v244 offset:26304
  s_waitcnt lgkmcnt(10)
  v_mfma_f32_32x32x16_bf16 v[88:103], v[200:203], a[176:179], v[88:103]
  ds_read_b64_tr_b16 v[234:235], v244 offset:26816
  ds_read_b64_tr_b16 v[212:213], v244 offset:30464
  ds_read_b64_tr_b16 v[214:215], v244 offset:30976
  v_mfma_f32_32x32x16_bf16 v[40:55], v[180:183], a[180:183], v[40:55]
  ds_read_b64_tr_b16 v[220:221], v244 offset:30528
  ds_read_b64_tr_b16 v[222:223], v244 offset:31040
  v_mfma_f32_32x32x16_bf16 v[56:71], v[188:191], a[180:183], v[56:71]
  ds_read_b64_tr_b16 v[228:229], v244 offset:30592
  ds_read_b64_tr_b16 v[230:231], v244 offset:31104
  s_waitcnt lgkmcnt(14)
  v_mfma_f32_32x32x16_bf16 v[72:87], v[196:199], a[180:183], v[72:87]
  ds_read_b64_tr_b16 v[236:237], v244 offset:30656
  ds_read_b64_tr_b16 v[238:239], v244 offset:31168
  v_mfma_f32_32x32x16_bf16 v[88:103], v[204:207], a[180:183], v[88:103]
  s_waitcnt lgkmcnt(13)
  v_mfma_f32_32x32x16_bf16 v[40:55], v[208:211], a[184:187], v[40:55]
  s_waitcnt vmcnt(42) lgkmcnt(0)
  s_barrier
  v_mfma_f32_32x32x16_bf16 v[56:71], v[216:219], a[184:187], v[56:71]
  ds_read_b64_tr_b16 v[176:177], v244 offset:34816
  ds_read_b64_tr_b16 v[178:179], v244 offset:35328
  ds_read_b64_tr_b16 v[184:185], v244 offset:34880
  v_mfma_f32_32x32x16_bf16 v[72:87], v[224:227], a[184:187], v[72:87]
  ds_read_b64_tr_b16 v[186:187], v244 offset:35392
  ds_read_b64_tr_b16 v[192:193], v244 offset:34944
  s_add_u32 m0, s34, 17408
  s_nop 0
  buffer_load_dwordx4 v240, s[8:11], s33 offen lds
  v_mfma_f32_32x32x16_bf16 v[88:103], v[232:235], a[184:187], v[88:103]
  ds_read_b64_tr_b16 v[194:195], v244 offset:35456
  ds_read_b64_tr_b16 v[200:201], v244 offset:35008
  ds_read_b64_tr_b16 v[202:203], v244 offset:35520
  buffer_load_dwordx4 v241, s[8:11], s33 offen offset:1088 lds
  v_mfma_f32_32x32x16_bf16 v[40:55], v[212:215], a[188:191], v[40:55]
  ds_read_b64_tr_b16 v[180:181], v244 offset:39168
  ds_read_b64_tr_b16 v[182:183], v244 offset:39680
  ds_read_b64_tr_b16 v[188:189], v244 offset:39232
  buffer_load_dwordx4 v242, s[8:11], s33 offen offset:2176 lds
  v_mfma_f32_32x32x16_bf16 v[56:71], v[220:223], a[188:191], v[56:71]
  ds_read_b64_tr_b16 v[190:191], v244 offset:39744
  ds_read_b64_tr_b16 v[196:197], v244 offset:39296
  ds_read_b64_tr_b16 v[198:199], v244 offset:39808
  v_mfma_f32_32x32x16_bf16 v[72:87], v[228:231], a[188:191], v[72:87]
  ds_read_b64_tr_b16 v[204:205], v244 offset:39360
  ds_read_b64_tr_b16 v[206:207], v244 offset:39872
  v_mfma_f32_32x32x16_bf16 v[88:103], v[236:239], a[188:191], v[88:103]
  buffer_load_dwordx4 v243, s[8:11], s33 offen offset:3264 lds
  s_add_u32 s33, s33, 65536
  s_and_b32 s33, s33, 0xfffff
  s_waitcnt lgkmcnt(10)
  v_mfma_f32_32x32x16_bf16 v[40:55], v[176:179], a[192:195], v[40:55]
  ds_read_b64_tr_b16 v[208:209], v244 offset:43520
  ds_read_b64_tr_b16 v[210:211], v244 offset:44032
  ds_read_b64_tr_b16 v[216:217], v244 offset:43584
  v_mfma_f32_32x32x16_bf16 v[56:71], v[184:187], a[192:195], v[56:71]
  ds_read_b64_tr_b16 v[218:219], v244 offset:44096
  ds_read_b64_tr_b16 v[224:225], v244 offset:43648
  v_mfma_f32_32x32x16_bf16 v[72:87], v[192:195], a[192:195], v[72:87]
  ds_read_b64_tr_b16 v[226:227], v244 offset:44160
  ds_read_b64_tr_b16 v[232:233], v244 offset:43712
  s_waitcnt lgkmcnt(11)
  v_mfma_f32_32x32x16_bf16 v[88:103], v[200:203], a[192:195], v[88:103]
  ds_read_b64_tr_b16 v[234:235], v244 offset:44224
  ds_read_b64_tr_b16 v[212:213], v244 offset:47872
  ds_read_b64_tr_b16 v[214:215], v244 offset:48384
  v_mfma_f32_32x32x16_bf16 v[40:55], v[180:183], a[196:199], v[40:55]
  ds_read_b64_tr_b16 v[220:221], v244 offset:47936
  ds_read_b64_tr_b16 v[222:223], v244 offset:48448
  v_mfma_f32_32x32x16_bf16 v[56:71], v[188:191], a[196:199], v[56:71]
  ds_read_b64_tr_b16 v[228:229], v244 offset:48000
  ds_read_b64_tr_b16 v[230:231], v244 offset:48512
  s_waitcnt lgkmcnt(14)
  v_mfma_f32_32x32x16_bf16 v[72:87], v[196:199], a[196:199], v[72:87]
  ds_read_b64_tr_b16 v[236:237], v244 offset:48064
  ds_read_b64_tr_b16 v[238:239], v244 offset:48576
  v_mfma_f32_32x32x16_bf16 v[88:103], v[204:207], a[196:199], v[88:103]
  s_waitcnt lgkmcnt(13)
  v_mfma_f32_32x32x16_bf16 v[40:55], v[208:211], a[200:203], v[40:55]
  s_waitcnt vmcnt(42) lgkmcnt(0)
  s_barrier
  v_mfma_f32_32x32x16_bf16 v[56:71], v[216:219], a[200:203], v[56:71]
  ds_read_b64_tr_b16 v[176:177], v245 offset:0
  ds_read_b64_tr_b16 v[178:179], v245 offset:512
  ds_read_b64_tr_b16 v[184:185], v245 offset:64
  v_mfma_f32_32x32x16_bf16 v[72:87], v[224:227], a[200:203], v[72:87]
  ds_read_b64_tr_b16 v[186:187], v245 offset:576
  ds_read_b64_tr_b16 v[192:193], v245 offset:128
  s_add_u32 m0, s34, 34816
  s_nop 0
  buffer_load_dwordx4 v240, s[8:11], s33 offen lds
  v_mfma_f32_32x32x16_bf16 v[88:103], v[232:235], a[200:203], v[88:103]
  ds_read_b64_tr_b16 v[194:195], v245 offset:640
  ds_read_b64_tr_b16 v[200:201], v245 offset:192
  ds_read_b64_tr_b16 v[202:203], v245 offset:704
  buffer_load_dwordx4 v241, s[8:11], s33 offen offset:1088 lds
  v_mfma_f32_32x32x16_bf16 v[40:55], v[212:215], a[204:207], v[40:55]
  ds_read_b64_tr_b16 v[180:181], v245 offset:4352
  ds_read_b64_tr_b16 v[182:183], v245 offset:4864
  ds_read_b64_tr_b16 v[188:189], v245 offset:4416
  buffer_load_dwordx4 v242, s[8:11], s33 offen offset:2176 lds
  v_mfma_f32_32x32x16_bf16 v[56:71], v[220:223], a[204:207], v[56:71]
  ds_read_b64_tr_b16 v[190:191], v245 offset:4928
  ds_read_b64_tr_b16 v[196:197], v245 offset:4480
  ds_read_b64_tr_b16 v[198:199], v245 offset:4992
  v_mfma_f32_32x32x16_bf16 v[72:87], v[228:231], a[204:207], v[72:87]
  ds_read_b64_tr_b16 v[204:205], v245 offset:4544
  ds_read_b64_tr_b16 v[206:207], v245 offset:5056
  v_mfma_f32_32x32x16_bf16 v[88:103], v[236:239], a[204:207], v[88:103]
  buffer_load_dwordx4 v243, s[8:11], s33 offen offset:3264 lds
  s_add_u32 s33, s33, 65536
  s_and_b32 s33, s33, 0xfffff
  s_waitcnt lgkmcnt(10)
  v_mfma_f32_32x32x16_bf16 v[40:55], v[176:179], a[208:211], v[40:55]
  ds_read_b64_tr_b16 v[208:209], v245 offset:8704
  ds_read_b64_tr_b16 v[210:211], v245 offset:9216
  v_mfma_f32_32x32x16_bf16 v[56:71], v[184:187], a[208:211], v[56:71]
  ds_read_b64_tr_b16 v[216:217], v245 offset:8768
  ds_read_b64_tr_b16 v[218:219], v245 offset:9280
  v_mfma_f32_32x32x16_bf16 v[72:87], v[192:195], a[208:211], v[72:87]
  ds_read_b64_tr_b16 v[224:225], v245 offset:8832
  ds_read_b64_tr_b16 v[226:227], v245 offset:9344
  s_and_b32 s42, s2, 0xf9
  s_lshl_b32 s42, s42, 16
  s_lshl_b32 s44, s28, 11
  s_add_u32 s42, s42, s44
  s_lshl_b32 s44, s68, 13
  s_add_u32 s43, s42, s44
  s_waitcnt lgkmcnt(6)
  v_mfma_f32_32x32x16_bf16 v[88:103], v[200:203], a[208:211], v[88:103]
  ds_read_b64_tr_b16 v[232:233], v245 offset:8896
  ds_read_b64_tr_b16 v[234:235], v245 offset:9408
  ds_read_b64_tr_b16 v[212:213], v245 offset:13056
  v_mfma_f32_32x32x16_bf16 v[40:55], v[180:183], a[212:215], v[40:55]
  ds_read_b64_tr_b16 v[214:215], v245 offset:13568
  ds_read_b64_tr_b16 v[220:221], v245 offset:13120
  s_add_u32 s24, s78, 67108864
  s_addc_u32 s25, s79, 0
  s_mov_b32 s26, 16777216
  s_mov_b32 s27, 0x00020000
  v_mfma_f32_32x32x16_bf16 v[56:71], v[188:191], a[212:215], v[56:71]
  ds_read_b64_tr_b16 v[222:223], v245 offset:13632
  ds_read_b64_tr_b16 v[228:229], v245 offset:13184
  ds_read_b64_tr_b16 v[230:231], v245 offset:13696
  v_mfma_f32_32x32x16_bf16 v[72:87], v[196:199], a[212:215], v[72:87]
  ds_read_b64_tr_b16 v[236:237], v245 offset:13248
  ds_read_b64_tr_b16 v[238:239], v245 offset:13760
  v_mfma_f32_32x32x16_bf16 v[88:103], v[204:207], a[212:215], v[88:103]
  v_and_b32 v12, 3, v1
  v_lshlrev_b32 v12, 12, v12
  v_bfe_u32 v2, v1, 2, 1
  v_lshl_add_u32 v12, v2, 9, v12
  s_lshl_b32 s40, s30, 14
  s_lshl_b32 s44, s68, 10
  s_add_u32 s40, s40, s44
  s_add_u32 s40, s40, 128
  s_waitcnt lgkmcnt(5)
  v_mfma_f32_32x32x16_bf16 v[40:55], v[208:211], a[216:219], v[40:55]
  s_waitcnt vmcnt(12) lgkmcnt(0)
  s_barrier
  v_mfma_f32_32x32x16_bf16 v[56:71], v[216:219], a[216:219], v[56:71]
  ds_read_b64_tr_b16 v[176:177], v245 offset:17408
  ds_read_b64_tr_b16 v[178:179], v245 offset:17920
  s_cmp_eq_u32 s28, 0
  s_cbranch_scc1 L_oflag
L_ret5:
  ds_read_b64_tr_b16 v[184:185], v245 offset:17472
  v_mfma_f32_32x32x16_bf16 v[72:87], v[224:227], a[216:219], v[72:87]
  ds_read_b64_tr_b16 v[186:187], v245 offset:17984
  s_lshl_b32 s47, s70, 18
  s_lshl_b32 s46, s68, 16
  s_add_u32 s47, s47, s46
  s_add_u32 s47, s47, 4194304
  s_add_u32 s4, s78, s47
  s_addc_u32 s5, s79, 0
  s_mov_b32 s6, 65536
  s_and_b32 s32, s29, 7
  s_lshl_b32 s32, s32, 13
  ds_read_b64_tr_b16 v[192:193], v245 offset:17536
  v_mfma_f32_32x32x16_bf16 v[88:103], v[232:235], a[216:219], v[88:103]
  ds_read_b64_tr_b16 v[194:195], v245 offset:18048
  buffer_load_dwordx4 a[160:163], v25, s[4:7], s32 offen offset:0 sc1
  ds_read_b64_tr_b16 v[200:201], v245 offset:17600
  buffer_load_dwordx4 a[164:167], v25, s[4:7], s32 offen offset:1024 sc1
  ds_read_b64_tr_b16 v[202:203], v245 offset:18112
  v_mfma_f32_32x32x16_bf16 v[40:55], v[212:215], a[220:223], v[40:55]
  ds_read_b64_tr_b16 v[180:181], v245 offset:21760
  buffer_load_dwordx4 a[168:171], v25, s[4:7], s32 offen offset:2048 sc1
  ds_read_b64_tr_b16 v[182:183], v245 offset:22272
  v_mfma_f32_32x32x16_bf16 v[56:71], v[220:223], a[220:223], v[56:71]
  ds_read_b64_tr_b16 v[188:189], v245 offset:21824
  ds_read_b64_tr_b16 v[190:191], v245 offset:22336
  buffer_load_dwordx4 a[172:175], v25, s[4:7], s32 offen offset:3072 sc1
  s_add_u32 s32, s32, 4096
  s_and_b32 s32, s32, 0xffff
  ds_read_b64_tr_b16 v[196:197], v245 offset:21888
  s_add_u32 m0, s34, 52224
  s_nop 0
  buffer_load_dwordx4 v240, s[8:11], s33 offen lds
  v_mfma_f32_32x32x16_bf16 v[72:87], v[228:231], a[220:223], v[72:87]
  ds_read_b64_tr_b16 v[198:199], v245 offset:22400
  ds_read_b64_tr_b16 v[204:205], v245 offset:21952
  buffer_load_dwordx4 v241, s[8:11], s33 offen offset:1088 lds
  ds_read_b64_tr_b16 v[206:207], v245 offset:22464
  v_mfma_f32_32x32x16_bf16 v[88:103], v[236:239], a[220:223], v[88:103]
  buffer_load_dwordx4 v242, s[8:11], s33 offen offset:2176 lds
  buffer_load_dwordx4 v243, s[8:11], s33 offen offset:3264 lds
  s_add_u32 s33, s33, 65536
  s_and_b32 s33, s33, 0xfffff
  s_waitcnt lgkmcnt(6)
  v_mfma_f32_32x32x16_bf16 v[40:55], v[176:179], a[224:227], v[40:55]
  ds_read_b64_tr_b16 v[208:209], v245 offset:26112
  ds_read_b64_tr_b16 v[210:211], v245 offset:26624
  buffer_load_dwordx4 a[176:179], v25, s[4:7], s32 offen offset:0 sc1
  ds_read_b64_tr_b16 v[216:217], v245 offset:26176
  v_mfma_f32_32x32x16_bf16 v[56:71], v[184:187], a[224:227], v[56:71]
  ds_read_b64_tr_b16 v[218:219], v245 offset:26688
  ds_read_b64_tr_b16 v[224:225], v245 offset:26240
  v_mfma_f32_32x32x16_bf16 v[72:87], v[192:195], a[224:227], v[72:87]
  ds_read_b64_tr_b16 v[226:227], v245 offset:26752
  ds_read_b64_tr_b16 v[232:233], v245 offset:26304
  buffer_load_dwordx4 a[180:183], v25, s[4:7], s32 offen offset:1024 sc1
  v_mfma_f32_32x32x16_bf16 v[88:103], v[200:203], a[224:227], v[88:103]
  ds_read_b64_tr_b16 v[234:235], v245 offset:26816
  ds_read_b64_tr_b16 v[212:213], v245 offset:30464
  ds_read_b64_tr_b16 v[214:215], v245 offset:30976
  v_mfma_f32_32x32x16_bf16 v[40:55], v[180:183], a[228:231], v[40:55]
  ds_read_b64_tr_b16 v[220:221], v245 offset:30528
  buffer_load_dwordx4 a[184:187], v25, s[4:7], s32 offen offset:2048 sc1
  ds_read_b64_tr_b16 v[222:223], v245 offset:31040
  s_waitcnt lgkmcnt(12)
  v_mfma_f32_32x32x16_bf16 v[56:71], v[188:191], a[228:231], v[56:71]
  ds_read_b64_tr_b16 v[228:229], v245 offset:30592
  ds_read_b64_tr_b16 v[230:231], v245 offset:31104
  v_mfma_f32_32x32x16_bf16 v[72:87], v[196:199], a[228:231], v[72:87]
  ds_read_b64_tr_b16 v[236:237], v245 offset:30656
  ds_read_b64_tr_b16 v[238:239], v245 offset:31168
  v_mfma_f32_32x32x16_bf16 v[88:103], v[204:207], a[228:231], v[88:103]
  buffer_load_dwordx4 a[188:191], v25, s[4:7], s32 offen offset:3072 sc1
  s_add_u32 s32, s32, 4096
  s_and_b32 s32, s32, 0xffff
  s_waitcnt lgkmcnt(9)
  v_mfma_f32_32x32x16_bf16 v[40:55], v[208:211], a[232:235], v[40:55]
  s_waitcnt vmcnt(34) lgkmcnt(0)
  s_barrier
  v_mfma_f32_32x32x16_bf16 v[56:71], v[216:219], a[232:235], v[56:71]
  ds_read_b64_tr_b16 v[176:177], v245 offset:34816
  ds_read_b64_tr_b16 v[178:179], v245 offset:35328
  v_mfma_f32_32x32x16_bf16 v[72:87], v[224:227], a[232:235], v[72:87]
  ds_read_b64_tr_b16 v[184:185], v245 offset:34880
  ds_read_b64_tr_b16 v[186:187], v245 offset:35392
  s_add_u32 m0, s34, 69632
  s_nop 0
  buffer_load_dwordx4 v240, s[8:11], s33 offen lds
  ds_read_b64_tr_b16 v[192:193], v245 offset:34944
  v_mfma_f32_32x32x16_bf16 v[88:103], v[232:235], a[232:235], v[88:103]
  ds_read_b64_tr_b16 v[194:195], v245 offset:35456
  ds_read_b64_tr_b16 v[200:201], v245 offset:35008
  buffer_load_dwordx4 v241, s[8:11], s33 offen offset:1088 lds
  ds_read_b64_tr_b16 v[202:203], v245 offset:35520
  v_mfma_f32_32x32x16_bf16 v[40:55], v[212:215], a[236:239], v[40:55]
  ds_read_b64_tr_b16 v[180:181], v245 offset:39168
  ds_read_b64_tr_b16 v[182:183], v245 offset:39680
  buffer_load_dwordx4 v242, s[8:11], s33 offen offset:2176 lds
  ds_read_b64_tr_b16 v[188:189], v245 offset:39232
  v_mfma_f32_32x32x16_bf16 v[56:71], v[220:223], a[236:239], v[56:71]
  ds_read_b64_tr_b16 v[190:191], v245 offset:39744
  ds_read_b64_tr_b16 v[196:197], v245 offset:39296
  v_mfma_f32_32x32x16_bf16 v[72:87], v[228:231], a[236:239], v[72:87]
  ds_read_b64_tr_b16 v[198:199], v245 offset:39808
  ds_read_b64_tr_b16 v[204:205], v245 offset:39360
  buffer_load_dwordx4 v243, s[8:11], s33 offen offset:3264 lds
  s_add_u32 s33, s33, 65536
  s_and_b32 s33, s33, 0xfffff
  ds_read_b64_tr_b16 v[206:207], v245 offset:39872
  v_mfma_f32_32x32x16_bf16 v[88:103], v[236:239], a[236:239], v[88:103]
  buffer_load_dword v250, v12, s[80:83], s40 offen sc1
  s_waitcnt lgkmcnt(9)
  v_mfma_f32_32x32x16_bf16 v[40:55], v[176:179], a[240:243], v[40:55]
  s_waitcnt vmcnt(25) lgkmcnt(0)
  s_barrier
  v_mfma_f32_32x32x16_bf16 v[56:71], v[184:187], a[240:243], v[56:71]
  ds_read_b64_tr_b16 v[208:209], v244 offset:0
  ds_read_b64_tr_b16 v[210:211], v244 offset:512
  ds_read_b64_tr_b16 v[216:217], v244 offset:64
  v_mfma_f32_32x32x16_bf16 v[72:87], v[192:195], a[240:243], v[72:87]
  ds_read_b64_tr_b16 v[218:219], v244 offset:576
  ds_read_b64_tr_b16 v[224:225], v244 offset:128
  ds_read_b64_tr_b16 v[226:227], v244 offset:640
  v_mfma_f32_32x32x16_bf16 v[88:103], v[200:203], a[240:243], v[88:103]
  ds_read_b64_tr_b16 v[232:233], v244 offset:192
  ds_read_b64_tr_b16 v[234:235], v244 offset:704
  v_mfma_f32_32x32x16_bf16 v[40:55], v[180:183], a[244:247], v[40:55]
  ds_read_b64_tr_b16 v[212:213], v244 offset:4352
  ds_read_b64_tr_b16 v[214:215], v244 offset:4864
  ds_read_b64_tr_b16 v[220:221], v244 offset:4416
  v_mfma_f32_32x32x16_bf16 v[56:71], v[188:191], a[244:247], v[56:71]
  ds_read_b64_tr_b16 v[222:223], v244 offset:4928
  ds_read_b64_tr_b16 v[228:229], v244 offset:4480
  ds_read_b64_tr_b16 v[230:231], v244 offset:4992
  v_mfma_f32_32x32x16_bf16 v[72:87], v[196:199], a[244:247], v[72:87]
  ds_read_b64_tr_b16 v[236:237], v244 offset:4544
  ds_read_b64_tr_b16 v[238:239], v244 offset:5056
  v_mfma_f32_32x32x16_bf16 v[88:103], v[204:207], a[244:247], v[88:103]
  s_waitcnt vmcnt(0)
  v_cmp_ne_u32 vcc, 1, v250
  s_nop 0
  s_cbranch_vccnz L_ospin
L_ospin_ret:
  buffer_load_dwordx4 a[192:195], v25, s[4:7], s32 offen offset:0 sc1
  buffer_load_dwordx4 a[196:199], v25, s[4:7], s32 offen offset:1024 sc1
  buffer_load_dwordx4 a[200:203], v25, s[4:7], s32 offen offset:2048 sc1
  buffer_load_dwordx4 a[204:207], v25, s[4:7], s32 offen offset:3072 sc1
  s_add_u32 s32, s32, 4096
  s_and_b32 s32, s32, 0xffff
  buffer_load_dwordx4 a[208:211], v25, s[4:7], s32 offen offset:0 sc1
  buffer_load_dwordx4 a[212:215], v25, s[4:7], s32 offen offset:1024 sc1
  buffer_load_dwordx4 a[216:219], v25, s[4:7], s32 offen offset:2048 sc1
  buffer_load_dwordx4 a[220:223], v25, s[4:7], s32 offen offset:3072 sc1
  s_add_u32 s32, s32, 4096
  s_and_b32 s32, s32, 0xffff
  buffer_load_dwordx4 a[224:227], v25, s[4:7], s32 offen offset:0 sc1
  buffer_load_dwordx4 a[228:231], v25, s[4:7], s32 offen offset:1024 sc1
  buffer_load_dwordx4 a[232:235], v25, s[4:7], s32 offen offset:2048 sc1
  buffer_load_dwordx4 a[236:239], v25, s[4:7], s32 offen offset:3072 sc1
  s_add_u32 s32, s32, 4096
  s_and_b32 s32, s32, 0xffff
  v_cvt_pk_bf16_f32 v56, v56, v57
  v_cvt_pk_bf16_f32 v57, v58, v59
  v_cvt_pk_bf16_f32 v58, v60, v61
  v_cvt_pk_bf16_f32 v59, v62, v63
  v_cvt_pk_bf16_f32 v60, v64, v65
  v_cvt_pk_bf16_f32 v61, v66, v67
  v_cvt_pk_bf16_f32 v62, v68, v69
  v_cvt_pk_bf16_f32 v63, v70, v71
  s_add_u32 s44, s68, 1
  s_and_b32 s44, s44, 3
  s_lshl_b32 s44, s44, 17
  s_add_u32 s44, s44, s43
  s_add_u32 s44, s44, 0
  buffer_store_dwordx4 v[56:59], v25, s[24:27], s44 offen sc1
  buffer_store_dwordx4 v[60:63], v25, s[24:27], s44 offen offset:1024 sc1
  v_cvt_pk_bf16_f32 v72, v72, v73
  v_cvt_pk_bf16_f32 v73, v74, v75
  v_cvt_pk_bf16_f32 v74, v76, v77
  v_cvt_pk_bf16_f32 v75, v78, v79
  v_cvt_pk_bf16_f32 v76, v80, v81
  v_cvt_pk_bf16_f32 v77, v82, v83
  v_cvt_pk_bf16_f32 v78, v84, v85
  v_cvt_pk_bf16_f32 v79, v86, v87
  s_add_u32 s44, s68, 2
  s_and_b32 s44, s44, 3
  s_lshl_b32 s44, s44, 17
  s_add_u32 s44, s44, s43
  s_add_u32 s44, s44, 0
  buffer_store_dwordx4 v[72:75], v25, s[24:27], s44 offen sc1
  buffer_store_dwordx4 v[76:79], v25, s[24:27], s44 offen offset:1024 sc1
  v_cvt_pk_bf16_f32 v88, v88, v89
  v_cvt_pk_bf16_f32 v89, v90, v91
  v_cvt_pk_bf16_f32 v90, v92, v93
  v_cvt_pk_bf16_f32 v91, v94, v95
  v_cvt_pk_bf16_f32 v92, v96, v97
  v_cvt_pk_bf16_f32 v93, v98, v99
  v_cvt_pk_bf16_f32 v94, v100, v101
  v_cvt_pk_bf16_f32 v95, v102, v103
  s_add_u32 s44, s68, 3
  s_and_b32 s44, s44, 3
  s_lshl_b32 s44, s44, 17
  s_add_u32 s44, s44, s43
  s_add_u32 s44, s44, 0
  buffer_store_dwordx4 v[88:91], v25, s[24:27], s44 offen sc1
  buffer_store_dwordx4 v[92:95], v25, s[24:27], s44 offen offset:1024 sc1
  s_waitcnt vmcnt(31)
  s_waitcnt lgkmcnt(0)
  v_mfma_f32_32x32x16_bf16 v[112:127], v[208:211], a[160:163], 0
  ds_read_b64_tr_b16 v[176:177], v244 offset:8704
  ds_read_b64_tr_b16 v[178:179], v244 offset:9216
  v_mfma_f32_32x32x16_bf16 v[128:143], v[216:219], a[160:163], 0
  ds_read_b64_tr_b16 v[184:185], v244 offset:8768
  ds_read_b64_tr_b16 v[186:187], v244 offset:9280
  s_add_u32 m0, s34, 87040
  s_nop 0
  buffer_load_dwordx4 v240, s[8:11], s33 offen lds
  v_mfma_f32_32x32x16_bf16 v[144:159], v[224:227], a[160:163], 0
  ds_read_b64_tr_b16 v[192:193], v244 offset:8832
  ds_read_b64_tr_b16 v[194:195], v244 offset:9344
  ds_read_b64_tr_b16 v[200:201], v244 offset:8896
  buffer_load_dwordx4 v241, s[8:11], s33 offen offset:1088 lds
  v_mfma_f32_32x32x16_bf16 v[160:175], v[232:235], a[160:163], 0
  ds_read_b64_tr_b16 v[202:203], v244 offset:9408
  ds_read_b64_tr_b16 v[180:181], v244 offset:13056
  ds_read_b64_tr_b16 v[182:183], v244 offset:13568
  v_mfma_f32_32x32x16_bf16 v[112:127], v[212:215], a[164:167], v[112:127]
  ds_read_b64_tr_b16 v[188:189], v244 offset:13120
  buffer_load_dwordx4 v242, s[8:11], s33 offen offset:2176 lds
  ds_read_b64_tr_b16 v[190:191], v244 offset:13632
  v_mfma_f32_32x32x16_bf16 v[128:143], v[220:223], a[164:167], v[128:143]
  ds_read_b64_tr_b16 v[196:197], v244 offset:13184
  ds_read_b64_tr_b16 v[198:199], v244 offset:13696
  v_mfma_f32_32x32x16_bf16 v[144:159], v[228:231], a[164:167], v[144:159]
  ds_read_b64_tr_b16 v[204:205], v244 offset:13248
  ds_read_b64_tr_b16 v[206:207], v244 offset:13760
  v_mfma_f32_32x32x16_bf16 v[160:175], v[236:239], a[164:167], v[160:175]
  buffer_load_dwordx4 v243, s[8:11], s33 offen offset:3264 lds
  s_add_u32 s33, s33, 65536
  s_and_b32 s33, s33, 0xfffff
  s_waitcnt lgkmcnt(9)
  v_mfma_f32_32x32x16_bf16 v[112:127], v[176:179], a[168:171], v[112:127]
  s_waitcnt vmcnt(27) lgkmcnt(0)
  s_barrier
  v_mfma_f32_32x32x16_bf16 v[128:143], v[184:187], a[168:171], v[128:143]
  ds_read_b64_tr_b16 v[208:209], v244 offset:17408
  ds_read_b64_tr_b16 v[210:211], v244 offset:17920
  ds_read_b64_tr_b16 v[216:217], v244 offset:17472
  buffer_load_dwordx4 a[240:243], v25, s[4:7], s32 offen offset:0 sc1
  v_mfma_f32_32x32x16_bf16 v[144:159], v[192:195], a[168:171], v[144:159]
  ds_read_b64_tr_b16 v[218:219], v244 offset:17984
  ds_read_b64_tr_b16 v[224:225], v244 offset:17536
  ds_read_b64_tr_b16 v[226:227], v244 offset:18048
  buffer_load_dwordx4 a[244:247], v25, s[4:7], s32 offen offset:1024 sc1
  v_mfma_f32_32x32x16_bf16 v[160:175], v[200:203], a[168:171], v[160:175]
  ds_read_b64_tr_b16 v[232:233], v244 offset:17600
  ds_read_b64_tr_b16 v[234:235], v244 offset:18112
  v_mfma_f32_32x32x16_bf16 v[112:127], v[180:183], a[172:175], v[112:127]
  ds_read_b64_tr_b16 v[212:213], v244 offset:21760
  ds_read_b64_tr_b16 v[214:215], v244 offset:22272
  ds_read_b64_tr_b16 v[220:221], v244 offset:21824
  buffer_load_dwordx4 a[248:251], v25, s[4:7], s32 offen offset:2048 sc1
  v_mfma_f32_32x32x16_bf16 v[128:143], v[188:191], a[172:175], v[128:143]
  ds_read_b64_tr_b16 v[222:223], v244 offset:22336
  ds_read_b64_tr_b16 v[228:229], v244 offset:21888
  ds_read_b64_tr_b16 v[230:231], v244 offset:22400
  v_mfma_f32_32x32x16_bf16 v[144:159], v[196:199], a[172:175], v[144:159]
  ds_read_b64_tr_b16 v[236:237], v244 offset:21952
  ds_read_b64_tr_b16 v[238:239], v244 offset:22464
  v_mfma_f32_32x32x16_bf16 v[160:175], v[204:207], a[172:175], v[160:175]
  buffer_load_dwordx4 a[252:255], v25, s[4:7], s32 offen offset:3072 sc1
  s_add_u32 s32, s32, 4096
  s_and_b32 s32, s32, 0xffff
  s_waitcnt lgkmcnt(10)
  v_mfma_f32_32x32x16_bf16 v[112:127], v[208:211], a[176:179], v[112:127]
  ds_read_b64_tr_b16 v[176:177], v244 offset:26112
  ds_read_b64_tr_b16 v[178:179], v244 offset:26624
  v_mfma_f32_32x32x16_bf16 v[128:143], v[216:219], a[176:179], v[128:143]
  ds_read_b64_tr_b16 v[184:185], v244 offset:26176
  ds_read_b64_tr_b16 v[186:187], v244 offset:26688
  s_add_u32 m0, s34, 0
  s_nop 0
  buffer_load_dwordx4 v240, s[8:11], s33 offen lds
  v_mfma_f32_32x32x16_bf16 v[144:159], v[224:227], a[176:179], v[144:159]
  ds_read_b64_tr_b16 v[192:193], v244 offset:26240
  ds_read_b64_tr_b16 v[194:195], v244 offset:26752
  ds_read_b64_tr_b16 v[200:201], v244 offset:26304
  buffer_load_dwordx4 v241, s[8:11], s33 offen offset:1088 lds
  s_waitcnt lgkmcnt(8)
  v_mfma_f32_32x32x16_bf16 v[160:175], v[232:235], a[176:179], v[160:175]
  ds_read_b64_tr_b16 v[202:203], v244 offset:26816
  ds_read_b64_tr_b16 v[180:181], v244 offset:30464
  ds_read_b64_tr_b16 v[182:183], v244 offset:30976
  v_mfma_f32_32x32x16_bf16 v[112:127], v[212:215], a[180:183], v[112:127]
  ds_read_b64_tr_b16 v[188:189], v244 offset:30528
  buffer_load_dwordx4 v242, s[8:11], s33 offen offset:2176 lds
  ds_read_b64_tr_b16 v[190:191], v244 offset:31040
  v_mfma_f32_32x32x16_bf16 v[128:143], v[220:223], a[180:183], v[128:143]
  ds_read_b64_tr_b16 v[196:197], v244 offset:30592
  ds_read_b64_tr_b16 v[198:199], v244 offset:31104
  v_mfma_f32_32x32x16_bf16 v[144:159], v[228:231], a[180:183], v[144:159]
  ds_read_b64_tr_b16 v[204:205], v244 offset:30656
  ds_read_b64_tr_b16 v[206:207], v244 offset:31168
  s_waitcnt lgkmcnt(12)
  v_mfma_f32_32x32x16_bf16 v[160:175], v[236:239], a[180:183], v[160:175]
  buffer_load_dwordx4 v243, s[8:11], s33 offen offset:3264 lds
  s_add_u32 s33, s33, 65536
  s_and_b32 s33, s33, 0xfffff
  v_mfma_f32_32x32x16_bf16 v[112:127], v[176:179], a[184:187], v[112:127]
  s_waitcnt vmcnt(26) lgkmcnt(0)
  s_barrier
  v_mfma_f32_32x32x16_bf16 v[128:143], v[184:187], a[184:187], v[128:143]
  ds_read_b64_tr_b16 v[208:209], v244 offset:34816
  ds_read_b64_tr_b16 v[210:211], v244 offset:35328
  ds_read_b64_tr_b16 v[216:217], v244 offset:34880
  buffer_load_dwordx4 a[160:163], v25, s[4:7], s32 offen offset:0 sc1
  v_mfma_f32_32x32x16_bf16 v[144:159], v[192:195], a[184:187], v[144:159]
  ds_read_b64_tr_b16 v[218:219], v244 offset:35392
  ds_read_b64_tr_b16 v[224:225], v244 offset:34944
  ds_read_b64_tr_b16 v[226:227], v244 offset:35456
  buffer_load_dwordx4 a[164:167], v25, s[4:7], s32 offen offset:1024 sc1
  v_mfma_f32_32x32x16_bf16 v[160:175], v[200:203], a[184:187], v[160:175]
  ds_read_b64_tr_b16 v[232:233], v244 offset:35008
  ds_read_b64_tr_b16 v[234:235], v244 offset:35520
  v_mfma_f32_32x32x16_bf16 v[112:127], v[180:183], a[188:191], v[112:127]
  ds_read_b64_tr_b16 v[212:213], v244 offset:39168
  ds_read_b64_tr_b16 v[214:215], v244 offset:39680
  ds_read_b64_tr_b16 v[220:221], v244 offset:39232
  buffer_load_dwordx4 a[168:171], v25, s[4:7], s32 offen offset:2048 sc1
  v_mfma_f32_32x32x16_bf16 v[128:143], v[188:191], a[188:191], v[128:143]
  ds_read_b64_tr_b16 v[222:223], v244 offset:39744
  ds_read_b64_tr_b16 v[228:229], v244 offset:39296
  ds_read_b64_tr_b16 v[230:231], v244 offset:39808
  v_mfma_f32_32x32x16_bf16 v[144:159], v[196:199], a[188:191], v[144:159]
  ds_read_b64_tr_b16 v[236:237], v244 offset:39360
  ds_read_b64_tr_b16 v[238:239], v244 offset:39872
  v_mfma_f32_32x32x16_bf16 v[160:175], v[204:207], a[188:191], v[160:175]
  buffer_load_dwordx4 a[172:175], v25, s[4:7], s32 offen offset:3072 sc1
  s_add_u32 s32, s32, 4096
  s_and_b32 s32, s32, 0xffff
  s_waitcnt lgkmcnt(10)
  v_mfma_f32_32x32x16_bf16 v[112:127], v[208:211], a[192:195], v[112:127]
  ds_read_b64_tr_b16 v[176:177], v244 offset:43520
  ds_read_b64_tr_b16 v[178:179], v244 offset:44032
  v_mfma_f32_32x32x16_bf16 v[128:143], v[216:219], a[192:195], v[128:143]
  ds_read_b64_tr_b16 v[184:185], v244 offset:43584
  ds_read_b64_tr_b16 v[186:187], v244 offset:44096
  s_add_u32 m0, s34, 17408
  s_nop 0
  buffer_load_dwordx4 v240, s[8:11], s33 offen lds
  v_mfma_f32_32x32x16_bf16 v[144:159], v[224:227], a[192:195], v[144:159]
  ds_read_b64_tr_b16 v[192:193], v244 offset:43648
  ds_read_b64_tr_b16 v[194:195], v244 offset:44160
  ds_read_b64_tr_b16 v[200:201], v244 offset:43712
  buffer_load_dwordx4 v241, s[8:11], s33 offen offset:1088 lds
  s_waitcnt lgkmcnt(8)
  v_mfma_f32_32x32x16_bf16 v[160:175], v[232:235], a[192:195], v[160:175]
  ds_read_b64_tr_b16 v[202:203], v244 offset:44224
  ds_read_b64_tr_b16 v[180:181], v244 offset:47872
  ds_read_b64_tr_b16 v[182:183], v244 offset:48384
  v_mfma_f32_32x32x16_bf16 v[112:127], v[212:215], a[196:199], v[112:127]
  ds_read_b64_tr_b16 v[188:189], v244 offset:47936
  buffer_load_dwordx4 v242, s[8:11], s33 offen offset:2176 lds
  ds_read_b64_tr_b16 v[190:191], v244 offset:48448
  v_mfma_f32_32x32x16_bf16 v[128:143], v[220:223], a[196:199], v[128:143]
  ds_read_b64_tr_b16 v[196:197], v244 offset:48000
  ds_read_b64_tr_b16 v[198:199], v244 offset:48512
  v_mfma_f32_32x32x16_bf16 v[144:159], v[228:231], a[196:199], v[144:159]
  ds_read_b64_tr_b16 v[204:205], v244 offset:48064
  ds_read_b64_tr_b16 v[206:207], v244 offset:48576
  s_waitcnt lgkmcnt(12)
  v_mfma_f32_32x32x16_bf16 v[160:175], v[236:239], a[196:199], v[160:175]
  buffer_load_dwordx4 v243, s[8:11], s33 offen offset:3264 lds
  s_add_u32 s33, s33, 65536
  s_and_b32 s33, s33, 0xfffff
  v_mfma_f32_32x32x16_bf16 v[112:127], v[176:179], a[200:203], v[112:127]
  s_waitcnt vmcnt(30) lgkmcnt(0)
  s_barrier
  v_mfma_f32_32x32x16_bf16 v[128:143], v[184:187], a[200:203], v[128:143]
  ds_read_b64_tr_b16 v[208:209], v245 offset:0
  ds_read_b64_tr_b16 v[210:211], v245 offset:512
  ds_read_b64_tr_b16 v[216:217], v245 offset:64
  buffer_load_dwordx4 a[176:179], v25, s[4:7], s32 offen offset:0 sc1
  v_mfma_f32_32x32x16_bf16 v[144:159], v[192:195], a[200:203], v[144:159]
  ds_read_b64_tr_b16 v[218:219], v245 offset:576
  ds_read_b64_tr_b16 v[224:225], v245 offset:128
  ds_read_b64_tr_b16 v[226:227], v245 offset:640
  buffer_load_dwordx4 a[180:183], v25, s[4:7], s32 offen offset:1024 sc1
  v_mfma_f32_32x32x16_bf16 v[160:175], v[200:203], a[200:203], v[160:175]
  ds_read_b64_tr_b16 v[232:233], v245 offset:192
  ds_read_b64_tr_b16 v[234:235], v245 offset:704
  v_mfma_f32_32x32x16_bf16 v[112:127], v[180:183], a[204:207], v[112:127]
  ds_read_b64_tr_b16 v[212:213], v245 offset:4352
  ds_read_b64_tr_b16 v[214:215], v245 offset:4864
  ds_read_b64_tr_b16 v[220:221], v245 offset:4416
  buffer_load_dwordx4 a[184:187], v25, s[4:7], s32 offen offset:2048 sc1
  v_mfma_f32_32x32x16_bf16 v[128:143], v[188:191], a[204:207], v[128:143]
  ds_read_b64_tr_b16 v[222:223], v245 offset:4928
  ds_read_b64_tr_b16 v[228:229], v245 offset:4480
  ds_read_b64_tr_b16 v[230:231], v245 offset:4992
  v_mfma_f32_32x32x16_bf16 v[144:159], v[196:199], a[204:207], v[144:159]
  ds_read_b64_tr_b16 v[236:237], v245 offset:4544
  ds_read_b64_tr_b16 v[238:239], v245 offset:5056
  v_mfma_f32_32x32x16_bf16 v[160:175], v[204:207], a[204:207], v[160:175]
  buffer_load_dwordx4 a[188:191], v25, s[4:7], s32 offen offset:3072 sc1
  s_add_u32 s32, s32, 4096
  s_and_b32 s32, s32, 0xffff
  s_waitcnt lgkmcnt(10)
  v_mfma_f32_32x32x16_bf16 v[112:127], v[208:211], a[208:211], v[112:127]
  ds_read_b64_tr_b16 v[176:177], v245 offset:8704
  ds_read_b64_tr_b16 v[178:179], v245 offset:9216
  v_mfma_f32_32x32x16_bf16 v[128:143], v[216:219], a[208:211], v[128:143]
  ds_read_b64_tr_b16 v[184:185], v245 offset:8768
  ds_read_b64_tr_b16 v[186:187], v245 offset:9280
  s_add_u32 m0, s34, 34816
  s_nop 0
  buffer_load_dwordx4 v240, s[8:11], s33 offen lds
  v_mfma_f32_32x32x16_bf16 v[144:159], v[224:227], a[208:211], v[144:159]
  ds_read_b64_tr_b16 v[192:193], v245 offset:8832
  ds_read_b64_tr_b16 v[194:195], v245 offset:9344
  ds_read_b64_tr_b16 v[200:201], v245 offset:8896
  buffer_load_dwordx4 v241, s[8:11], s33 offen offset:1088 lds
  s_waitcnt lgkmcnt(8)
  v_mfma_f32_32x32x16_bf16 v[160:175], v[232:235], a[208:211], v[160:175]
  ds_read_b64_tr_b16 v[202:203], v245 offset:9408
  ds_read_b64_tr_b16 v[180:181], v245 offset:13056
  ds_read_b64_tr_b16 v[182:183], v245 offset:13568
  v_mfma_f32_32x32x16_bf16 v[112:127], v[212:215], a[212:215], v[112:127]
  ds_read_b64_tr_b16 v[188:189], v245 offset:13120
  buffer_load_dwordx4 v242, s[8:11], s33 offen offset:2176 lds
  ds_read_b64_tr_b16 v[190:191], v245 offset:13632
  v_mfma_f32_32x32x16_bf16 v[128:143], v[220:223], a[212:215], v[128:143]
  ds_read_b64_tr_b16 v[196:197], v245 offset:13184
  ds_read_b64_tr_b16 v[198:199], v245 offset:13696
  v_mfma_f32_32x32x16_bf16 v[144:159], v[228:231], a[212:215], v[144:159]
  ds_read_b64_tr_b16 v[204:205], v245 offset:13248
  ds_read_b64_tr_b16 v[206:207], v245 offset:13760
  s_waitcnt lgkmcnt(12)
  v_mfma_f32_32x32x16_bf16 v[160:175], v[236:239], a[212:215], v[160:175]
  buffer_load_dwordx4 v243, s[8:11], s33 offen offset:3264 lds
  s_add_u32 s33, s33, 65536
  s_and_b32 s33, s33, 0xfffff
  v_mfma_f32_32x32x16_bf16 v[112:127], v[176:179], a[216:219], v[112:127]
  s_waitcnt vmcnt(34) lgkmcnt(0)
  s_barrier
  v_mfma_f32_32x32x16_bf16 v[128:143], v[184:187], a[216:219], v[128:143]
  ds_read_b64_tr_b16 v[208:209], v245 offset:17408
  ds_read_b64_tr_b16 v[210:211], v245 offset:17920
  ds_read_b64_tr_b16 v[216:217], v245 offset:17472
  buffer_load_dwordx4 a[192:195], v25, s[4:7], s32 offen offset:0 sc1
  v_mfma_f32_32x32x16_bf16 v[144:159], v[192:195], a[216:219], v[144:159]
  ds_read_b64_tr_b16 v[218:219], v245 offset:17984
  ds_read_b64_tr_b16 v[224:225], v245 offset:17536
  ds_read_b64_tr_b16 v[226:227], v245 offset:18048
  buffer_load_dwordx4 a[196:199], v25, s[4:7], s32 offen offset:1024 sc1
  v_mfma_f32_32x32x16_bf16 v[160:175], v[200:203], a[216:219], v[160:175]
  ds_read_b64_tr_b16 v[232:233], v245 offset:17600
  ds_read_b64_tr_b16 v[234:235], v245 offset:18112
  v_mfma_f32_32x32x16_bf16 v[112:127], v[180:183], a[220:223], v[112:127]
  ds_read_b64_tr_b16 v[212:213], v245 offset:21760
  ds_read_b64_tr_b16 v[214:215], v245 offset:22272
  ds_read_b64_tr_b16 v[220:221], v245 offset:21824
  buffer_load_dwordx4 a[200:203], v25, s[4:7], s32 offen offset:2048 sc1
  v_mfma_f32_32x32x16_bf16 v[128:143], v[188:191], a[220:223], v[128:143]
  ds_read_b64_tr_b16 v[222:223], v245 offset:22336
  ds_read_b64_tr_b16 v[228:229], v245 offset:21888
  ds_read_b64_tr_b16 v[230:231], v245 offset:22400
  v_mfma_f32_32x32x16_bf16 v[144:159], v[196:199], a[220:223], v[144:159]
  ds_read_b64_tr_b16 v[236:237], v245 offset:21952
  ds_read_b64_tr_b16 v[238:239], v245 offset:22464
  v_mfma_f32_32x32x16_bf16 v[160:175], v[204:207], a[220:223], v[160:175]
  buffer_load_dwordx4 a[204:207], v25, s[4:7], s32 offen offset:3072 sc1
  s_add_u32 s32, s32, 4096
  s_and_b32 s32, s32, 0xffff
  s_waitcnt lgkmcnt(10)
  v_mfma_f32_32x32x16_bf16 v[112:127], v[208:211], a[224:227], v[112:127]
  ds_read_b64_tr_b16 v[176:177], v245 offset:26112
  ds_read_b64_tr_b16 v[178:179], v245 offset:26624
  v_mfma_f32_32x32x16_bf16 v[128:143], v[216:219], a[224:227], v[128:143]
  ds_read_b64_tr_b16 v[184:185], v245 offset:26176
  ds_read_b64_tr_b16 v[186:187], v245 offset:26688
  s_add_u32 m0, s34, 52224
  s_nop 0
  buffer_load_dwordx4 v240, s[8:11], s33 offen lds
  v_mfma_f32_32x32x16_bf16 v[144:159], v[224:227], a[224:227], v[144:159]
  ds_read_b64_tr_b16 v[192:193], v245 offset:26240
  ds_read_b64_tr_b16 v[194:195], v245 offset:26752
  ds_read_b64_tr_b16 v[200:201], v245 offset:26304
  buffer_load_dwordx4 v241, s[8:11], s33 offen offset:1088 lds
  s_waitcnt lgkmcnt(8)
  v_mfma_f32_32x32x16_bf16 v[160:175], v[232:235], a[224:227], v[160:175]
  ds_read_b64_tr_b16 v[202:203], v245 offset:26816
  ds_read_b64_tr_b16 v[180:181], v245 offset:30464
  ds_read_b64_tr_b16 v[182:183], v245 offset:30976
  v_mfma_f32_32x32x16_bf16 v[112:127], v[212:215], a[228:231], v[112:127]
  ds_read_b64_tr_b16 v[188:189], v245 offset:30528
  buffer_load_dwordx4 v242, s[8:11], s33 offen offset:2176 lds
  ds_read_b64_tr_b16 v[190:191], v245 offset:31040
  v_mfma_f32_32x32x16_bf16 v[128:143], v[220:223], a[228:231], v[128:143]
  ds_read_b64_tr_b16 v[196:197], v245 offset:30592
  ds_read_b64_tr_b16 v[198:199], v245 offset:31104
  v_mfma_f32_32x32x16_bf16 v[144:159], v[228:231], a[228:231], v[144:159]
  ds_read_b64_tr_b16 v[204:205], v245 offset:30656
  ds_read_b64_tr_b16 v[206:207], v245 offset:31168
  s_waitcnt lgkmcnt(12)
  v_mfma_f32_32x32x16_bf16 v[160:175], v[236:239], a[228:231], v[160:175]
  buffer_load_dwordx4 v243, s[8:11], s33 offen offset:3264 lds
  s_add_u32 s33, s33, 65536
  s_and_b32 s33, s33, 0xfffff
  v_mfma_f32_32x32x16_bf16 v[112:127], v[176:179], a[232:235], v[112:127]
  s_waitcnt vmcnt(28) lgkmcnt(0)
  s_barrier
  v_mfma_f32_32x32x16_bf16 v[128:143], v[184:187], a[232:235], v[128:143]
  ds_read_b64_tr_b16 v[208:209], v245 offset:34816
  ds_read_b64_tr_b16 v[210:211], v245 offset:35328
  s_cmp_eq_u32 s28, 0
  s_cbranch_scc1 L_bflag
L_ret6:
  ds_read_b64_tr_b16 v[216:217], v245 offset:34880
  v_mfma_f32_32x32x16_bf16 v[144:159], v[192:195], a[232:235], v[144:159]
  ds_read_b64_tr_b16 v[218:219], v245 offset:35392
  ds_read_b64_tr_b16 v[224:225], v245 offset:34944
  buffer_load_dwordx4 a[208:211], v25, s[4:7], s32 offen offset:0 sc1
  ds_read_b64_tr_b16 v[226:227], v245 offset:35456
  v_mfma_f32_32x32x16_bf16 v[160:175], v[200:203], a[232:235], v[160:175]
  ds_read_b64_tr_b16 v[232:233], v245 offset:35008
  ds_read_b64_tr_b16 v[234:235], v245 offset:35520
  buffer_load_dwordx4 a[212:215], v25, s[4:7], s32 offen offset:1024 sc1
  v_mfma_f32_32x32x16_bf16 v[112:127], v[180:183], a[236:239], v[112:127]
  ds_read_b64_tr_b16 v[212:213], v245 offset:39168
  ds_read_b64_tr_b16 v[214:215], v245 offset:39680
  ds_read_b64_tr_b16 v[220:221], v245 offset:39232
  v_mfma_f32_32x32x16_bf16 v[128:143], v[188:191], a[236:239], v[128:143]
  ds_read_b64_tr_b16 v[222:223], v245 offset:39744
  ds_read_b64_tr_b16 v[228:229], v245 offset:39296
  buffer_load_dwordx4 a[216:219], v25, s[4:7], s32 offen offset:2048 sc1
  ds_read_b64_tr_b16 v[230:231], v245 offset:39808
  v_mfma_f32_32x32x16_bf16 v[144:159], v[196:199], a[236:239], v[144:159]
  ds_read_b64_tr_b16 v[236:237], v245 offset:39360
  ds_read_b64_tr_b16 v[238:239], v245 offset:39872
  v_mfma_f32_32x32x16_bf16 v[160:175], v[204:207], a[236:239], v[160:175]
  buffer_load_dwordx4 a[220:223], v25, s[4:7], s32 offen offset:3072 sc1
  s_add_u32 s32, s32, 4096
  s_and_b32 s32, s32, 0xffff
  s_waitcnt lgkmcnt(10)
  v_mfma_f32_32x32x16_bf16 v[112:127], v[208:211], a[240:243], v[112:127]
  ds_read_b64_tr_b16 v[176:177], v245 offset:43520
  ds_read_b64_tr_b16 v[178:179], v245 offset:44032
  v_mfma_f32_32x32x16_bf16 v[128:143], v[216:219], a[240:243], v[128:143]
  ds_read_b64_tr_b16 v[184:185], v245 offset:43584
  ds_read_b64_tr_b16 v[186:187], v245 offset:44096
  s_add_u32 m0, s34, 69632
  s_nop 0
  buffer_load_dwordx4 v240, s[8:11], s33 offen lds
  v_mfma_f32_32x32x16_bf16 v[144:159], v[224:227], a[240:243], v[144:159]
  ds_read_b64_tr_b16 v[192:193], v245 offset:43648
  ds_read_b64_tr_b16 v[194:195], v245 offset:44160
  ds_read_b64_tr_b16 v[200:201], v245 offset:43712
  buffer_load_dwordx4 v241, s[8:11], s33 offen offset:1088 lds
  s_waitcnt lgkmcnt(8)
  v_mfma_f32_32x32x16_bf16 v[160:175], v[232:235], a[240:243], v[160:175]
  ds_read_b64_tr_b16 v[202:203], v245 offset:44224
  ds_read_b64_tr_b16 v[180:181], v245 offset:47872
  ds_read_b64_tr_b16 v[182:183], v245 offset:48384
  v_mfma_f32_32x32x16_bf16 v[112:127], v[212:215], a[244:247], v[112:127]
  ds_read_b64_tr_b16 v[188:189], v245 offset:47936
  buffer_load_dwordx4 v242, s[8:11], s33 offen offset:2176 lds
  ds_read_b64_tr_b16 v[190:191], v245 offset:48448
  v_mfma_f32_32x32x16_bf16 v[128:143], v[220:223], a[244:247], v[128:143]
  ds_read_b64_tr_b16 v[196:197], v245 offset:48000
  ds_read_b64_tr_b16 v[198:199], v245 offset:48512
  v_mfma_f32_32x32x16_bf16 v[144:159], v[228:231], a[244:247], v[144:159]
  ds_read_b64_tr_b16 v[204:205], v245 offset:48064
  ds_read_b64_tr_b16 v[206:207], v245 offset:48576
  s_waitcnt lgkmcnt(12)
  v_mfma_f32_32x32x16_bf16 v[160:175], v[236:239], a[244:247], v[160:175]
  buffer_load_dwordx4 v243, s[8:11], s33 offen offset:3264 lds
  s_add_u32 s33, s33, 65536
  s_and_b32 s33, s33, 0xfffff
  v_mfma_f32_32x32x16_bf16 v[112:127], v[176:179], a[248:251], v[112:127]
  s_waitcnt vmcnt(28) lgkmcnt(0)
  s_barrier
  v_mfma_f32_32x32x16_bf16 v[128:143], v[184:187], a[248:251], v[128:143]
  ds_read_b64_tr_b16 v[208:209], v244 offset:0
  ds_read_b64_tr_b16 v[210:211], v244 offset:512
  ds_read_b64_tr_b16 v[216:217], v244 offset:64
  buffer_load_dwordx4 a[224:227], v25, s[4:7], s32 offen offset:0 sc1
  v_mfma_f32_32x32x16_bf16 v[144:159], v[192:195], a[248:251], v[144:159]
  ds_read_b64_tr_b16 v[218:219], v244 offset:576
  ds_read_b64_tr_b16 v[224:225], v244 offset:128
  ds_read_b64_tr_b16 v[226:227], v244 offset:640
  buffer_load_dwordx4 a[228:231], v25, s[4:7], s32 offen offset:1024 sc1
  v_mfma_f32_32x32x16_bf16 v[160:175], v[200:203], a[248:251], v[160:175]
  ds_read_b64_tr_b16 v[232:233], v244 offset:192
  ds_read_b64_tr_b16 v[234:235], v244 offset:704
  v_mfma_f32_32x32x16_bf16 v[112:127], v[180:183], a[252:255], v[112:127]
  ds_read_b64_tr_b16 v[212:213], v244 offset:4352
  ds_read_b64_tr_b16 v[214:215], v244 offset:4864
  ds_read_b64_tr_b16 v[220:221], v244 offset:4416
  buffer_load_dwordx4 a[232:235], v25, s[4:7], s32 offen offset:2048 sc1
  v_mfma_f32_32x32x16_bf16 v[128:143], v[188:191], a[252:255], v[128:143]
  ds_read_b64_tr_b16 v[222:223], v244 offset:4928
  ds_read_b64_tr_b16 v[228:229], v244 offset:4480
  ds_read_b64_tr_b16 v[230:231], v244 offset:4992
  v_mfma_f32_32x32x16_bf16 v[144:159], v[196:199], a[252:255], v[144:159]
  ds_read_b64_tr_b16 v[236:237], v244 offset:4544
  ds_read_b64_tr_b16 v[238:239], v244 offset:5056
  v_mfma_f32_32x32x16_bf16 v[160:175], v[204:207], a[252:255], v[160:175]
  buffer_load_dwordx4 a[236:239], v25, s[4:7], s32 offen offset:3072 sc1
  s_add_u32 s32, s32, 4096
  s_and_b32 s32, s32, 0xffff
  s_waitcnt lgkmcnt(10)
  v_mfma_f32_32x32x16_bf16 v[112:127], v[208:211], a[160:163], v[112:127]
  ds_read_b64_tr_b16 v[176:177], v244 offset:8704
  ds_read_b64_tr_b16 v[178:179], v244 offset:9216
  v_mfma_f32_32x32x16_bf16 v[128:143], v[216:219], a[160:163], v[128:143]
  ds_read_b64_tr_b16 v[184:185], v244 offset:8768
  ds_read_b64_tr_b16 v[186:187], v244 offset:9280
  s_add_u32 m0, s34, 87040
  s_nop 0
  buffer_load_dwordx4 v240, s[8:11], s33 offen lds
  v_mfma_f32_32x32x16_bf16 v[144:159], v[224:227], a[160:163], v[144:159]
  ds_read_b64_tr_b16 v[192:193], v244 offset:8832
  ds_read_b64_tr_b16 v[194:195], v244 offset:9344
  ds_read_b64_tr_b16 v[200:201], v244 offset:8896
  buffer_load_dwordx4 v241, s[8:11], s33 offen offset:1088 lds
  s_waitcnt lgkmcnt(8)
  v_mfma_f32_32x32x16_bf16 v[160:175], v[232:235], a[160:163], v[160:175]
  ds_read_b64_tr_b16 v[202:203], v244 offset:9408
  ds_read_b64_tr_b16 v[180:181], v244 offset:13056
  ds_read_b64_tr_b16 v[182:183], v244 offset:13568
  v_mfma_f32_32x32x16_bf16 v[112:127], v[212:215], a[164:167], v[112:127]
  ds_read_b64_tr_b16 v[188:189], v244 offset:13120
  buffer_load_dwordx4 v242, s[8:11], s33 offen offset:2176 lds
  ds_read_b64_tr_b16 v[190:191], v244 offset:13632
  v_mfma_f32_32x32x16_bf16 v[128:143], v[220:223], a[164:167], v[128:143]
  ds_read_b64_tr_b16 v[196:197], v244 offset:13184
  ds_read_b64_tr_b16 v[198:199], v244 offset:13696
  v_mfma_f32_32x32x16_bf16 v[144:159], v[228:231], a[164:167], v[144:159]
  ds_read_b64_tr_b16 v[204:205], v244 offset:13248
  ds_read_b64_tr_b16 v[206:207], v244 offset:13760
  s_waitcnt lgkmcnt(12)
  v_mfma_f32_32x32x16_bf16 v[160:175], v[236:239], a[164:167], v[160:175]
  buffer_load_dwordx4 v243, s[8:11], s33 offen offset:3264 lds
  s_add_u32 s33, s33, 65536
  s_and_b32 s33, s33, 0xfffff
  v_mfma_f32_32x32x16_bf16 v[112:127], v[176:179], a[168:171], v[112:127]
  s_waitcnt vmcnt(28) lgkmcnt(0)
  s_barrier
  v_mfma_f32_32x32x16_bf16 v[128:143], v[184:187], a[168:171], v[128:143]
  ds_read_b64_tr_b16 v[208:209], v244 offset:17408
  ds_read_b64_tr_b16 v[210:211], v244 offset:17920
  buffer_load_dwordx4 a[240:243], v25, s[4:7], s32 offen offset:0 sc1
  ds_read_b64_tr_b16 v[216:217], v244 offset:17472
  v_mfma_f32_32x32x16_bf16 v[144:159], v[192:195], a[168:171], v[144:159]
  ds_read_b64_tr_b16 v[218:219], v244 offset:17984
  ds_read_b64_tr_b16 v[224:225], v244 offset:17536
  buffer_load_dwordx4 a[244:247], v25, s[4:7], s32 offen offset:1024 sc1
  ds_read_b64_tr_b16 v[226:227], v244 offset:18048
  v_mfma_f32_32x32x16_bf16 v[160:175], v[200:203], a[168:171], v[160:175]
  ds_read_b64_tr_b16 v[232:233], v244 offset:17600
  ds_read_b64_tr_b16 v[234:235], v244 offset:18112
  buffer_load_dwordx4 a[248:251], v25, s[4:7], s32 offen offset:2048 sc1
  v_mfma_f32_32x32x16_bf16 v[112:127], v[180:183], a[172:175], v[112:127]
  ds_read_b64_tr_b16 v[212:213], v244 offset:21760
  ds_read_b64_tr_b16 v[214:215], v244 offset:22272
  ds_read_b64_tr_b16 v[220:221], v244 offset:21824
  v_mfma_f32_32x32x16_bf16 v[128:143], v[188:191], a[172:175], v[128:143]
  ds_read_b64_tr_b16 v[222:223], v244 offset:22336
  ds_read_b64_tr_b16 v[228:229], v244 offset:21888
  v_mfma_f32_32x32x16_bf16 v[144:159], v[196:199], a[172:175], v[144:159]
  ds_read_b64_tr_b16 v[230:231], v244 offset:22400
  ds_read_b64_tr_b16 v[236:237], v244 offset:21952
  buffer_load_dwordx4 a[252:255], v25, s[4:7], s32 offen offset:3072 sc1
  s_add_u32 s32, s32, 4096
  s_and_b32 s32, s32, 0xffff
  ds_read_b64_tr_b16 v[238:239], v244 offset:22464
  v_mfma_f32_32x32x16_bf16 v[160:175], v[204:207], a[172:175], v[160:175]
  v_and_b32 v12, 3, v1
  v_lshlrev_b32 v12, 10, v12
  s_and_b32 s40, s2, 0xf9
  s_lshl_b32 s40, s40, 9
  s_add_u32 s40, s40, 256
  buffer_load_dword v250, v12, s[80:83], s40 offen sc1
  s_waitcnt lgkmcnt(7)
  v_mfma_f32_32x32x16_bf16 v[112:127], v[208:211], a[176:179], v[112:127]
  ds_read_b64_tr_b16 v[176:177], v244 offset:26112
  ds_read_b64_tr_b16 v[178:179], v244 offset:26624
  v_mfma_f32_32x32x16_bf16 v[128:143], v[216:219], a[176:179], v[128:143]
  ds_read_b64_tr_b16 v[184:185], v244 offset:26176
  ds_read_b64_tr_b16 v[186:187], v244 offset:26688
  s_add_u32 m0, s34, 0
  s_nop 0
  buffer_load_dwordx4 v240, s[8:11], s33 offen lds
  v_mfma_f32_32x32x16_bf16 v[144:159], v[224:227], a[176:179], v[144:159]
  ds_read_b64_tr_b16 v[192:193], v244 offset:26240
  ds_read_b64_tr_b16 v[194:195], v244 offset:26752
  ds_read_b64_tr_b16 v[200:201], v244 offset:26304
  buffer_load_dwordx4 v241, s[8:11], s33 offen offset:1088 lds
  v_mfma_f32_32x32x16_bf16 v[160:175], v[232:235], a[176:179], v[160:175]
  ds_read_b64_tr_b16 v[202:203], v244 offset:26816
  ds_read_b64_tr_b16 v[180:181], v244 offset:30464
  ds_read_b64_tr_b16 v[182:183], v244 offset:30976
  s_waitcnt lgkmcnt(10)
  v_mfma_f32_32x32x16_bf16 v[112:127], v[212:215], a[180:183], v[112:127]
  ds_read_b64_tr_b16 v[188:189], v244 offset:30528
  buffer_load_dwordx4 v242, s[8:11], s33 offen offset:2176 lds
  ds_read_b64_tr_b16 v[190:191], v244 offset:31040
  v_mfma_f32_32x32x16_bf16 v[128:143], v[220:223], a[180:183], v[128:143]
  ds_read_b64_tr_b16 v[196:197], v244 offset:30592
  ds_read_b64_tr_b16 v[198:199], v244 offset:31104
  v_mfma_f32_32x32x16_bf16 v[144:159], v[228:231], a[180:183], v[144:159]
  ds_read_b64_tr_b16 v[204:205], v244 offset:30656
  ds_read_b64_tr_b16 v[206:207], v244 offset:31168
  v_mfma_f32_32x32x16_bf16 v[160:175], v[236:239], a[180:183], v[160:175]
  buffer_load_dwordx4 v243, s[8:11], s33 offen offset:3264 lds
  s_add_u32 s33, s33, 65536
  s_and_b32 s33, s33, 0xfffff
  s_waitcnt lgkmcnt(9)
  v_mfma_f32_32x32x16_bf16 v[112:127], v[176:179], a[184:187], v[112:127]
  s_waitcnt vmcnt(29) lgkmcnt(0)
  s_barrier
  v_mfma_f32_32x32x16_bf16 v[128:143], v[184:187], a[184:187], v[128:143]
  ds_read_b64_tr_b16 v[208:209], v244 offset:34816
  ds_read_b64_tr_b16 v[210:211], v244 offset:35328
  ds_read_b64_tr_b16 v[216:217], v244 offset:34880
  buffer_load_dwordx4 a[160:163], v25, s[4:7], s32 offen offset:0 sc1
  v_mfma_f32_32x32x16_bf16 v[144:159], v[192:195], a[184:187], v[144:159]
  ds_read_b64_tr_b16 v[218:219], v244 offset:35392
  ds_read_b64_tr_b16 v[224:225], v244 offset:34944
  ds_read_b64_tr_b16 v[226:227], v244 offset:35456
  buffer_load_dwordx4 a[164:167], v25, s[4:7], s32 offen offset:1024 sc1
  v_mfma_f32_32x32x16_bf16 v[160:175], v[200:203], a[184:187], v[160:175]
  ds_read_b64_tr_b16 v[232:233], v244 offset:35008
  ds_read_b64_tr_b16 v[234:235], v244 offset:35520
  v_mfma_f32_32x32x16_bf16 v[112:127], v[180:183], a[188:191], v[112:127]
  ds_read_b64_tr_b16 v[212:213], v244 offset:39168
  ds_read_b64_tr_b16 v[214:215], v244 offset:39680
  ds_read_b64_tr_b16 v[220:221], v244 offset:39232
  buffer_load_dwordx4 a[168:171], v25, s[4:7], s32 offen offset:2048 sc1
  v_mfma_f32_32x32x16_bf16 v[128:143], v[188:191], a[188:191], v[128:143]
  ds_read_b64_tr_b16 v[222:223], v244 offset:39744
  ds_read_b64_tr_b16 v[228:229], v244 offset:39296
  ds_read_b64_tr_b16 v[230:231], v244 offset:39808
  v_mfma_f32_32x32x16_bf16 v[144:159], v[196:199], a[188:191], v[144:159]
  ds_read_b64_tr_b16 v[236:237], v244 offset:39360
  ds_read_b64_tr_b16 v[238:239], v244 offset:39872
  v_mfma_f32_32x32x16_bf16 v[160:175], v[204:207], a[188:191], v[160:175]
  buffer_load_dwordx4 a[172:175], v25, s[4:7], s32 offen offset:3072 sc1
  s_add_u32 s32, s32, 4096
  s_and_b32 s32, s32, 0xffff
  s_waitcnt lgkmcnt(10)
  v_mfma_f32_32x32x16_bf16 v[112:127], v[208:211], a[192:195], v[112:127]
  ds_read_b64_tr_b16 v[176:177], v244 offset:43520
  ds_read_b64_tr_b16 v[178:179], v244 offset:44032
  v_mfma_f32_32x32x16_bf16 v[128:143], v[216:219], a[192:195], v[128:143]
  ds_read_b64_tr_b16 v[184:185], v244 offset:43584
  s_lshl_b32 s44, s68, 17
  s_add_u32 s42, s42, s44
  s_add_u32 s44, s68, 1
  s_and_b32 s44, s44, 3
  s_lshl_b32 s44, s44, 13
  s_add_u32 s35, s44, s42
  s_add_u32 s44, s68, 2
  s_and_b32 s44, s44, 3
  s_lshl_b32 s44, s44, 13
  s_add_u32 s36, s44, s42
  s_add_u32 s44, s68, 3
  s_and_b32 s44, s44, 3
  s_lshl_b32 s44, s44, 13
  s_add_u32 s37, s44, s42
  ds_read_b64_tr_b16 v[186:187], v244 offset:44096
  v_mfma_f32_32x32x16_bf16 v[144:159], v[224:227], a[192:195], v[144:159]
  ds_read_b64_tr_b16 v[192:193], v244 offset:43648
  ds_read_b64_tr_b16 v[194:195], v244 offset:44160
  s_waitcnt vmcnt(8)
  v_cmp_ne_u32 vcc, 1, v250
  ds_read_b64_tr_b16 v[200:201], v244 offset:43712
  s_waitcnt lgkmcnt(4)
  v_mfma_f32_32x32x16_bf16 v[160:175], v[232:235], a[192:195], v[160:175]
  ds_read_b64_tr_b16 v[202:203], v244 offset:44224
  s_nop 0
  s_cbranch_vccnz L_bspin
L_bspin_ret:
  ds_read_b64_tr_b16 v[180:181], v244 offset:47872
  v_mfma_f32_32x32x16_bf16 v[112:127], v[212:215], a[196:199], v[112:127]
  ds_read_b64_tr_b16 v[182:183], v244 offset:48384
  ds_read_b64_tr_b16 v[188:189], v244 offset:47936
  s_add_u32 m0, s34, 17408
  s_nop 0
  buffer_load_dwordx4 v240, s[8:11], s33 offen lds
  v_mfma_f32_32x32x16_bf16 v[128:143], v[220:223], a[196:199], v[128:143]
  ds_read_b64_tr_b16 v[190:191], v244 offset:48448
  ds_read_b64_tr_b16 v[196:197], v244 offset:48000
  buffer_load_dwordx4 v241, s[8:11], s33 offen offset:1088 lds
  ds_read_b64_tr_b16 v[198:199], v244 offset:48512
  v_mfma_f32_32x32x16_bf16 v[144:159], v[228:231], a[196:199], v[144:159]
  ds_read_b64_tr_b16 v[204:205], v244 offset:48064
  buffer_load_dwordx4 v242, s[8:11], s33 offen offset:2176 lds
  ds_read_b64_tr_b16 v[206:207], v244 offset:48576
  v_mfma_f32_32x32x16_bf16 v[160:175], v[236:239], a[196:199], v[160:175]
  buffer_load_dwordx4 v243, s[8:11], s33 offen offset:3264 lds
  s_add_u32 s33, s33, 65536
  s_and_b32 s33, s33, 0xfffff
  v_mfma_f32_32x32x16_bf16 v[112:127], v[176:179], a[200:203], v[112:127]
  s_waitcnt vmcnt(29) lgkmcnt(0)
  s_barrier
  v_mfma_f32_32x32x16_bf16 v[128:143], v[184:187], a[200:203], v[128:143]
  ds_read_b64_tr_b16 v[208:209], v245 offset:0
  ds_read_b64_tr_b16 v[210:211], v245 offset:512
  buffer_load_dwordx4 v[72:75], v25, s[24:27], s35 offen offset:0 sc1
  ds_read_b64_tr_b16 v[216:217], v245 offset:64
  v_mfma_f32_32x32x16_bf16 v[144:159], v[192:195], a[200:203], v[144:159]
  ds_read_b64_tr_b16 v[218:219], v245 offset:576
  buffer_load_dwordx4 v[76:79], v25, s[24:27], s35 offen offset:1024 sc1
  ds_read_b64_tr_b16 v[224:225], v245 offset:128
  v_mfma_f32_32x32x16_bf16 v[160:175], v[200:203], a[200:203], v[160:175]
  ds_read_b64_tr_b16 v[226:227], v245 offset:640
  buffer_load_dwordx4 v[80:83], v25, s[24:27], s36 offen offset:0 sc1
  ds_read_b64_tr_b16 v[232:233], v245 offset:192
  buffer_load_dwordx4 v[84:87], v25, s[24:27], s36 offen offset:1024 sc1
  ds_read_b64_tr_b16 v[234:235], v245 offset:704
  v_mfma_f32_32x32x16_bf16 v[112:127], v[180:183], a[204:207], v[112:127]
  ds_read_b64_tr_b16 v[212:213], v245 offset:4352
  buffer_load_dwordx4 v[88:91], v25, s[24:27], s37 offen offset:0 sc1
  ds_read_b64_tr_b16 v[214:215], v245 offset:4864
  v_mfma_f32_32x32x16_bf16 v[128:143], v[188:191], a[204:207], v[128:143]
  ds_read_b64_tr_b16 v[220:221], v245 offset:4416
  ds_read_b64_tr_b16 v[222:223], v245 offset:4928
  buffer_load_dwordx4 v[92:95], v25, s[24:27], s37 offen offset:1024 sc1
  ds_read_b64_tr_b16 v[228:229], v245 offset:4480
  buffer_load_dwordx4 a[176:179], v25, s[4:7], s32 offen offset:0 sc1
  v_mfma_f32_32x32x16_bf16 v[144:159], v[196:199], a[204:207], v[144:159]
  ds_read_b64_tr_b16 v[230:231], v245 offset:4992
  ds_read_b64_tr_b16 v[236:237], v245 offset:4544
  buffer_load_dwordx4 a[180:183], v25, s[4:7], s32 offen offset:1024 sc1
  ds_read_b64_tr_b16 v[238:239], v245 offset:5056
  v_mfma_f32_32x32x16_bf16 v[160:175], v[204:207], a[204:207], v[160:175]
  buffer_load_dwordx4 a[184:187], v25, s[4:7], s32 offen offset:2048 sc1
  buffer_load_dwordx4 a[188:191], v25, s[4:7], s32 offen offset:3072 sc1
  s_add_u32 s32, s32, 4096
  s_and_b32 s32, s32, 0xffff
  s_waitcnt lgkmcnt(8)
  v_mfma_f32_32x32x16_bf16 v[112:127], v[208:211], a[208:211], v[112:127]
  ds_read_b64_tr_b16 v[176:177], v245 offset:8704
  ds_read_b64_tr_b16 v[178:179], v245 offset:9216
  v_mfma_f32_32x32x16_bf16 v[128:143], v[216:219], a[208:211], v[128:143]
  ds_read_b64_tr_b16 v[184:185], v245 offset:8768
  ds_read_b64_tr_b16 v[186:187], v245 offset:9280
  s_add_u32 m0, s34, 34816
  s_nop 0
  buffer_load_dwordx4 v240, s[8:11], s33 offen lds
  v_mfma_f32_32x32x16_bf16 v[144:159], v[224:227], a[208:211], v[144:159]
  ds_read_b64_tr_b16 v[192:193], v245 offset:8832
  ds_read_b64_tr_b16 v[194:195], v245 offset:9344
  ds_read_b64_tr_b16 v[200:201], v245 offset:8896
  buffer_load_dwordx4 v241, s[8:11], s33 offen offset:1088 lds
  v_mfma_f32_32x32x16_bf16 v[160:175], v[232:235], a[208:211], v[160:175]
  ds_read_b64_tr_b16 v[202:203], v245 offset:9408
  ds_read_b64_tr_b16 v[180:181], v245 offset:13056
  ds_read_b64_tr_b16 v[182:183], v245 offset:13568
  s_waitcnt lgkmcnt(10)
  v_mfma_f32_32x32x16_bf16 v[112:127], v[212:215], a[212:215], v[112:127]
  ds_read_b64_tr_b16 v[188:189], v245 offset:13120
  buffer_load_dwordx4 v242, s[8:11], s33 offen offset:2176 lds
  ds_read_b64_tr_b16 v[190:191], v245 offset:13632
  v_mfma_f32_32x32x16_bf16 v[128:143], v[220:223], a[212:215], v[128:143]
  ds_read_b64_tr_b16 v[196:197], v245 offset:13184
  ds_read_b64_tr_b16 v[198:199], v245 offset:13696
  v_mfma_f32_32x32x16_bf16 v[144:159], v[228:231], a[212:215], v[144:159]
  ds_read_b64_tr_b16 v[204:205], v245 offset:13248
  ds_read_b64_tr_b16 v[206:207], v245 offset:13760
  v_mfma_f32_32x32x16_bf16 v[160:175], v[236:239], a[212:215], v[160:175]
  buffer_load_dwordx4 v243, s[8:11], s33 offen offset:3264 lds
  s_add_u32 s33, s33, 65536
  s_and_b32 s33, s33, 0xfffff
  s_waitcnt lgkmcnt(9)
  v_mfma_f32_32x32x16_bf16 v[112:127], v[176:179], a[216:219], v[112:127]
  s_waitcnt vmcnt(35) lgkmcnt(0)
  s_barrier
  v_mfma_f32_32x32x16_bf16 v[128:143], v[184:187], a[216:219], v[128:143]
  ds_read_b64_tr_b16 v[208:209], v245 offset:17408
  ds_read_b64_tr_b16 v[210:211], v245 offset:17920
  ds_read_b64_tr_b16 v[216:217], v245 offset:17472
  buffer_load_dwordx4 a[192:195], v25, s[4:7], s32 offen offset:0 sc1
  v_mfma_f32_32x32x16_bf16 v[144:159], v[192:195], a[216:219], v[144:159]
  ds_read_b64_tr_b16 v[218:219], v245 offset:17984
  ds_read_b64_tr_b16 v[224:225], v245 offset:17536
  ds_read_b64_tr_b16 v[226:227], v245 offset:18048
  buffer_load_dwordx4 a[196:199], v25, s[4:7], s32 offen offset:1024 sc1
  v_mfma_f32_32x32x16_bf16 v[160:175], v[200:203], a[216:219], v[160:175]
  ds_read_b64_tr_b16 v[232:233], v245 offset:17600
  ds_read_b64_tr_b16 v[234:235], v245 offset:18112
  v_mfma_f32_32x32x16_bf16 v[112:127], v[180:183], a[220:223], v[112:127]
  ds_read_b64_tr_b16 v[212:213], v245 offset:21760
  ds_read_b64_tr_b16 v[214:215], v245 offset:22272
  ds_read_b64_tr_b16 v[220:221], v245 offset:21824
  buffer_load_dwordx4 a[200:203], v25, s[4:7], s32 offen offset:2048 sc1
  v_mfma_f32_32x32x16_bf16 v[128:143], v[188:191], a[220:223], v[128:143]
  ds_read_b64_tr_b16 v[222:223], v245 offset:22336
  ds_read_b64_tr_b16 v[228:229], v245 offset:21888
  ds_read_b64_tr_b16 v[230:231], v245 offset:22400
  v_mfma_f32_32x32x16_bf16 v[144:159], v[196:199], a[220:223], v[144:159]
  ds_read_b64_tr_b16 v[236:237], v245 offset:21952
  ds_read_b64_tr_b16 v[238:239], v245 offset:22464
  v_mfma_f32_32x32x16_bf16 v[160:175], v[204:207], a[220:223], v[160:175]
  buffer_load_dwordx4 a[204:207], v25, s[4:7], s32 offen offset:3072 sc1
  s_add_u32 s32, s32, 4096
  s_and_b32 s32, s32, 0xffff
  s_waitcnt lgkmcnt(10)
  v_mfma_f32_32x32x16_bf16 v[112:127], v[208:211], a[224:227], v[112:127]
  s_add_u32 m0, s34, 52224
  s_nop 0
  buffer_load_dwordx4 v240, s[8:11], s33 offen lds
  ds_read_b64_tr_b16 v[176:177], v245 offset:26112
  buffer_load_dwordx4 v241, s[8:11], s33 offen offset:1088 lds
  ds_read_b64_tr_b16 v[178:179], v245 offset:26624
  v_mfma_f32_32x32x16_bf16 v[128:143], v[216:219], a[224:227], v[128:143]
  buffer_load_dwordx4 v242, s[8:11], s33 offen offset:2176 lds
  ds_read_b64_tr_b16 v[184:185], v245 offset:26176
  buffer_load_dwordx4 v243, s[8:11], s33 offen offset:3264 lds
  s_add_u32 s33, s33, 65536
  s_and_b32 s33, s33, 0xfffff
  ds_read_b64_tr_b16 v[186:187], v245 offset:26688
  s_waitcnt vmcnt(16)
  v_mfma_f32_32x32x16_bf16 v[144:159], v[224:227], a[224:227], v[144:159]
  v_lshlrev_b32 v2, 16, v72
  ds_read_b64_tr_b16 v[192:193], v245 offset:26240
  v_and_b32 v3, 0xffff0000, v72
  ds_read_b64_tr_b16 v[194:195], v245 offset:26752
  v_add_f32 v40, v40, v2
  ds_read_b64_tr_b16 v[200:201], v245 offset:26304
  s_waitcnt lgkmcnt(7)
  v_mfma_f32_32x32x16_bf16 v[160:175], v[232:235], a[224:227], v[160:175]
  v_add_f32 v41, v41, v3
  ds_read_b64_tr_b16 v[202:203], v245 offset:26816
  v_lshlrev_b32 v4, 16, v73
  ds_read_b64_tr_b16 v[180:181], v245 offset:30464
  v_and_b32 v5, 0xffff0000, v73
  ds_read_b64_tr_b16 v[182:183], v245 offset:30976
  v_mfma_f32_32x32x16_bf16 v[112:127], v[212:215], a[228:231], v[112:127]
  v_add_f32 v42, v42, v4
  ds_read_b64_tr_b16 v[188:189], v245 offset:30528
  v_add_f32 v43, v43, v5
  ds_read_b64_tr_b16 v[190:191], v245 offset:31040
  v_lshlrev_b32 v2, 16, v74
  v_mfma_f32_32x32x16_bf16 v[128:143], v[220:223], a[228:231], v[128:143]
  v_and_b32 v3, 0xffff0000, v74
  ds_read_b64_tr_b16 v[196:197], v245 offset:30592
  v_add_f32 v44, v44, v2
  ds_read_b64_tr_b16 v[198:199], v245 offset:31104
  v_mfma_f32_32x32x16_bf16 v[144:159], v[228:231], a[228:231], v[144:159]
  v_add_f32 v45, v45, v3
  ds_read_b64_tr_b16 v[204:205], v245 offset:30656
  v_lshlrev_b32 v4, 16, v75
  ds_read_b64_tr_b16 v[206:207], v245 offset:31168
  v_and_b32 v5, 0xffff0000, v75
  v_mfma_f32_32x32x16_bf16 v[160:175], v[236:239], a[228:231], v[160:175]
  v_add_f32 v46, v46, v4
  v_add_f32 v47, v47, v5
  s_waitcnt lgkmcnt(6)
  v_mfma_f32_32x32x16_bf16 v[112:127], v[176:179], a[232:235], v[112:127]
  s_waitcnt vmcnt(35) lgkmcnt(0)
  s_barrier
  v_mfma_f32_32x32x16_bf16 v[128:143], v[184:187], a[232:235], v[128:143]
  buffer_load_dwordx4 a[208:211], v25, s[4:7], s32 offen offset:0 sc1
  ds_read_b64_tr_b16 v[208:209], v245 offset:34816
  buffer_load_dwordx4 a[212:215], v25, s[4:7], s32 offen offset:1024 sc1
  ds_read_b64_tr_b16 v[210:211], v245 offset:35328
  buffer_load_dwordx4 a[216:219], v25, s[4:7], s32 offen offset:2048 sc1
  v_mfma_f32_32x32x16_bf16 v[144:159], v[192:195], a[232:235], v[144:159]
  ds_read_b64_tr_b16 v[216:217], v245 offset:34880
  buffer_load_dwordx4 a[220:223], v25, s[4:7], s32 offen offset:3072 sc1
  s_add_u32 s32, s32, 4096
  s_and_b32 s32, s32, 0xffff
  ds_read_b64_tr_b16 v[218:219], v245 offset:35392
  v_lshlrev_b32 v2, 16, v76
  ds_read_b64_tr_b16 v[224:225], v245 offset:34944
  v_and_b32 v3, 0xffff0000, v76
  v_mfma_f32_32x32x16_bf16 v[160:175], v[200:203], a[232:235], v[160:175]
  v_add_f32 v48, v48, v2
  ds_read_b64_tr_b16 v[226:227], v245 offset:35456
  v_add_f32 v49, v49, v3
  ds_read_b64_tr_b16 v[232:233], v245 offset:35008
  v_lshlrev_b32 v4, 16, v77
  ds_read_b64_tr_b16 v[234:235], v245 offset:35520
  v_mfma_f32_32x32x16_bf16 v[112:127], v[180:183], a[236:239], v[112:127]
  v_and_b32 v5, 0xffff0000, v77
  ds_read_b64_tr_b16 v[212:213], v245 offset:39168
  v_add_f32 v50, v50, v4
  ds_read_b64_tr_b16 v[214:215], v245 offset:39680
  v_add_f32 v51, v51, v5
  ds_read_b64_tr_b16 v[220:221], v245 offset:39232
  v_mfma_f32_32x32x16_bf16 v[128:143], v[188:191], a[236:239], v[128:143]
  v_lshlrev_b32 v2, 16, v78
  v_and_b32 v3, 0xffff0000, v78
  ds_read_b64_tr_b16 v[222:223], v245 offset:39744
  v_add_f32 v52, v52, v2
  ds_read_b64_tr_b16 v[228:229], v245 offset:39296
  v_add_f32 v53, v53, v3
  v_mfma_f32_32x32x16_bf16 v[144:159], v[196:199], a[236:239], v[144:159]
  ds_read_b64_tr_b16 v[230:231], v245 offset:39808
  v_lshlrev_b32 v4, 16, v79
  ds_read_b64_tr_b16 v[236:237], v245 offset:39360
  v_and_b32 v5, 0xffff0000, v79
  ds_read_b64_tr_b16 v[238:239], v245 offset:39872
  v_add_f32 v54, v54, v4
  v_mfma_f32_32x32x16_bf16 v[160:175], v[204:207], a[236:239], v[160:175]
  v_add_f32 v55, v55, v5
  v_lshlrev_b32 v2, 16, v80
  v_and_b32 v3, 0xffff0000, v80
  s_waitcnt lgkmcnt(6)
  v_mfma_f32_32x32x16_bf16 v[112:127], v[208:211], a[240:243], v[112:127]
  ds_read_b64_tr_b16 v[176:177], v245 offset:43520
  v_add_f32 v40, v40, v2
  ds_read_b64_tr_b16 v[178:179], v245 offset:44032
  v_add_f32 v41, v41, v3
  ds_read_b64_tr_b16 v[184:185], v245 offset:43584
  v_lshlrev_b32 v4, 16, v81
  v_mfma_f32_32x32x16_bf16 v[128:143], v[216:219], a[240:243], v[128:143]
  ds_read_b64_tr_b16 v[186:187], v245 offset:44096
  v_and_b32 v5, 0xffff0000, v81
  ds_read_b64_tr_b16 v[192:193], v245 offset:43648
  v_add_f32 v42, v42, v4
  v_mfma_f32_32x32x16_bf16 v[144:159], v[224:227], a[240:243], v[144:159]
  ds_read_b64_tr_b16 v[194:195], v245 offset:44160
  v_add_f32 v43, v43, v5
  ds_read_b64_tr_b16 v[200:201], v245 offset:43712
  v_lshlrev_b32 v2, 16, v82
  v_mfma_f32_32x32x16_bf16 v[160:175], v[232:235], a[240:243], v[160:175]
  ds_read_b64_tr_b16 v[202:203], v245 offset:44224
  v_and_b32 v3, 0xffff0000, v82
  ds_read_b64_tr_b16 v[180:181], v245 offset:47872
  v_add_f32 v44, v44, v2
  ds_read_b64_tr_b16 v[182:183], v245 offset:48384
  v_mfma_f32_32x32x16_bf16 v[112:127], v[212:215], a[244:247], v[112:127]
  v_add_f32 v45, v45, v3
  ds_read_b64_tr_b16 v[188:189], v245 offset:47936
  v_lshlrev_b32 v4, 16, v83
  ds_read_b64_tr_b16 v[190:191], v245 offset:48448
  s_waitcnt lgkmcnt(8)
  v_mfma_f32_32x32x16_bf16 v[128:143], v[220:223], a[244:247], v[128:143]
  v_and_b32 v5, 0xffff0000, v83
  ds_read_b64_tr_b16 v[196:197], v245 offset:48000
  v_add_f32 v46, v46, v4
  ds_read_b64_tr_b16 v[198:199], v245 offset:48512
  v_mfma_f32_32x32x16_bf16 v[144:159], v[228:231], a[244:247], v[144:159]
  ds_read_b64_tr_b16 v[204:205], v245 offset:48064
  v_add_f32 v47, v47, v5
  ds_read_b64_tr_b16 v[206:207], v245 offset:48576
  v_lshlrev_b32 v2, 16, v84
  v_mfma_f32_32x32x16_bf16 v[160:175], v[236:239], a[244:247], v[160:175]
  v_and_b32 v3, 0xffff0000, v84
  v_add_f32 v48, v48, v2
  v_mfma_f32_32x32x16_bf16 v[112:127], v[176:179], a[248:251], v[112:127]
  s_waitcnt vmcnt(30) lgkmcnt(0)
  s_barrier
  v_mfma_f32_32x32x16_bf16 v[128:143], v[184:187], a[248:251], v[128:143]
  ds_read_b64_tr_b16 v[216:217], v244 offset:64
  v_add_f32 v49, v49, v3
  ds_read_b64_tr_b16 v[218:219], v244 offset:576
  v_lshlrev_b32 v4, 16, v85
  ds_read_b64_tr_b16 v[224:225], v244 offset:128
  v_and_b32 v5, 0xffff0000, v85
  v_mfma_f32_32x32x16_bf16 v[144:159], v[192:195], a[248:251], v[144:159]
  ds_read_b64_tr_b16 v[226:227], v244 offset:640
  v_add_f32 v50, v50, v4
  ds_read_b64_tr_b16 v[232:233], v244 offset:192
  v_add_f32 v51, v51, v5
  ds_read_b64_tr_b16 v[234:235], v244 offset:704
  v_lshlrev_b32 v2, 16, v86
  v_mfma_f32_32x32x16_bf16 v[160:175], v[200:203], a[248:251], v[160:175]
  ds_read_b64_tr_b16 a[0:1], v244 offset:0
  v_and_b32 v3, 0xffff0000, v86
  ds_read_b64_tr_b16 a[2:3], v244 offset:512
  v_add_f32 v52, v52, v2
  v_mfma_f32_32x32x16_bf16 v[112:127], v[180:183], a[252:255], v[112:127]
  ds_read_b64_tr_b16 v[220:221], v244 offset:4416
  v_add_f32 v53, v53, v3
  ds_read_b64_tr_b16 v[222:223], v244 offset:4928
  v_lshlrev_b32 v4, 16, v87
  ds_read_b64_tr_b16 v[228:229], v244 offset:4480
  v_and_b32 v5, 0xffff0000, v87
  v_mfma_f32_32x32x16_bf16 v[128:143], v[188:191], a[252:255], v[128:143]
  ds_read_b64_tr_b16 v[230:231], v244 offset:4992
  v_add_f32 v54, v54, v4
  ds_read_b64_tr_b16 v[236:237], v244 offset:4544
  v_add_f32 v55, v55, v5
  ds_read_b64_tr_b16 v[238:239], v244 offset:5056
  v_mfma_f32_32x32x16_bf16 v[144:159], v[196:199], a[252:255], v[144:159]
  v_lshlrev_b32 v2, 16, v88
  ds_read_b64_tr_b16 a[4:5], v244 offset:4352
  v_and_b32 v3, 0xffff0000, v88
  ds_read_b64_tr_b16 a[6:7], v244 offset:4864
  v_add_f32 v40, v40, v2
  v_mfma_f32_32x32x16_bf16 v[160:175], v[204:207], a[252:255], v[160:175]
  v_add_f32 v41, v41, v3
  v_lshlrev_b32 v4, 16, v89
  s_waitcnt lgkmcnt(7)
  v_mfma_f32_32x32x16_bf16 v[128:143], v[216:219], a[160:163], v[128:143]
  v_and_b32 v5, 0xffff0000, v89
  ds_read_b64_tr_b16 v[184:185], v244 offset:8768
  v_add_f32 v42, v42, v4
  ds_read_b64_tr_b16 v[186:187], v244 offset:9280
  v_add_f32 v43, v43, v5
  ds_read_b64_tr_b16 v[192:193], v244 offset:8832
  v_mfma_f32_32x32x16_bf16 v[144:159], v[224:227], a[160:163], v[144:159]
  v_lshlrev_b32 v2, 16, v90
  ds_read_b64_tr_b16 v[194:195], v244 offset:9344
  v_and_b32 v3, 0xffff0000, v90
  ds_read_b64_tr_b16 v[200:201], v244 offset:8896
  v_add_f32 v44, v44, v2
  ds_read_b64_tr_b16 v[202:203], v244 offset:9408
  v_mfma_f32_32x32x16_bf16 v[160:175], v[232:235], a[160:163], v[160:175]
  v_add_f32 v45, v45, v3
  ds_read_b64_tr_b16 a[8:9], v244 offset:8704
  v_lshlrev_b32 v4, 16, v91
  ds_read_b64_tr_b16 a[10:11], v244 offset:9216
  v_and_b32 v5, 0xffff0000, v91
  s_waitcnt lgkmcnt(8)
  v_mfma_f32_32x32x16_bf16 v[128:143], v[220:223], a[164:167], v[128:143]
  v_add_f32 v46, v46, v4
  ds_read_b64_tr_b16 v[188:189], v244 offset:13120
  v_add_f32 v47, v47, v5
  ds_read_b64_tr_b16 v[190:191], v244 offset:13632
  v_lshlrev_b32 v2, 16, v92
  ds_read_b64_tr_b16 v[196:197], v244 offset:13184
  v_mfma_f32_32x32x16_bf16 v[144:159], v[228:231], a[164:167], v[144:159]
  v_and_b32 v3, 0xffff0000, v92
  ds_read_b64_tr_b16 v[198:199], v244 offset:13696
  v_add_f32 v48, v48, v2
  ds_read_b64_tr_b16 v[204:205], v244 offset:13248
  v_add_f32 v49, v49, v3
  ds_read_b64_tr_b16 v[206:207], v244 offset:13760
  v_mfma_f32_32x32x16_bf16 v[160:175], v[236:239], a[164:167], v[160:175]
  v_lshlrev_b32 v4, 16, v93
  ds_read_b64_tr_b16 a[12:13], v244 offset:13056
  v_and_b32 v5, 0xffff0000, v93
  ds_read_b64_tr_b16 a[14:15], v244 offset:13568
  v_add_f32 v50, v50, v4
  s_waitcnt lgkmcnt(8)
  v_mfma_f32_32x32x16_bf16 v[128:143], v[184:187], a[168:171], v[128:143]
  s_waitcnt vmcnt(16) lgkmcnt(0)
  s_barrier
  v_mfma_f32_32x32x16_bf16 v[144:159], v[192:195], a[168:171], v[144:159]
  v_add_f32 v51, v51, v5
  ds_read_b64_tr_b16 v[216:217], v244 offset:17472
  v_lshlrev_b32 v2, 16, v94
  ds_read_b64_tr_b16 v[218:219], v244 offset:17984
  v_and_b32 v3, 0xffff0000, v94
  ds_read_b64_tr_b16 v[224:225], v244 offset:17536
  v_mfma_f32_32x32x16_bf16 v[160:175], v[200:203], a[168:171], v[160:175]
  v_add_f32 v52, v52, v2
  ds_read_b64_tr_b16 v[226:227], v244 offset:18048
  v_add_f32 v53, v53, v3
  ds_read_b64_tr_b16 v[232:233], v244 offset:17600
  v_lshlrev_b32 v4, 16, v95
  ds_read_b64_tr_b16 v[234:235], v244 offset:18112
  v_mfma_f32_32x32x16_bf16 v[128:143], v[188:191], a[172:175], v[128:143]
  v_and_b32 v5, 0xffff0000, v95
  ds_read_b64_tr_b16 a[16:17], v244 offset:17408
  v_add_f32 v54, v54, v4
  ds_read_b64_tr_b16 a[18:19], v244 offset:17920
  v_add_f32 v55, v55, v5
  ds_read_b64_tr_b16 v[220:221], v244 offset:21824
  v_mul_f32 v56, 0xbfb8aa3b, v40
  v_mfma_f32_32x32x16_bf16 v[144:159], v[196:199], a[172:175], v[144:159]
  ds_read_b64_tr_b16 v[222:223], v244 offset:22336
  v_mul_f32 v57, 0xbfb8aa3b, v41
  ds_read_b64_tr_b16 v[228:229], v244 offset:21888
  v_mul_f32 v58, 0xbfb8aa3b, v42
  ds_read_b64_tr_b16 v[230:231], v244 offset:22400
  v_mul_f32 v59, 0xbfb8aa3b, v43
  v_mfma_f32_32x32x16_bf16 v[160:175], v[204:207], a[172:175], v[160:175]
  ds_read_b64_tr_b16 v[236:237], v244 offset:21952
  v_mul_f32 v60, 0xbfb8aa3b, v44
  ds_read_b64_tr_b16 v[238:239], v244 offset:22464
  v_mul_f32 v61, 0xbfb8aa3b, v45
  ds_read_b64_tr_b16 a[20:21], v244 offset:21760
  v_mul_f32 v62, 0xbfb8aa3b, v46
  ds_read_b64_tr_b16 a[22:23], v244 offset:22272
  v_mul_f32 v63, 0xbfb8aa3b, v47
  s_waitcnt lgkmcnt(8)
  v_mfma_f32_32x32x16_bf16 v[128:143], v[216:219], a[176:179], v[128:143]
  v_mul_f32 v64, 0xbfb8aa3b, v48
  ds_read_b64_tr_b16 v[184:185], v244 offset:26176
  v_mul_f32 v65, 0xbfb8aa3b, v49
  ds_read_b64_tr_b16 v[186:187], v244 offset:26688
  v_mul_f32 v66, 0xbfb8aa3b, v50
  ds_read_b64_tr_b16 v[192:193], v244 offset:26240
  v_mfma_f32_32x32x16_bf16 v[144:159], v[224:227], a[176:179], v[144:159]
  v_mul_f32 v67, 0xbfb8aa3b, v51
  ds_read_b64_tr_b16 v[194:195], v244 offset:26752
  v_mul_f32 v68, 0xbfb8aa3b, v52
  ds_read_b64_tr_b16 v[200:201], v244 offset:26304
  v_mul_f32 v69, 0xbfb8aa3b, v53
  ds_read_b64_tr_b16 v[202:203], v244 offset:26816
  v_mfma_f32_32x32x16_bf16 v[160:175], v[232:235], a[176:179], v[160:175]
  v_mul_f32 v70, 0xbfb8aa3b, v54
  ds_read_b64_tr_b16 a[24:25], v244 offset:26112
  v_mul_f32 v71, 0xbfb8aa3b, v55
  ds_read_b64_tr_b16 a[26:27], v244 offset:26624
  v_exp_f32 v56, v56
  s_waitcnt lgkmcnt(8)
  v_mfma_f32_32x32x16_bf16 v[128:143], v[220:223], a[180:183], v[128:143]
  v_exp_f32 v57, v57
  ds_read_b64_tr_b16 v[188:189], v244 offset:30528
  v_exp_f32 v58, v58
  ds_read_b64_tr_b16 v[190:191], v244 offset:31040
  v_exp_f32 v59, v59
  v_mfma_f32_32x32x16_bf16 v[144:159], v[228:231], a[180:183], v[144:159]
  ds_read_b64_tr_b16 v[196:197], v244 offset:30592
  v_exp_f32 v60, v60
  ds_read_b64_tr_b16 v[198:199], v244 offset:31104
  v_exp_f32 v61, v61
  ds_read_b64_tr_b16 v[204:205], v244 offset:30656
  v_exp_f32 v62, v62
  v_mfma_f32_32x32x16_bf16 v[160:175], v[236:239], a[180:183], v[160:175]
  ds_read_b64_tr_b16 v[206:207], v244 offset:31168
  v_exp_f32 v63, v63
  ds_read_b64_tr_b16 a[28:29], v244 offset:30464
  v_exp_f32 v64, v64
  ds_read_b64_tr_b16 a[30:31], v244 offset:30976
  v_exp_f32 v65, v65
  s_waitcnt lgkmcnt(8)
  v_mfma_f32_32x32x16_bf16 v[128:143], v[184:187], a[184:187], v[128:143]
  s_waitcnt vmcnt(8) lgkmcnt(0)
  s_barrier
  v_mfma_f32_32x32x16_bf16 v[144:159], v[192:195], a[184:187], v[144:159]
  v_exp_f32 v66, v66
  ds_read_b64_tr_b16 v[216:217], v244 offset:34880
  v_exp_f32 v67, v67
  ds_read_b64_tr_b16 v[218:219], v244 offset:35392
  v_exp_f32 v68, v68
  ds_read_b64_tr_b16 v[224:225], v244 offset:34944
  v_mfma_f32_32x32x16_bf16 v[160:175], v[200:203], a[184:187], v[160:175]
  v_exp_f32 v69, v69
  ds_read_b64_tr_b16 v[226:227], v244 offset:35456
  v_exp_f32 v70, v70
  ds_read_b64_tr_b16 v[232:233], v244 offset:35008
  v_exp_f32 v71, v71
  ds_read_b64_tr_b16 v[234:235], v244 offset:35520
  v_add_f32 v56, 1.0, v56
  v_mfma_f32_32x32x16_bf16 v[128:143], v[188:191], a[188:191], v[128:143]
  v_add_f32 v57, 1.0, v57
  ds_read_b64_tr_b16 a[32:33], v244 offset:34816
  v_add_f32 v58, 1.0, v58
  ds_read_b64_tr_b16 a[34:35], v244 offset:35328
  v_add_f32 v59, 1.0, v59
  ds_read_b64_tr_b16 v[220:221], v244 offset:39232
  v_mfma_f32_32x32x16_bf16 v[144:159], v[196:199], a[188:191], v[144:159]
  v_add_f32 v60, 1.0, v60
  ds_read_b64_tr_b16 v[222:223], v244 offset:39744
  v_add_f32 v61, 1.0, v61
  ds_read_b64_tr_b16 v[228:229], v244 offset:39296
  v_add_f32 v62, 1.0, v62
  ds_read_b64_tr_b16 v[230:231], v244 offset:39808
  v_add_f32 v63, 1.0, v63
  v_mfma_f32_32x32x16_bf16 v[160:175], v[204:207], a[188:191], v[160:175]
  ds_read_b64_tr_b16 v[236:237], v244 offset:39360
  v_add_f32 v64, 1.0, v64
  ds_read_b64_tr_b16 v[238:239], v244 offset:39872
  v_add_f32 v65, 1.0, v65
  ds_read_b64_tr_b16 a[36:37], v244 offset:39168
  v_add_f32 v66, 1.0, v66
  ds_read_b64_tr_b16 a[38:39], v244 offset:39680
  v_add_f32 v67, 1.0, v67
  s_waitcnt lgkmcnt(8)
  v_mfma_f32_32x32x16_bf16 v[128:143], v[216:219], a[192:195], v[128:143]
  v_add_f32 v68, 1.0, v68
  ds_read_b64_tr_b16 v[184:185], v244 offset:43584
  v_add_f32 v69, 1.0, v69
  ds_read_b64_tr_b16 v[186:187], v244 offset:44096
  v_add_f32 v70, 1.0, v70
  ds_read_b64_tr_b16 v[192:193], v244 offset:43648
  v_mfma_f32_32x32x16_bf16 v[144:159], v[224:227], a[192:195], v[144:159]
  v_add_f32 v71, 1.0, v71
  ds_read_b64_tr_b16 v[194:195], v244 offset:44160
  v_rcp_f32 v56, v56
  ds_read_b64_tr_b16 v[200:201], v244 offset:43712
  v_mfma_f32_32x32x16_bf16 v[160:175], v[232:235], a[192:195], v[160:175]
  v_rcp_f32 v57, v57
  ds_read_b64_tr_b16 v[202:203], v244 offset:44224
  v_rcp_f32 v58, v58
  ds_read_b64_tr_b16 a[40:41], v244 offset:43520
  v_rcp_f32 v59, v59
  ds_read_b64_tr_b16 a[42:43], v244 offset:44032
  s_waitcnt lgkmcnt(8)
  v_mfma_f32_32x32x16_bf16 v[128:143], v[220:223], a[196:199], v[128:143]
  v_rcp_f32 v60, v60
  ds_read_b64_tr_b16 v[188:189], v244 offset:47936
  v_rcp_f32 v61, v61
  ds_read_b64_tr_b16 v[190:191], v244 offset:48448
  v_rcp_f32 v62, v62
  v_mfma_f32_32x32x16_bf16 v[144:159], v[228:231], a[196:199], v[144:159]
  ds_read_b64_tr_b16 v[196:197], v244 offset:48000
  v_rcp_f32 v63, v63
  ds_read_b64_tr_b16 v[198:199], v244 offset:48512
  v_rcp_f32 v64, v64
  ds_read_b64_tr_b16 v[204:205], v244 offset:48064
  v_rcp_f32 v65, v65
  v_mfma_f32_32x32x16_bf16 v[160:175], v[236:239], a[196:199], v[160:175]
  ds_read_b64_tr_b16 v[206:207], v244 offset:48576
  v_rcp_f32 v66, v66
  ds_read_b64_tr_b16 a[44:45], v244 offset:47872
  v_rcp_f32 v67, v67
  ds_read_b64_tr_b16 a[46:47], v244 offset:48384
  v_rcp_f32 v68, v68
  s_waitcnt lgkmcnt(8)
  v_mfma_f32_32x32x16_bf16 v[128:143], v[184:187], a[200:203], v[128:143]
  s_waitcnt vmcnt(0) lgkmcnt(0)
  s_barrier
  v_mfma_f32_32x32x16_bf16 v[144:159], v[192:195], a[200:203], v[144:159]
  v_rcp_f32 v69, v69
  ds_read_b64_tr_b16 v[216:217], v245 offset:64
  v_rcp_f32 v70, v70
  ds_read_b64_tr_b16 v[218:219], v245 offset:576
  v_rcp_f32 v71, v71
  ds_read_b64_tr_b16 v[224:225], v245 offset:128
  v_mfma_f32_32x32x16_bf16 v[160:175], v[200:203], a[200:203], v[160:175]
  v_lshlrev_b32 v72, 16, v104
  ds_read_b64_tr_b16 v[226:227], v245 offset:640
  v_and_b32 v73, 0xffff0000, v104
  ds_read_b64_tr_b16 v[232:233], v245 offset:192
  v_lshlrev_b32 v74, 16, v105
  ds_read_b64_tr_b16 v[234:235], v245 offset:704
  v_and_b32 v75, 0xffff0000, v105
  v_mfma_f32_32x32x16_bf16 v[128:143], v[188:191], a[204:207], v[128:143]
  v_lshlrev_b32 v76, 16, v106
  ds_read_b64_tr_b16 a[48:49], v245 offset:0
  v_and_b32 v77, 0xffff0000, v106
  ds_read_b64_tr_b16 a[50:51], v245 offset:512
  v_lshlrev_b32 v78, 16, v107
  ds_read_b64_tr_b16 v[220:221], v245 offset:4416
  v_mfma_f32_32x32x16_bf16 v[144:159], v[196:199], a[204:207], v[144:159]
  v_and_b32 v79, 0xffff0000, v107
  ds_read_b64_tr_b16 v[222:223], v245 offset:4928
  v_lshlrev_b32 v80, 16, v108
  ds_read_b64_tr_b16 v[228:229], v245 offset:4480
  v_and_b32 v81, 0xffff0000, v108
  ds_read_b64_tr_b16 v[230:231], v245 offset:4992
  v_lshlrev_b32 v82, 16, v109
  v_mfma_f32_32x32x16_bf16 v[160:175], v[204:207], a[204:207], v[160:175]
  ds_read_b64_tr_b16 v[236:237], v245 offset:4544
  v_and_b32 v83, 0xffff0000, v109
  ds_read_b64_tr_b16 v[238:239], v245 offset:5056
  v_lshlrev_b32 v84, 16, v110
  ds_read_b64_tr_b16 a[52:53], v245 offset:4352
  v_and_b32 v85, 0xffff0000, v110
  ds_read_b64_tr_b16 a[54:55], v245 offset:4864
  v_lshlrev_b32 v86, 16, v111
  s_waitcnt lgkmcnt(8)
  v_mfma_f32_32x32x16_bf16 v[128:143], v[216:219], a[208:211], v[128:143]
  v_and_b32 v87, 0xffff0000, v111
  ds_read_b64_tr_b16 v[184:185], v245 offset:8768
  v_mul_f32 v56, v56, v40
  ds_read_b64_tr_b16 v[186:187], v245 offset:9280
  v_mul_f32 v57, v57, v41
  ds_read_b64_tr_b16 v[192:193], v245 offset:8832
  v_mfma_f32_32x32x16_bf16 v[144:159], v[224:227], a[208:211], v[144:159]
  v_mul_f32 v58, v58, v42
  ds_read_b64_tr_b16 v[194:195], v245 offset:9344
  v_mul_f32 v59, v59, v43
  ds_read_b64_tr_b16 v[200:201], v245 offset:8896
  v_mul_f32 v60, v60, v44
  ds_read_b64_tr_b16 v[202:203], v245 offset:9408
  v_mfma_f32_32x32x16_bf16 v[160:175], v[232:235], a[208:211], v[160:175]
  v_mul_f32 v61, v61, v45
  ds_read_b64_tr_b16 a[56:57], v245 offset:8704
  v_mul_f32 v62, v62, v46
  ds_read_b64_tr_b16 a[58:59], v245 offset:9216
  v_mul_f32 v63, v63, v47
  s_waitcnt lgkmcnt(8)
  v_mfma_f32_32x32x16_bf16 v[128:143], v[220:223], a[212:215], v[128:143]
  v_mul_f32 v64, v64, v48
  ds_read_b64_tr_b16 v[188:189], v245 offset:13120
  v_mul_f32 v65, v65, v49
  ds_read_b64_tr_b16 v[190:191], v245 offset:13632
  v_mul_f32 v66, v66, v50
  ds_read_b64_tr_b16 v[196:197], v245 offset:13184
  v_mfma_f32_32x32x16_bf16 v[144:159], v[228:231], a[212:215], v[144:159]
  v_mul_f32 v67, v67, v51
  ds_read_b64_tr_b16 v[198:199], v245 offset:13696
  v_mul_f32 v68, v68, v52
  ds_read_b64_tr_b16 v[204:205], v245 offset:13248
  v_mul_f32 v69, v69, v53
  ds_read_b64_tr_b16 v[206:207], v245 offset:13760
  v_mfma_f32_32x32x16_bf16 v[160:175], v[236:239], a[212:215], v[160:175]
  v_mul_f32 v70, v70, v54
  ds_read_b64_tr_b16 a[60:61], v245 offset:13056
  v_mul_f32 v71, v71, v55
  ds_read_b64_tr_b16 a[62:63], v245 offset:13568
  s_add_u32 s35, s35, 32768
  s_add_u32 s36, s36, 32768
  s_add_u32 s37, s37, 32768
  s_mov_b32 s16, s74
  s_mov_b32 s17, s75
  s_mov_b32 s18, 2097152
  s_mov_b32 s19, 0x00020000
  s_waitcnt lgkmcnt(5)
  v_mfma_f32_32x32x16_bf16 v[128:143], v[184:187], a[216:219], v[128:143]
  v_mfma_f32_32x32x16_bf16 v[144:159], v[192:195], a[216:219], v[144:159]
  v_mfma_f32_32x32x16_bf16 v[160:175], v[200:203], a[216:219], v[160:175]
  v_mfma_f32_32x32x16_bf16 v[128:143], v[188:191], a[220:223], v[128:143]
  s_waitcnt lgkmcnt(4)
  v_mfma_f32_32x32x16_bf16 v[144:159], v[196:199], a[220:223], v[144:159]
  s_waitcnt lgkmcnt(2)
  v_mfma_f32_32x32x16_bf16 v[160:175], v[204:207], a[220:223], v[160:175]
  v_mfma_f32_32x32x16_bf16 v[112:127], a[0:3], a[160:163], v[112:127]
  v_mfma_f32_32x32x16_bf16 v[112:127], a[4:7], a[164:167], v[112:127]
  s_nop 7
  s_nop 1
  v_mfma_f32_32x32x16_bf16 v[112:127], a[8:11], a[168:171], v[112:127]
  v_cvt_pk_bf16_f32 v128, v128, v129
  v_cvt_pk_bf16_f32 v129, v130, v131
  v_cvt_pk_bf16_f32 v130, v132, v133
  v_mfma_f32_32x32x16_bf16 v[112:127], a[12:15], a[172:175], v[112:127]
  v_cvt_pk_bf16_f32 v131, v134, v135
  v_cvt_pk_bf16_f32 v132, v136, v137
  v_cvt_pk_bf16_f32 v133, v138, v139
  v_mfma_f32_32x32x16_bf16 v[112:127], a[16:19], a[176:179], v[112:127]
  v_cvt_pk_bf16_f32 v134, v140, v141
  v_cvt_pk_bf16_f32 v135, v142, v143
  v_mfma_f32_32x32x16_bf16 v[112:127], a[20:23], a[180:183], v[112:127]
  s_add_u32 s44, s68, 1
  s_and_b32 s44, s44, 3
  s_lshl_b32 s44, s44, 17
  s_add_u32 s44, s44, s43
  s_add_u32 s44, s44, 32768
  buffer_store_dwordx4 v[128:131], v25, s[24:27], s44 offen sc1
  buffer_store_dwordx4 v[132:135], v25, s[24:27], s44 offen offset:1024 sc1
  v_cvt_pk_bf16_f32 v144, v144, v145
  v_cvt_pk_bf16_f32 v145, v146, v147
  v_mfma_f32_32x32x16_bf16 v[112:127], a[24:27], a[184:187], v[112:127]
  v_cvt_pk_bf16_f32 v146, v148, v149
  v_cvt_pk_bf16_f32 v147, v150, v151
  v_cvt_pk_bf16_f32 v148, v152, v153
  v_cvt_pk_bf16_f32 v149, v154, v155
  v_mfma_f32_32x32x16_bf16 v[112:127], a[28:31], a[188:191], v[112:127]
  v_cvt_pk_bf16_f32 v150, v156, v157
  v_cvt_pk_bf16_f32 v151, v158, v159
  v_mfma_f32_32x32x16_bf16 v[112:127], a[32:35], a[192:195], v[112:127]
  s_add_u32 s44, s68, 2
  s_and_b32 s44, s44, 3
  s_lshl_b32 s44, s44, 17
  s_add_u32 s44, s44, s43
  s_add_u32 s44, s44, 32768
  buffer_store_dwordx4 v[144:147], v25, s[24:27], s44 offen sc1
  buffer_store_dwordx4 v[148:151], v25, s[24:27], s44 offen offset:1024 sc1
  v_cvt_pk_bf16_f32 v160, v160, v161
  v_mfma_f32_32x32x16_bf16 v[112:127], a[36:39], a[196:199], v[112:127]
  v_cvt_pk_bf16_f32 v161, v162, v163
  v_cvt_pk_bf16_f32 v162, v164, v165
  v_cvt_pk_bf16_f32 v163, v166, v167
  v_cvt_pk_bf16_f32 v164, v168, v169
  v_mfma_f32_32x32x16_bf16 v[112:127], a[40:43], a[200:203], v[112:127]
  v_cvt_pk_bf16_f32 v165, v170, v171
  v_cvt_pk_bf16_f32 v166, v172, v173
  v_cvt_pk_bf16_f32 v167, v174, v175
  v_mfma_f32_32x32x16_bf16 v[112:127], a[44:47], a[204:207], v[112:127]
  s_add_u32 s44, s68, 3
  s_and_b32 s44, s44, 3
  s_lshl_b32 s44, s44, 17
  s_add_u32 s44, s44, s43
  s_add_u32 s44, s44, 32768
  buffer_store_dwordx4 v[160:163], v25, s[24:27], s44 offen sc1
  buffer_store_dwordx4 v[164:167], v25, s[24:27], s44 offen offset:1024 sc1
  buffer_load_dwordx4 v[176:179], v25, s[24:27], s35 offen offset:0 sc1
  v_mfma_f32_32x32x16_bf16 v[112:127], a[48:51], a[208:211], v[112:127]
  buffer_load_dwordx4 v[180:183], v25, s[24:27], s35 offen offset:1024 sc1
  buffer_load_dwordx4 v[184:187], v25, s[24:27], s36 offen offset:0 sc1
  buffer_load_dwordx4 v[188:191], v25, s[24:27], s36 offen offset:1024 sc1
  v_mfma_f32_32x32x16_bf16 v[112:127], a[52:55], a[212:215], v[112:127]
  buffer_load_dwordx4 v[192:195], v25, s[24:27], s37 offen offset:0 sc1
  buffer_load_dwordx4 v[196:199], v25, s[24:27], s37 offen offset:1024 sc1
  s_mov_b32 s41, 0
  v_mfma_f32_32x32x16_bf16 v[112:127], a[56:59], a[216:219], v[112:127]
  s_waitcnt lgkmcnt(0)
  v_mfma_f32_32x32x16_bf16 v[112:127], a[60:63], a[220:223], v[112:127]
  s_branch L_pollS_chk
L_pollS:
  buffer_load_dwordx4 v[176:179], v25, s[24:27], s35 offen offset:0 sc1
  buffer_load_dwordx4 v[180:183], v25, s[24:27], s35 offen offset:1024 sc1
  buffer_load_dwordx4 v[184:187], v25, s[24:27], s36 offen offset:0 sc1
  buffer_load_dwordx4 v[188:191], v25, s[24:27], s36 offen offset:1024 sc1
  buffer_load_dwordx4 v[192:195], v25, s[24:27], s37 offen offset:0 sc1
  buffer_load_dwordx4 v[196:199], v25, s[24:27], s37 offen offset:1024 sc1
  s_add_u32 s41, s41, 1
L_pollS_chk:
  s_waitcnt vmcnt(0)
  v_max3_u32 v2, v176, v177, v178
  v_max3_u32 v3, v179, v180, v181
  v_max3_u32 v2, v2, v182, v183
  v_max3_u32 v3, v3, v184, v185
  v_max3_u32 v2, v2, v186, v187
  v_max3_u32 v3, v3, v188, v189
  v_max3_u32 v2, v2, v190, v191
  v_max3_u32 v3, v3, v192, v193
  v_max3_u32 v2, v2, v194, v195
  v_max3_u32 v3, v3, v196, v197
  v_max3_u32 v2, v2, v198, v199
  v_max_u32 v2, v2, v3
  v_cmp_eq_u32 vcc, -1, v2
  s_cmp_gt_u32 s41, 0x200000
  s_cbranch_scc1 L_pollS_end
  s_cbranch_vccnz L_pollS
L_pollS_end:
  v_lshlrev_b32 v2, 16, v176
  v_and_b32 v3, 0xffff0000, v176
  v_add_f32 v112, v112, v2
  v_add_f32 v113, v113, v3
  v_lshlrev_b32 v4, 16, v177
  v_and_b32 v5, 0xffff0000, v177
  v_add_f32 v114, v114, v4
  v_add_f32 v115, v115, v5
  v_lshlrev_b32 v2, 16, v178
  v_and_b32 v3, 0xffff0000, v178
  v_add_f32 v116, v116, v2
  v_add_f32 v117, v117, v3
  v_lshlrev_b32 v4, 16, v179
  v_and_b32 v5, 0xffff0000, v179
  v_add_f32 v118, v118, v4
  v_add_f32 v119, v119, v5
  v_lshlrev_b32 v2, 16, v180
  v_and_b32 v3, 0xffff0000, v180
  v_add_f32 v120, v120, v2
  v_add_f32 v121, v121, v3
  v_lshlrev_b32 v4, 16, v181
  v_and_b32 v5, 0xffff0000, v181
  v_add_f32 v122, v122, v4
  v_add_f32 v123, v123, v5
  v_lshlrev_b32 v2, 16, v182
  v_and_b32 v3, 0xffff0000, v182
  v_add_f32 v124, v124, v2
  v_add_f32 v125, v125, v3
  v_lshlrev_b32 v4, 16, v183
  v_and_b32 v5, 0xffff0000, v183
  v_add_f32 v126, v126, v4
  v_add_f32 v127, v127, v5
  v_lshlrev_b32 v2, 16, v184
  v_and_b32 v3, 0xffff0000, v184
  v_add_f32 v112, v112, v2
  v_add_f32 v113, v113, v3
  v_lshlrev_b32 v4, 16, v185
  v_and_b32 v5, 0xffff0000, v185
  v_add_f32 v114, v114, v4
  v_add_f32 v115, v115, v5
  v_lshlrev_b32 v2, 16, v186
  v_and_b32 v3, 0xffff0000, v186
  v_add_f32 v116, v116, v2
  v_add_f32 v117, v117, v3
  v_lshlrev_b32 v4, 16, v187
  v_and_b32 v5, 0xffff0000, v187
  v_add_f32 v118, v118, v4
  v_add_f32 v119, v119, v5
  v_lshlrev_b32 v2, 16, v188
  v_and_b32 v3, 0xffff0000, v188
  v_add_f32 v120, v120, v2
  v_add_f32 v121, v121, v3
  v_lshlrev_b32 v4, 16, v189
  v_and_b32 v5, 0xffff0000, v189
  v_add_f32 v122, v122, v4
  v_add_f32 v123, v123, v5
  v_lshlrev_b32 v2, 16, v190
  v_and_b32 v3, 0xffff0000, v190
  v_add_f32 v124, v124, v2
  v_add_f32 v125, v125, v3
  v_lshlrev_b32 v4, 16, v191
  v_and_b32 v5, 0xffff0000, v191
  v_add_f32 v126, v126, v4
  v_add_f32 v127, v127, v5
  v_lshlrev_b32 v2, 16, v192
  v_and_b32 v3, 0xffff0000, v192
  v_add_f32 v112, v112, v2
  v_add_f32 v113, v113, v3
  v_lshlrev_b32 v4, 16, v193
  v_and_b32 v5, 0xffff0000, v193
  v_add_f32 v114, v114, v4
  v_add_f32 v115, v115, v5
  v_lshlrev_b32 v2, 16, v194
  v_and_b32 v3, 0xffff0000, v194
  v_add_f32 v116, v116, v2
  v_add_f32 v117, v117, v3
  v_lshlrev_b32 v4, 16, v195
  v_and_b32 v5, 0xffff0000, v195
  v_add_f32 v118, v118, v4
  v_add_f32 v119, v119, v5
  v_lshlrev_b32 v2, 16, v196
  v_and_b32 v3, 0xffff0000, v196
  v_add_f32 v120, v120, v2
  v_add_f32 v121, v121, v3
  v_lshlrev_b32 v4, 16, v197
  v_and_b32 v5, 0xffff0000, v197
  v_add_f32 v122, v122, v4
  v_add_f32 v123, v123, v5
  v_lshlrev_b32 v2, 16, v198
  v_and_b32 v3, 0xffff0000, v198
  v_add_f32 v124, v124, v2
  v_add_f32 v125, v125, v3
  v_lshlrev_b32 v4, 16, v199
  v_and_b32 v5, 0xffff0000, v199
  v_add_f32 v126, v126, v4
  v_add_f32 v127, v127, v5
  v_fmac_f32 v72, v112, v56
  v_fmac_f32 v73, v113, v57
  v_fmac_f32 v74, v114, v58
  v_fmac_f32 v75, v115, v59
  v_fmac_f32 v76, v116, v60
  v_fmac_f32 v77, v117, v61
  v_fmac_f32 v78, v118, v62
  v_fmac_f32 v79, v119, v63
  v_fmac_f32 v80, v120, v64
  v_fmac_f32 v81, v121, v65
  v_fmac_f32 v82, v122, v66
  v_fmac_f32 v83, v123, v67
  v_fmac_f32 v84, v124, v68
  v_fmac_f32 v85, v125, v69
  v_fmac_f32 v86, v126, v70
  v_fmac_f32 v87, v127, v71
  v_cvt_pk_bf16_f32 v104, v72, v73
  v_cvt_pk_bf16_f32 v105, v74, v75
  v_cvt_pk_bf16_f32 v106, v76, v77
  v_cvt_pk_bf16_f32 v107, v78, v79
  v_cvt_pk_bf16_f32 v108, v80, v81
  v_cvt_pk_bf16_f32 v109, v82, v83
  v_cvt_pk_bf16_f32 v110, v84, v85
  v_cvt_pk_bf16_f32 v111, v86, v87
  buffer_store_dwordx2 v[104:105], v246, s[16:19], 0 offen offset:0
  buffer_store_dwordx2 v[106:107], v246, s[16:19], 0 offen offset:16
  buffer_store_dwordx2 v[108:109], v246, s[16:19], 0 offen offset:32
  buffer_store_dwordx2 v[110:111], v246, s[16:19], 0 offen offset:48
L_end:
  s_endpgm
L_pre:
  s_cmp_eq_u32 s41, 13
  s_cbranch_scc1 L_fix1
  s_cmp_eq_u32 s41, 11
  s_cbranch_scc1 L_cnt
  s_and_b32 s44, s30, 1
  s_lshl_b32 s44, s44, 1
  s_add_u32 s44, s44, 1
  s_cmp_lg_u32 s44, s41
  s_cbranch_scc1 L_arrive
  s_add_u32 s48, s48, 2
  s_cmp_lt_u32 s28, 2
  s_cselect_b32 s44, s40, 0
  s_and_b32 s45, s28, 1
  s_mul_i32 s45, s45, 8704
  s_sub_u32 s44, s45, s44
  v_add_u32 v2, s44, v11
  v_add_u32 v3, s44, v12
  v_add_u32 v4, s44, v13
  v_add_u32 v5, s44, v14
  ds_read_b64_tr_b16 v[84:85], v2 offset:0
  ds_read_b64_tr_b16 v[86:87], v2 offset:256
  ds_read_b64_tr_b16 v[88:89], v2 offset:64
  ds_read_b64_tr_b16 v[90:91], v2 offset:320
  ds_read_b64_tr_b16 v[92:93], v3 offset:0
  ds_read_b64_tr_b16 v[94:95], v3 offset:256
  ds_read_b64_tr_b16 v[96:97], v3 offset:64
  ds_read_b64_tr_b16 v[98:99], v3 offset:320
  ds_read_b64_tr_b16 v[100:101], v4 offset:0
  ds_read_b64_tr_b16 v[102:103], v4 offset:256
  ds_read_b64_tr_b16 v[104:105], v4 offset:1088
  ds_read_b64_tr_b16 v[106:107], v4 offset:1344
  ds_read_b64_tr_b16 v[108:109], v5 offset:0
  ds_read_b64_tr_b16 v[110:111], v5 offset:128
  v_lshlrev_b32 v76, 16, v248
  v_and_b32 v77, 0xffff0000, v248
  v_lshlrev_b32 v78, 16, v249
  v_and_b32 v79, 0xffff0000, v249
  v_lshlrev_b32 v80, 16, v250
  v_and_b32 v81, 0xffff0000, v250
  v_lshlrev_b32 v82, 16, v251
  v_and_b32 v83, 0xffff0000, v251
  v_add_f32 v26, v76, v77
  v_mul_f32 v27, v76, v76
  v_fmac_f32 v27, v77, v77
  v_add_f32 v26, v26, v78
  v_fmac_f32 v27, v78, v78
  v_add_f32 v26, v26, v79
  v_fmac_f32 v27, v79, v79
  v_add_f32 v26, v26, v80
  v_fmac_f32 v27, v80, v80
  v_add_f32 v26, v26, v81
  v_fmac_f32 v27, v81, v81
  v_add_f32 v26, v26, v82
  v_fmac_f32 v27, v82, v82
  v_add_f32 v26, v26, v83
  v_fmac_f32 v27, v83, v83
  v_lshlrev_b32 v76, 16, v252
  s_waitcnt lgkmcnt(0)
  v_mfma_f32_32x32x16_bf16 a[0:15], v[240:243], v[84:87], 0
  v_and_b32 v77, 0xffff0000, v252
  v_lshlrev_b32 v78, 16, v253
  v_and_b32 v79, 0xffff0000, v253
  v_lshlrev_b32 v80, 16, v254
  v_and_b32 v81, 0xffff0000, v254
  v_lshlrev_b32 v82, 16, v255
  v_mfma_f32_32x32x16_bf16 a[16:31], v[240:243], v[88:91], 0
  v_and_b32 v83, 0xffff0000, v255
  v_add_f32 v28, v76, v77
  v_mul_f32 v29, v76, v76
  v_fmac_f32 v29, v77, v77
  v_add_f32 v28, v28, v78
  v_fmac_f32 v29, v78, v78
  v_mfma_f32_32x32x16_bf16 a[32:47], v[240:243], v[92:95], 0
  v_add_f32 v28, v28, v79
  v_fmac_f32 v29, v79, v79
  v_add_f32 v28, v28, v80
  v_fmac_f32 v29, v80, v80
  v_add_f32 v28, v28, v81
  v_fmac_f32 v29, v81, v81
  v_mfma_f32_32x32x16_bf16 a[48:63], v[240:243], v[96:99], 0
  v_add_f32 v28, v28, v82
  v_fmac_f32 v29, v82, v82
  v_add_f32 v28, v28, v83
  v_fmac_f32 v29, v83, v83
  s_nop 1
  v_add_f32_dpp v26, v26, v26 row_shr:1 row_mask:0xf bank_mask:0xf bound_ctrl:0
  v_mfma_f32_32x32x16_bf16 a[64:79], v[240:243], v[100:103], 0
  v_add_f32_dpp v27, v27, v27 row_shr:1 row_mask:0xf bank_mask:0xf bound_ctrl:0
  v_add_f32_dpp v28, v28, v28 row_shr:1 row_mask:0xf bank_mask:0xf bound_ctrl:0
  v_add_f32_dpp v29, v29, v29 row_shr:1 row_mask:0xf bank_mask:0xf bound_ctrl:0
  v_add_f32_dpp v26, v26, v26 row_shr:2 row_mask:0xf bank_mask:0xf bound_ctrl:0
  v_add_f32_dpp v27, v27, v27 row_shr:2 row_mask:0xf bank_mask:0xf bound_ctrl:0
  v_add_f32_dpp v28, v28, v28 row_shr:2 row_mask:0xf bank_mask:0xf bound_ctrl:0
  v_mfma_f32_32x32x16_bf16 a[80:95], v[240:243], v[104:107], 0
  v_add_f32_dpp v29, v29, v29 row_shr:2 row_mask:0xf bank_mask:0xf bound_ctrl:0
  v_add_f32_dpp v26, v26, v26 row_shr:4 row_mask:0xf bank_mask:0xf bound_ctrl:0
  v_add_f32_dpp v27, v27, v27 row_shr:4 row_mask:0xf bank_mask:0xf bound_ctrl:0
  v_add_f32_dpp v28, v28, v28 row_shr:4 row_mask:0xf bank_mask:0xf bound_ctrl:0
  v_add_f32_dpp v29, v29, v29 row_shr:4 row_mask:0xf bank_mask:0xf bound_ctrl:0
  v_add_f32_dpp v26, v26, v26 row_shr:8 row_mask:0xf bank_mask:0xf bound_ctrl:0
  v_mfma_f32_32x32x16_bf16 a[96:111], v[240:243], v[108:111], 0
  v_add_f32_dpp v27, v27, v27 row_shr:8 row_mask:0xf bank_mask:0xf bound_ctrl:0
  v_add_f32_dpp v28, v28, v28 row_shr:8 row_mask:0xf bank_mask:0xf bound_ctrl:0
  v_add_f32_dpp v29, v29, v29 row_shr:8 row_mask:0xf bank_mask:0xf bound_ctrl:0
  v_add_f32_dpp v26, v26, v26 row_bcast:15 row_mask:0xa bank_mask:0xf
  v_add_f32_dpp v27, v27, v27 row_bcast:15 row_mask:0xa bank_mask:0xf
  v_add_f32_dpp v28, v28, v28 row_bcast:15 row_mask:0xa bank_mask:0xf
  v_add_f32_dpp v29, v29, v29 row_bcast:15 row_mask:0xa bank_mask:0xf
  v_add_f32_dpp v26, v26, v26 row_bcast:31 row_mask:0xc bank_mask:0xf
  v_add_f32_dpp v27, v27, v27 row_bcast:31 row_mask:0xc bank_mask:0xf
  v_add_f32_dpp v28, v28, v28 row_bcast:31 row_mask:0xc bank_mask:0xf
  v_add_f32_dpp v29, v29, v29 row_bcast:31 row_mask:0xc bank_mask:0xf
  v_readlane_b32 s44, v26, 63
  v_readlane_b32 s45, v27, 63
  v_readlane_b32 s46, v28, 63
  v_readlane_b32 s47, v29, 63
  s_add_u32 s80, s78, 84934656
  s_addc_u32 s81, s79, 0
  s_mov_b32 s82, 131072
  s_mov_b32 s83, 0x00020000
  v_mov_b32 v76, s44
  v_mov_b32 v77, s45
  v_mov_b32 v78, s46
  v_mov_b32 v79, s47
  v_mul_f32 v76, 0xbb000000, v76
  v_mul_f32 v77, 0x3b000000, v77
  v_mul_f32 v78, 0xbb000000, v78
  v_mul_f32 v79, 0x3b000000, v79
  v_fma_f32 v77, -v76, v76, v77
  v_fma_f32 v79, -v78, v78, v79
  v_add_f32 v77, 0x3727c5ac, v77
  v_add_f32 v79, 0x3727c5ac, v79
  v_rsq_f32 v77, v77
  v_rsq_f32 v79, v79
  s_lshl_b32 s44, s30, 5
  s_add_u32 s44, s44, s29
  s_lshl_b32 s44, s44, 2
  s_add_u32 s44, s44, s28
  s_lshl_b32 s44, s44, 7
  v_mov_b32 v80, 0
  s_mov_b64 exec, 0xff
  buffer_store_dwordx4 v[76:79], v25, s[80:83], s44 offen sc1
  s_add_u32 s80, s78, 83886080
  s_addc_u32 s81, s79, 0
  s_mov_b32 s82, 131072
  s_mov_b32 s83, 0x00020000
  s_lshl_b32 s44, s2, 9
  v_lshlrev_b32 v81, 7, v1
  s_mov_b64 exec, 7
  buffer_store_dword v80, v81, s[80:83], s44 offen sc1
  s_mov_b64 exec, -1
  v_accvgpr_read_b32 v2, a0
  v_accvgpr_read_b32 v3, a16
  v_accvgpr_read_b32 v4, a32
  v_accvgpr_read_b32 v5, a48
  v_accvgpr_read_b32 v6, a64
  v_accvgpr_read_b32 v7, a80
  v_accvgpr_read_b32 v8, a96
  ds_write_b32 v30, v2 offset:0
  ds_write_b32 v30, v3 offset:512
  ds_write_b32 v30, v4 offset:1024
  ds_write_b32 v30, v5 offset:1536
  ds_write_b32 v30, v6 offset:2048
  ds_write_b32 v30, v7 offset:2560
  ds_write_b32 v30, v8 offset:3072
  s_add_u32 s80, s78, 85983232
  s_addc_u32 s81, s79, 0
  s_mov_b32 s82, 262144
  s_mov_b32 s83, 0x00020000
  s_lshl_b32 s44, s29, 3
  s_add_u32 s44, s44, s30
  s_lshl_b32 s44, s44, 10
  s_waitcnt lgkmcnt(0)
  s_barrier
  ds_read_b128 v[4:7], v31
  s_waitcnt lgkmcnt(0)
  v_add_f32 v4, v4, v5
  v_add_f32 v6, v6, v7
  v_add_f32 v4, v4, v6
  buffer_store_dword v4, v32, s[80:83], s44 offen sc1
  s_branch L_pre_ret
L_fix1:
  v_and_b32 v38, 15, v1
  v_lshrrev_b32 v39, 4, v1
  v_lshlrev_b32 v38, 4, v38
  s_lshl_b32 s45, s29, 19
  s_lshl_b32 s46, s28, 10
  s_add_u32 s45, s45, s46
  s_add_u32 s45, s45, 393216
  v_lshlrev_b32 v39, 12, v39
  v_add3_u32 v17, v38, v39, s45
  v_subrev_u32 v18, 784, v17
  v_subrev_u32 v19, 1568, v17
  v_subrev_u32 v20, 2352, v17
  s_mov_b32 s4, s54
  s_mov_b32 s5, s55
  s_mov_b32 s6, 16777216
  s_mov_b32 s7, 0x00020000
  s_mov_b32 s43, 0
  s_mov_b32 s35, 16384
  s_mov_b32 s51, -1
  v_and_b32 v38, 15, v1
  v_lshrrev_b32 v39, 4, v1
  v_lshlrev_b32 v38, 4, v38
  s_lshl_b32 s45, s29, 19
  s_lshl_b32 s46, s28, 12
  s_add_u32 s45, s45, s46
  s_add_u32 s45, s45, 393216
  v_lshlrev_b32 v39, 10, v39
  v_add3_u32 v21, v38, v39, s45
  v_subrev_u32 v22, 832, v21
  v_subrev_u32 v23, 1664, v21
  v_subrev_u32 v24, 2496, v21
  s_mov_b32 s8, s56
  s_mov_b32 s9, s57
  s_mov_b32 s10, 16777216
  s_mov_b32 s11, 0x00020000
  s_mov_b32 s12, s56
  s_mov_b32 s13, s57
  s_mov_b32 s14, 16777216
  s_mov_b32 s15, 0x00020000
  s_mov_b32 s16, s56
  s_mov_b32 s17, s57
  s_mov_b32 s18, 16777216
  s_mov_b32 s19, 0x00020000
  s_mov_b32 s36, 16384
  s_mov_b32 s37, 16384
  s_branch L_pre_ret
L_cnt:
  s_mov_b32 s24, s76
  s_mov_b32 s25, s77
  s_mov_b32 s26, 256
  s_mov_b32 s27, 0x00020000
  buffer_load_dword v2, off, s[24:27], 0 sc1
  s_add_u32 s24, s78, 20971520
  s_addc_u32 s25, s79, 0
  s_mov_b32 s26, 5636096
  s_mov_b32 s27, 0x00020000
  s_mov_b32 s48, 13
  s_branch L_pre_ret
L_arrive:
  s_mov_b32 s48, 11
  s_cmp_lg_u32 s28, 0
  s_cbranch_scc1 L_pre_ret
  s_mov_b32 s24, s76
  s_mov_b32 s25, s77
  s_mov_b32 s26, 256
  s_mov_b32 s27, 0x00020000
  v_mov_b32 v38, 1
  s_mov_b64 exec, 1
  buffer_atomic_add v38, off, s[24:27], 0 sc1
  s_mov_b64 exec, -1
  s_add_u32 s24, s78, 20971520
  s_addc_u32 s25, s79, 0
  s_mov_b32 s26, 5636096
  s_mov_b32 s27, 0x00020000
  s_branch L_pre_ret
L_spin:
  s_mov_b32 s20, s76
  s_mov_b32 s21, s77
  s_mov_b32 s22, 256
  s_mov_b32 s23, 0x00020000
  s_mov_b32 s47, 0
L_spin_loop:
  s_sleep 2
  buffer_load_dword v38, off, s[20:23], 0 sc1
  s_add_u32 s47, s47, 1
  s_waitcnt vmcnt(0)
  v_readfirstlane_b32 s45, v38
  s_cmp_gt_u32 s47, 0x200000
  s_cbranch_scc1 L_spin_out
  s_cmp_lt_u32 s45, 256
  s_cbranch_scc1 L_spin_loop
L_spin_out:
  s_add_u32 s20, s78, 4194304
  s_addc_u32 s21, s79, 0
  s_mov_b32 s22, 16777216
  s_mov_b32 s23, 0x00020000
  s_branch L_spin_ret
L_hflag:
  s_cmp_lg_u32 s28, 0
  s_cbranch_scc1 L_ret4
  s_lshl_b32 s45, s2, 9
  v_mov_b32 v251, 1
  s_mov_b64 exec, 1
  buffer_store_dword v251, off, s[80:83], s45 offset:0 sc1
  s_mov_b64 exec, -1
  s_branch L_ret4
L_oflag:
  s_cmp_lg_u32 s28, 0
  s_cbranch_scc1 L_ret5
  s_lshl_b32 s45, s2, 9
  v_mov_b32 v251, 1
  s_mov_b64 exec, 1
  buffer_store_dword v251, off, s[80:83], s45 offset:128 sc1
  s_mov_b64 exec, -1
  s_branch L_ret5
L_bflag:
  s_cmp_lg_u32 s28, 0
  s_cbranch_scc1 L_ret6
  s_lshl_b32 s45, s2, 9
  v_mov_b32 v251, 1
  s_mov_b64 exec, 1
  buffer_store_dword v251, off, s[80:83], s45 offset:256 sc1
  s_mov_b64 exec, -1
  s_branch L_ret6
L_hspin:
  s_mov_b32 s41, 0
  s_lshl_b32 s45, s30, 14
L_hspin_loop:
  s_sleep 1
  buffer_load_dword v250, v12, s[80:83], s45 offen sc1
  s_add_u32 s41, s41, 1
  s_waitcnt vmcnt(0)
  v_cmp_ne_u32 vcc, 1, v250
  s_cmp_gt_u32 s41, 0x200000
  s_cbranch_scc1 L_hspin_ret
  s_cbranch_vccnz L_hspin_loop
  s_branch L_hspin_ret
L_ospin:
  s_mov_b32 s41, 0
L_ospin_loop:
  s_sleep 1
  buffer_load_dword v250, v12, s[80:83], s40 offen sc1
  s_add_u32 s41, s41, 1
  s_waitcnt vmcnt(0)
  v_cmp_ne_u32 vcc, 1, v250
  s_cmp_gt_u32 s41, 0x200000
  s_cbranch_scc1 L_ospin_ret
  s_cbranch_vccnz L_ospin_loop
  s_branch L_ospin_ret
L_bspin:
  s_mov_b32 s41, 0
L_bspin_loop:
  s_sleep 1
  buffer_load_dword v250, v12, s[80:83], s40 offen sc1
  s_add_u32 s41, s41, 1
  s_waitcnt vmcnt(0)
  v_cmp_ne_u32 vcc, 1, v250
  s_cmp_gt_u32 s41, 0x200000
  s_cbranch_scc1 L_bspin_ret
  s_cbranch_vccnz L_bspin_loop
  s_branch L_bspin_ret
L_fb_b1:
  s_mov_b32 s71, 0
  s_branch L_fbk_11
L_fb_b0:
  s_mov_b32 s71, 1
  s_branch L_fbk_01
L_fb_c1:
  s_mov_b32 s71, 2
  s_branch L_fbk_11
L_fb_c0:
  s_mov_b32 s71, 3
  s_branch L_fbk_01
L_fb_d1:
  s_mov_b32 s71, 4
  s_branch L_fbk_11
L_fb_d0:
  s_mov_b32 s71, 5
  s_branch L_fbk_01
L_fb_t1:
  s_mov_b32 s71, 6
  s_branch L_fbk_10
L_fbk_01:
  s_nop 7
  s_nop 7
  s_nop 7
  v_max3_f32 v2, v112, v113, v114
  v_max3_f32 v2, v2, v115, v116
  v_max3_f32 v2, v2, v117, v118
  v_max3_f32 v2, v2, v119, v120
  v_max3_f32 v2, v2, v121, v122
  v_max3_f32 v2, v2, v123, v124
  v_max3_f32 v2, v2, v125, v126
  v_max_f32 v2, v2, v127
  v_mov_b32 v3, v2
  s_nop 1
  v_permlane32_swap_b32 v3, v2
  s_nop 1
  v_max_f32 v2, v2, v3
  v_max_f32 v2, 0, v2
  v_sub_f32 v3, 0, v2
  v_exp_f32 v3, v3
  v_sub_f32 v176, v176, v2
  v_sub_f32 v177, v177, v2
  v_sub_f32 v178, v178, v2
  v_sub_f32 v179, v179, v2
  v_sub_f32 v180, v180, v2
  v_sub_f32 v181, v181, v2
  v_sub_f32 v182, v182, v2
  v_sub_f32 v183, v183, v2
  v_sub_f32 v184, v184, v2
  v_sub_f32 v185, v185, v2
  v_sub_f32 v186, v186, v2
  v_sub_f32 v187, v187, v2
  v_sub_f32 v188, v188, v2
  v_sub_f32 v189, v189, v2
  v_sub_f32 v190, v190, v2
  v_sub_f32 v191, v191, v2
  v_sub_f32 v112, v112, v2
  v_sub_f32 v113, v113, v2
  v_sub_f32 v114, v114, v2
  v_sub_f32 v115, v115, v2
  v_sub_f32 v116, v116, v2
  v_sub_f32 v117, v117, v2
  v_sub_f32 v118, v118, v2
  v_sub_f32 v119, v119, v2
  v_sub_f32 v120, v120, v2
  v_sub_f32 v121, v121, v2
  v_sub_f32 v122, v122, v2
  v_sub_f32 v123, v123, v2
  v_sub_f32 v124, v124, v2
  v_sub_f32 v125, v125, v2
  v_sub_f32 v126, v126, v2
  v_sub_f32 v127, v127, v2
  v_sub_f32 v144, v144, v2
  v_sub_f32 v145, v145, v2
  v_sub_f32 v146, v146, v2
  v_sub_f32 v147, v147, v2
  v_sub_f32 v148, v148, v2
  v_sub_f32 v149, v149, v2
  v_sub_f32 v150, v150, v2
  v_sub_f32 v151, v151, v2
  v_sub_f32 v152, v152, v2
  v_sub_f32 v153, v153, v2
  v_sub_f32 v154, v154, v2
  v_sub_f32 v155, v155, v2
  v_sub_f32 v156, v156, v2
  v_sub_f32 v157, v157, v2
  v_sub_f32 v158, v158, v2
  v_sub_f32 v159, v159, v2
  v_mul_f32 v10, v10, v3
  v_accvgpr_read_b32 v224, a0
  v_accvgpr_read_b32 v225, a1
  v_accvgpr_read_b32 v226, a2
  v_accvgpr_read_b32 v227, a3
  v_accvgpr_read_b32 v228, a4
  v_accvgpr_read_b32 v229, a5
  v_accvgpr_read_b32 v230, a6
  v_accvgpr_read_b32 v231, a7
  v_accvgpr_read_b32 v232, a8
  v_accvgpr_read_b32 v233, a9
  v_accvgpr_read_b32 v234, a10
  v_accvgpr_read_b32 v235, a11
  v_accvgpr_read_b32 v236, a12
  v_accvgpr_read_b32 v237, a13
  v_accvgpr_read_b32 v238, a14
  v_accvgpr_read_b32 v239, a15
  v_mul_f32 v224, v224, v3
  v_mul_f32 v225, v225, v3
  v_mul_f32 v226, v226, v3
  v_mul_f32 v227, v227, v3
  v_mul_f32 v228, v228, v3
  v_mul_f32 v229, v229, v3
  v_mul_f32 v230, v230, v3
  v_mul_f32 v231, v231, v3
  v_mul_f32 v232, v232, v3
  v_mul_f32 v233, v233, v3
  v_mul_f32 v234, v234, v3
  v_mul_f32 v235, v235, v3
  v_mul_f32 v236, v236, v3
  v_mul_f32 v237, v237, v3
  v_mul_f32 v238, v238, v3
  v_mul_f32 v239, v239, v3
  v_accvgpr_write_b32 a0, v224
  v_accvgpr_write_b32 a1, v225
  v_accvgpr_write_b32 a2, v226
  v_accvgpr_write_b32 a3, v227
  v_accvgpr_write_b32 a4, v228
  v_accvgpr_write_b32 a5, v229
  v_accvgpr_write_b32 a6, v230
  v_accvgpr_write_b32 a7, v231
  v_accvgpr_write_b32 a8, v232
  v_accvgpr_write_b32 a9, v233
  v_accvgpr_write_b32 a10, v234
  v_accvgpr_write_b32 a11, v235
  v_accvgpr_write_b32 a12, v236
  v_accvgpr_write_b32 a13, v237
  v_accvgpr_write_b32 a14, v238
  v_accvgpr_write_b32 a15, v239
  v_accvgpr_read_b32 v224, a32
  v_accvgpr_read_b32 v225, a33
  v_accvgpr_read_b32 v226, a34
  v_accvgpr_read_b32 v227, a35
  v_accvgpr_read_b32 v228, a36
  v_accvgpr_read_b32 v229, a37
  v_accvgpr_read_b32 v230, a38
  v_accvgpr_read_b32 v231, a39
  v_accvgpr_read_b32 v232, a40
  v_accvgpr_read_b32 v233, a41
  v_accvgpr_read_b32 v234, a42
  v_accvgpr_read_b32 v235, a43
  v_accvgpr_read_b32 v236, a44
  v_accvgpr_read_b32 v237, a45
  v_accvgpr_read_b32 v238, a46
  v_accvgpr_read_b32 v239, a47
  v_mul_f32 v224, v224, v3
  v_mul_f32 v225, v225, v3
  v_mul_f32 v226, v226, v3
  v_mul_f32 v227, v227, v3
  v_mul_f32 v228, v228, v3
  v_mul_f32 v229, v229, v3
  v_mul_f32 v230, v230, v3
  v_mul_f32 v231, v231, v3
  v_mul_f32 v232, v232, v3
  v_mul_f32 v233, v233, v3
  v_mul_f32 v234, v234, v3
  v_mul_f32 v235, v235, v3
  v_mul_f32 v236, v236, v3
  v_mul_f32 v237, v237, v3
  v_mul_f32 v238, v238, v3
  v_mul_f32 v239, v239, v3
  v_accvgpr_write_b32 a32, v224
  v_accvgpr_write_b32 a33, v225
  v_accvgpr_write_b32 a34, v226
  v_accvgpr_write_b32 a35, v227
  v_accvgpr_write_b32 a36, v228
  v_accvgpr_write_b32 a37, v229
  v_accvgpr_write_b32 a38, v230
  v_accvgpr_write_b32 a39, v231
  v_accvgpr_write_b32 a40, v232
  v_accvgpr_write_b32 a41, v233
  v_accvgpr_write_b32 a42, v234
  v_accvgpr_write_b32 a43, v235
  v_accvgpr_write_b32 a44, v236
  v_accvgpr_write_b32 a45, v237
  v_accvgpr_write_b32 a46, v238
  v_accvgpr_write_b32 a47, v239
  v_accvgpr_read_b32 v224, a64
  v_accvgpr_read_b32 v225, a65
  v_accvgpr_read_b32 v226, a66
  v_accvgpr_read_b32 v227, a67
  v_accvgpr_read_b32 v228, a68
  v_accvgpr_read_b32 v229, a69
  v_accvgpr_read_b32 v230, a70
  v_accvgpr_read_b32 v231, a71
  v_accvgpr_read_b32 v232, a72
  v_accvgpr_read_b32 v233, a73
  v_accvgpr_read_b32 v234, a74
  v_accvgpr_read_b32 v235, a75
  v_accvgpr_read_b32 v236, a76
  v_accvgpr_read_b32 v237, a77
  v_accvgpr_read_b32 v238, a78
  v_accvgpr_read_b32 v239, a79
  v_mul_f32 v224, v224, v3
  v_mul_f32 v225, v225, v3
  v_mul_f32 v226, v226, v3
  v_mul_f32 v227, v227, v3
  v_mul_f32 v228, v228, v3
  v_mul_f32 v229, v229, v3
  v_mul_f32 v230, v230, v3
  v_mul_f32 v231, v231, v3
  v_mul_f32 v232, v232, v3
  v_mul_f32 v233, v233, v3
  v_mul_f32 v234, v234, v3
  v_mul_f32 v235, v235, v3
  v_mul_f32 v236, v236, v3
  v_mul_f32 v237, v237, v3
  v_mul_f32 v238, v238, v3
  v_mul_f32 v239, v239, v3
  v_accvgpr_write_b32 a64, v224
  v_accvgpr_write_b32 a65, v225
  v_accvgpr_write_b32 a66, v226
  v_accvgpr_write_b32 a67, v227
  v_accvgpr_write_b32 a68, v228
  v_accvgpr_write_b32 a69, v229
  v_accvgpr_write_b32 a70, v230
  v_accvgpr_write_b32 a71, v231
  v_accvgpr_write_b32 a72, v232
  v_accvgpr_write_b32 a73, v233
  v_accvgpr_write_b32 a74, v234
  v_accvgpr_write_b32 a75, v235
  v_accvgpr_write_b32 a76, v236
  v_accvgpr_write_b32 a77, v237
  v_accvgpr_write_b32 a78, v238
  v_accvgpr_write_b32 a79, v239
  v_accvgpr_read_b32 v224, a96
  v_accvgpr_read_b32 v225, a97
  v_accvgpr_read_b32 v226, a98
  v_accvgpr_read_b32 v227, a99
  v_accvgpr_read_b32 v228, a100
  v_accvgpr_read_b32 v229, a101
  v_accvgpr_read_b32 v230, a102
  v_accvgpr_read_b32 v231, a103
  v_accvgpr_read_b32 v232, a104
  v_accvgpr_read_b32 v233, a105
  v_accvgpr_read_b32 v234, a106
  v_accvgpr_read_b32 v235, a107
  v_accvgpr_read_b32 v236, a108
  v_accvgpr_read_b32 v237, a109
  v_accvgpr_read_b32 v238, a110
  v_accvgpr_read_b32 v239, a111
  v_mul_f32 v224, v224, v3
  v_mul_f32 v225, v225, v3
  v_mul_f32 v226, v226, v3
  v_mul_f32 v227, v227, v3
  v_mul_f32 v228, v228, v3
  v_mul_f32 v229, v229, v3
  v_mul_f32 v230, v230, v3
  v_mul_f32 v231, v231, v3
  v_mul_f32 v232, v232, v3
  v_mul_f32 v233, v233, v3
  v_mul_f32 v234, v234, v3
  v_mul_f32 v235, v235, v3
  v_mul_f32 v236, v236, v3
  v_mul_f32 v237, v237, v3
  v_mul_f32 v238, v238, v3
  v_mul_f32 v239, v239, v3
  v_accvgpr_write_b32 a96, v224
  v_accvgpr_write_b32 a97, v225
  v_accvgpr_write_b32 a98, v226
  v_accvgpr_write_b32 a99, v227
  v_accvgpr_write_b32 a100, v228
  v_accvgpr_write_b32 a101, v229
  v_accvgpr_write_b32 a102, v230
  v_accvgpr_write_b32 a103, v231
  v_accvgpr_write_b32 a104, v232
  v_accvgpr_write_b32 a105, v233
  v_accvgpr_write_b32 a106, v234
  v_accvgpr_write_b32 a107, v235
  v_accvgpr_write_b32 a108, v236
  v_accvgpr_write_b32 a109, v237
  v_accvgpr_write_b32 a110, v238
  v_accvgpr_write_b32 a111, v239
  v_exp_f32 v224, v112
  v_exp_f32 v225, v113
  v_exp_f32 v226, v114
  v_exp_f32 v227, v115
  v_exp_f32 v228, v116
  v_exp_f32 v229, v117
  v_exp_f32 v230, v118
  v_exp_f32 v231, v119
  v_exp_f32 v232, v120
  v_exp_f32 v233, v121
  v_exp_f32 v234, v122
  v_exp_f32 v235, v123
  v_exp_f32 v236, v124
  v_exp_f32 v237, v125
  v_exp_f32 v238, v126
  v_exp_f32 v239, v127
  s_nop 0
  v_add_f32 v30, v224, v225
  v_add_f32 v30, v30, v226
  v_add_f32 v30, v30, v227
  v_add_f32 v30, v30, v228
  v_add_f32 v30, v30, v229
  v_add_f32 v30, v30, v230
  v_add_f32 v30, v30, v231
  v_add_f32 v30, v30, v232
  v_add_f32 v30, v30, v233
  v_add_f32 v30, v30, v234
  v_add_f32 v30, v30, v235
  v_add_f32 v30, v30, v236
  v_add_f32 v30, v30, v237
  v_add_f32 v30, v30, v238
  v_add_f32 v30, v30, v239
  v_cvt_pk_bf16_f32 v208, v224, v225
  v_cvt_pk_bf16_f32 v209, v226, v227
  v_cvt_pk_bf16_f32 v210, v228, v229
  v_cvt_pk_bf16_f32 v211, v230, v231
  v_cvt_pk_bf16_f32 v212, v232, v233
  v_cvt_pk_bf16_f32 v213, v234, v235
  v_cvt_pk_bf16_f32 v214, v236, v237
  v_cvt_pk_bf16_f32 v215, v238, v239
  v_max3_f32 v2, v128, v129, v130
  v_max3_f32 v2, v2, v131, v132
  v_max3_f32 v2, v2, v133, v134
  v_max3_f32 v2, v2, v135, v136
  v_max3_f32 v2, v2, v137, v138
  v_max3_f32 v2, v2, v139, v140
  v_max3_f32 v2, v2, v141, v142
  v_max_f32 v2, v2, v143
  v_mov_b32 v3, v2
  s_nop 1
  v_permlane32_swap_b32 v3, v2
  s_nop 1
  v_max_f32 v2, v2, v3
  v_max_f32 v2, 0, v2
  v_sub_f32 v3, 0, v2
  v_exp_f32 v3, v3
  v_sub_f32 v192, v192, v2
  v_sub_f32 v193, v193, v2
  v_sub_f32 v194, v194, v2
  v_sub_f32 v195, v195, v2
  v_sub_f32 v196, v196, v2
  v_sub_f32 v197, v197, v2
  v_sub_f32 v198, v198, v2
  v_sub_f32 v199, v199, v2
  v_sub_f32 v200, v200, v2
  v_sub_f32 v201, v201, v2
  v_sub_f32 v202, v202, v2
  v_sub_f32 v203, v203, v2
  v_sub_f32 v204, v204, v2
  v_sub_f32 v205, v205, v2
  v_sub_f32 v206, v206, v2
  v_sub_f32 v207, v207, v2
  v_sub_f32 v128, v128, v2
  v_sub_f32 v129, v129, v2
  v_sub_f32 v130, v130, v2
  v_sub_f32 v131, v131, v2
  v_sub_f32 v132, v132, v2
  v_sub_f32 v133, v133, v2
  v_sub_f32 v134, v134, v2
  v_sub_f32 v135, v135, v2
  v_sub_f32 v136, v136, v2
  v_sub_f32 v137, v137, v2
  v_sub_f32 v138, v138, v2
  v_sub_f32 v139, v139, v2
  v_sub_f32 v140, v140, v2
  v_sub_f32 v141, v141, v2
  v_sub_f32 v142, v142, v2
  v_sub_f32 v143, v143, v2
  v_sub_f32 v160, v160, v2
  v_sub_f32 v161, v161, v2
  v_sub_f32 v162, v162, v2
  v_sub_f32 v163, v163, v2
  v_sub_f32 v164, v164, v2
  v_sub_f32 v165, v165, v2
  v_sub_f32 v166, v166, v2
  v_sub_f32 v167, v167, v2
  v_sub_f32 v168, v168, v2
  v_sub_f32 v169, v169, v2
  v_sub_f32 v170, v170, v2
  v_sub_f32 v171, v171, v2
  v_sub_f32 v172, v172, v2
  v_sub_f32 v173, v173, v2
  v_sub_f32 v174, v174, v2
  v_sub_f32 v175, v175, v2
  v_mul_f32 v11, v11, v3
  v_accvgpr_read_b32 v224, a16
  v_accvgpr_read_b32 v225, a17
  v_accvgpr_read_b32 v226, a18
  v_accvgpr_read_b32 v227, a19
  v_accvgpr_read_b32 v228, a20
  v_accvgpr_read_b32 v229, a21
  v_accvgpr_read_b32 v230, a22
  v_accvgpr_read_b32 v231, a23
  v_accvgpr_read_b32 v232, a24
  v_accvgpr_read_b32 v233, a25
  v_accvgpr_read_b32 v234, a26
  v_accvgpr_read_b32 v235, a27
  v_accvgpr_read_b32 v236, a28
  v_accvgpr_read_b32 v237, a29
  v_accvgpr_read_b32 v238, a30
  v_accvgpr_read_b32 v239, a31
  v_mul_f32 v224, v224, v3
  v_mul_f32 v225, v225, v3
  v_mul_f32 v226, v226, v3
  v_mul_f32 v227, v227, v3
  v_mul_f32 v228, v228, v3
  v_mul_f32 v229, v229, v3
  v_mul_f32 v230, v230, v3
  v_mul_f32 v231, v231, v3
  v_mul_f32 v232, v232, v3
  v_mul_f32 v233, v233, v3
  v_mul_f32 v234, v234, v3
  v_mul_f32 v235, v235, v3
  v_mul_f32 v236, v236, v3
  v_mul_f32 v237, v237, v3
  v_mul_f32 v238, v238, v3
  v_mul_f32 v239, v239, v3
  v_accvgpr_write_b32 a16, v224
  v_accvgpr_write_b32 a17, v225
  v_accvgpr_write_b32 a18, v226
  v_accvgpr_write_b32 a19, v227
  v_accvgpr_write_b32 a20, v228
  v_accvgpr_write_b32 a21, v229
  v_accvgpr_write_b32 a22, v230
  v_accvgpr_write_b32 a23, v231
  v_accvgpr_write_b32 a24, v232
  v_accvgpr_write_b32 a25, v233
  v_accvgpr_write_b32 a26, v234
  v_accvgpr_write_b32 a27, v235
  v_accvgpr_write_b32 a28, v236
  v_accvgpr_write_b32 a29, v237
  v_accvgpr_write_b32 a30, v238
  v_accvgpr_write_b32 a31, v239
  v_accvgpr_read_b32 v224, a48
  v_accvgpr_read_b32 v225, a49
  v_accvgpr_read_b32 v226, a50
  v_accvgpr_read_b32 v227, a51
  v_accvgpr_read_b32 v228, a52
  v_accvgpr_read_b32 v229, a53
  v_accvgpr_read_b32 v230, a54
  v_accvgpr_read_b32 v231, a55
  v_accvgpr_read_b32 v232, a56
  v_accvgpr_read_b32 v233, a57
  v_accvgpr_read_b32 v234, a58
  v_accvgpr_read_b32 v235, a59
  v_accvgpr_read_b32 v236, a60
  v_accvgpr_read_b32 v237, a61
  v_accvgpr_read_b32 v238, a62
  v_accvgpr_read_b32 v239, a63
  v_mul_f32 v224, v224, v3
  v_mul_f32 v225, v225, v3
  v_mul_f32 v226, v226, v3
  v_mul_f32 v227, v227, v3
  v_mul_f32 v228, v228, v3
  v_mul_f32 v229, v229, v3
  v_mul_f32 v230, v230, v3
  v_mul_f32 v231, v231, v3
  v_mul_f32 v232, v232, v3
  v_mul_f32 v233, v233, v3
  v_mul_f32 v234, v234, v3
  v_mul_f32 v235, v235, v3
  v_mul_f32 v236, v236, v3
  v_mul_f32 v237, v237, v3
  v_mul_f32 v238, v238, v3
  v_mul_f32 v239, v239, v3
  v_accvgpr_write_b32 a48, v224
  v_accvgpr_write_b32 a49, v225
  v_accvgpr_write_b32 a50, v226
  v_accvgpr_write_b32 a51, v227
  v_accvgpr_write_b32 a52, v228
  v_accvgpr_write_b32 a53, v229
  v_accvgpr_write_b32 a54, v230
  v_accvgpr_write_b32 a55, v231
  v_accvgpr_write_b32 a56, v232
  v_accvgpr_write_b32 a57, v233
  v_accvgpr_write_b32 a58, v234
  v_accvgpr_write_b32 a59, v235
  v_accvgpr_write_b32 a60, v236
  v_accvgpr_write_b32 a61, v237
  v_accvgpr_write_b32 a62, v238
  v_accvgpr_write_b32 a63, v239
  v_accvgpr_read_b32 v224, a80
  v_accvgpr_read_b32 v225, a81
  v_accvgpr_read_b32 v226, a82
  v_accvgpr_read_b32 v227, a83
  v_accvgpr_read_b32 v228, a84
  v_accvgpr_read_b32 v229, a85
  v_accvgpr_read_b32 v230, a86
  v_accvgpr_read_b32 v231, a87
  v_accvgpr_read_b32 v232, a88
  v_accvgpr_read_b32 v233, a89
  v_accvgpr_read_b32 v234, a90
  v_accvgpr_read_b32 v235, a91
  v_accvgpr_read_b32 v236, a92
  v_accvgpr_read_b32 v237, a93
  v_accvgpr_read_b32 v238, a94
  v_accvgpr_read_b32 v239, a95
  v_mul_f32 v224, v224, v3
  v_mul_f32 v225, v225, v3
  v_mul_f32 v226, v226, v3
  v_mul_f32 v227, v227, v3
  v_mul_f32 v228, v228, v3
  v_mul_f32 v229, v229, v3
  v_mul_f32 v230, v230, v3
  v_mul_f32 v231, v231, v3
  v_mul_f32 v232, v232, v3
  v_mul_f32 v233, v233, v3
  v_mul_f32 v234, v234, v3
  v_mul_f32 v235, v235, v3
  v_mul_f32 v236, v236, v3
  v_mul_f32 v237, v237, v3
  v_mul_f32 v238, v238, v3
  v_mul_f32 v239, v239, v3
  v_accvgpr_write_b32 a80, v224
  v_accvgpr_write_b32 a81, v225
  v_accvgpr_write_b32 a82, v226
  v_accvgpr_write_b32 a83, v227
  v_accvgpr_write_b32 a84, v228
  v_accvgpr_write_b32 a85, v229
  v_accvgpr_write_b32 a86, v230
  v_accvgpr_write_b32 a87, v231
  v_accvgpr_write_b32 a88, v232
  v_accvgpr_write_b32 a89, v233
  v_accvgpr_write_b32 a90, v234
  v_accvgpr_write_b32 a91, v235
  v_accvgpr_write_b32 a92, v236
  v_accvgpr_write_b32 a93, v237
  v_accvgpr_write_b32 a94, v238
  v_accvgpr_write_b32 a95, v239
  v_accvgpr_read_b32 v224, a112
  v_accvgpr_read_b32 v225, a113
  v_accvgpr_read_b32 v226, a114
  v_accvgpr_read_b32 v227, a115
  v_accvgpr_read_b32 v228, a116
  v_accvgpr_read_b32 v229, a117
  v_accvgpr_read_b32 v230, a118
  v_accvgpr_read_b32 v231, a119
  v_accvgpr_read_b32 v232, a120
  v_accvgpr_read_b32 v233, a121
  v_accvgpr_read_b32 v234, a122
  v_accvgpr_read_b32 v235, a123
  v_accvgpr_read_b32 v236, a124
  v_accvgpr_read_b32 v237, a125
  v_accvgpr_read_b32 v238, a126
  v_accvgpr_read_b32 v239, a127
  v_mul_f32 v224, v224, v3
  v_mul_f32 v225, v225, v3
  v_mul_f32 v226, v226, v3
  v_mul_f32 v227, v227, v3
  v_mul_f32 v228, v228, v3
  v_mul_f32 v229, v229, v3
  v_mul_f32 v230, v230, v3
  v_mul_f32 v231, v231, v3
  v_mul_f32 v232, v232, v3
  v_mul_f32 v233, v233, v3
  v_mul_f32 v234, v234, v3
  v_mul_f32 v235, v235, v3
  v_mul_f32 v236, v236, v3
  v_mul_f32 v237, v237, v3
  v_mul_f32 v238, v238, v3
  v_mul_f32 v239, v239, v3
  v_accvgpr_write_b32 a112, v224
  v_accvgpr_write_b32 a113, v225
  v_accvgpr_write_b32 a114, v226
  v_accvgpr_write_b32 a115, v227
  v_accvgpr_write_b32 a116, v228
  v_accvgpr_write_b32 a117, v229
  v_accvgpr_write_b32 a118, v230
  v_accvgpr_write_b32 a119, v231
  v_accvgpr_write_b32 a120, v232
  v_accvgpr_write_b32 a121, v233
  v_accvgpr_write_b32 a122, v234
  v_accvgpr_write_b32 a123, v235
  v_accvgpr_write_b32 a124, v236
  v_accvgpr_write_b32 a125, v237
  v_accvgpr_write_b32 a126, v238
  v_accvgpr_write_b32 a127, v239
  v_exp_f32 v224, v128
  v_exp_f32 v225, v129
  v_exp_f32 v226, v130
  v_exp_f32 v227, v131
  v_exp_f32 v228, v132
  v_exp_f32 v229, v133
  v_exp_f32 v230, v134
  v_exp_f32 v231, v135
  v_exp_f32 v232, v136
  v_exp_f32 v233, v137
  v_exp_f32 v234, v138
  v_exp_f32 v235, v139
  v_exp_f32 v236, v140
  v_exp_f32 v237, v141
  v_exp_f32 v238, v142
  v_exp_f32 v239, v143
  s_nop 0
  v_add_f32 v31, v224, v225
  v_add_f32 v31, v31, v226
  v_add_f32 v31, v31, v227
  v_add_f32 v31, v31, v228
  v_add_f32 v31, v31, v229
  v_add_f32 v31, v31, v230
  v_add_f32 v31, v31, v231
  v_add_f32 v31, v31, v232
  v_add_f32 v31, v31, v233
  v_add_f32 v31, v31, v234
  v_add_f32 v31, v31, v235
  v_add_f32 v31, v31, v236
  v_add_f32 v31, v31, v237
  v_add_f32 v31, v31, v238
  v_add_f32 v31, v31, v239
  v_cvt_pk_bf16_f32 v216, v224, v225
  v_cvt_pk_bf16_f32 v217, v226, v227
  v_cvt_pk_bf16_f32 v218, v228, v229
  v_cvt_pk_bf16_f32 v219, v230, v231
  v_cvt_pk_bf16_f32 v220, v232, v233
  v_cvt_pk_bf16_f32 v221, v234, v235
  v_cvt_pk_bf16_f32 v222, v236, v237
  v_cvt_pk_bf16_f32 v223, v238, v239
  s_cmp_eq_u32 s71, 1
  s_cbranch_scc1 L_ret_b0
  s_cmp_eq_u32 s71, 3
  s_cbranch_scc1 L_ret_c0
  s_nop 1
  s_branch L_ret_d0
L_fbk_10:
  s_nop 7
  s_nop 7
  s_nop 7
  v_max3_f32 v2, v144, v145, v146
  v_max3_f32 v2, v2, v147, v148
  v_max3_f32 v2, v2, v149, v150
  v_max3_f32 v2, v2, v151, v152
  v_max3_f32 v2, v2, v153, v154
  v_max3_f32 v2, v2, v155, v156
  v_max3_f32 v2, v2, v157, v158
  v_max_f32 v2, v2, v159
  v_mov_b32 v3, v2
  s_nop 1
  v_permlane32_swap_b32 v3, v2
  s_nop 1
  v_max_f32 v2, v2, v3
  v_max_f32 v2, 0, v2
  v_sub_f32 v3, 0, v2
  v_exp_f32 v3, v3
  v_sub_f32 v176, v176, v2
  v_sub_f32 v177, v177, v2
  v_sub_f32 v178, v178, v2
  v_sub_f32 v179, v179, v2
  v_sub_f32 v180, v180, v2
  v_sub_f32 v181, v181, v2
  v_sub_f32 v182, v182, v2
  v_sub_f32 v183, v183, v2
  v_sub_f32 v184, v184, v2
  v_sub_f32 v185, v185, v2
  v_sub_f32 v186, v186, v2
  v_sub_f32 v187, v187, v2
  v_sub_f32 v188, v188, v2
  v_sub_f32 v189, v189, v2
  v_sub_f32 v190, v190, v2
  v_sub_f32 v191, v191, v2
  v_sub_f32 v144, v144, v2
  v_sub_f32 v145, v145, v2
  v_sub_f32 v146, v146, v2
  v_sub_f32 v147, v147, v2
  v_sub_f32 v148, v148, v2
  v_sub_f32 v149, v149, v2
  v_sub_f32 v150, v150, v2
  v_sub_f32 v151, v151, v2
  v_sub_f32 v152, v152, v2
  v_sub_f32 v153, v153, v2
  v_sub_f32 v154, v154, v2
  v_sub_f32 v155, v155, v2
  v_sub_f32 v156, v156, v2
  v_sub_f32 v157, v157, v2
  v_sub_f32 v158, v158, v2
  v_sub_f32 v159, v159, v2
  v_mul_f32 v10, v10, v3
  v_accvgpr_read_b32 v208, a0
  v_accvgpr_read_b32 v209, a1
  v_accvgpr_read_b32 v210, a2
  v_accvgpr_read_b32 v211, a3
  v_accvgpr_read_b32 v212, a4
  v_accvgpr_read_b32 v213, a5
  v_accvgpr_read_b32 v214, a6
  v_accvgpr_read_b32 v215, a7
  v_accvgpr_read_b32 v216, a8
  v_accvgpr_read_b32 v217, a9
  v_accvgpr_read_b32 v218, a10
  v_accvgpr_read_b32 v219, a11
  v_accvgpr_read_b32 v220, a12
  v_accvgpr_read_b32 v221, a13
  v_accvgpr_read_b32 v222, a14
  v_accvgpr_read_b32 v223, a15
  v_mul_f32 v208, v208, v3
  v_mul_f32 v209, v209, v3
  v_mul_f32 v210, v210, v3
  v_mul_f32 v211, v211, v3
  v_mul_f32 v212, v212, v3
  v_mul_f32 v213, v213, v3
  v_mul_f32 v214, v214, v3
  v_mul_f32 v215, v215, v3
  v_mul_f32 v216, v216, v3
  v_mul_f32 v217, v217, v3
  v_mul_f32 v218, v218, v3
  v_mul_f32 v219, v219, v3
  v_mul_f32 v220, v220, v3
  v_mul_f32 v221, v221, v3
  v_mul_f32 v222, v222, v3
  v_mul_f32 v223, v223, v3
  v_accvgpr_write_b32 a0, v208
  v_accvgpr_write_b32 a1, v209
  v_accvgpr_write_b32 a2, v210
  v_accvgpr_write_b32 a3, v211
  v_accvgpr_write_b32 a4, v212
  v_accvgpr_write_b32 a5, v213
  v_accvgpr_write_b32 a6, v214
  v_accvgpr_write_b32 a7, v215
  v_accvgpr_write_b32 a8, v216
  v_accvgpr_write_b32 a9, v217
  v_accvgpr_write_b32 a10, v218
  v_accvgpr_write_b32 a11, v219
  v_accvgpr_write_b32 a12, v220
  v_accvgpr_write_b32 a13, v221
  v_accvgpr_write_b32 a14, v222
  v_accvgpr_write_b32 a15, v223
  v_accvgpr_read_b32 v208, a32
  v_accvgpr_read_b32 v209, a33
  v_accvgpr_read_b32 v210, a34
  v_accvgpr_read_b32 v211, a35
  v_accvgpr_read_b32 v212, a36
  v_accvgpr_read_b32 v213, a37
  v_accvgpr_read_b32 v214, a38
  v_accvgpr_read_b32 v215, a39
  v_accvgpr_read_b32 v216, a40
  v_accvgpr_read_b32 v217, a41
  v_accvgpr_read_b32 v218, a42
  v_accvgpr_read_b32 v219, a43
  v_accvgpr_read_b32 v220, a44
  v_accvgpr_read_b32 v221, a45
  v_accvgpr_read_b32 v222, a46
  v_accvgpr_read_b32 v223, a47
  v_mul_f32 v208, v208, v3
  v_mul_f32 v209, v209, v3
  v_mul_f32 v210, v210, v3
  v_mul_f32 v211, v211, v3
  v_mul_f32 v212, v212, v3
  v_mul_f32 v213, v213, v3
  v_mul_f32 v214, v214, v3
  v_mul_f32 v215, v215, v3
  v_mul_f32 v216, v216, v3
  v_mul_f32 v217, v217, v3
  v_mul_f32 v218, v218, v3
  v_mul_f32 v219, v219, v3
  v_mul_f32 v220, v220, v3
  v_mul_f32 v221, v221, v3
  v_mul_f32 v222, v222, v3
  v_mul_f32 v223, v223, v3
  v_accvgpr_write_b32 a32, v208
  v_accvgpr_write_b32 a33, v209
  v_accvgpr_write_b32 a34, v210
  v_accvgpr_write_b32 a35, v211
  v_accvgpr_write_b32 a36, v212
  v_accvgpr_write_b32 a37, v213
  v_accvgpr_write_b32 a38, v214
  v_accvgpr_write_b32 a39, v215
  v_accvgpr_write_b32 a40, v216
  v_accvgpr_write_b32 a41, v217
  v_accvgpr_write_b32 a42, v218
  v_accvgpr_write_b32 a43, v219
  v_accvgpr_write_b32 a44, v220
  v_accvgpr_write_b32 a45, v221
  v_accvgpr_write_b32 a46, v222
  v_accvgpr_write_b32 a47, v223
  v_accvgpr_read_b32 v208, a64
  v_accvgpr_read_b32 v209, a65
  v_accvgpr_read_b32 v210, a66
  v_accvgpr_read_b32 v211, a67
  v_accvgpr_read_b32 v212, a68
  v_accvgpr_read_b32 v213, a69
  v_accvgpr_read_b32 v214, a70
  v_accvgpr_read_b32 v215, a71
  v_accvgpr_read_b32 v216, a72
  v_accvgpr_read_b32 v217, a73
  v_accvgpr_read_b32 v218, a74
  v_accvgpr_read_b32 v219, a75
  v_accvgpr_read_b32 v220, a76
  v_accvgpr_read_b32 v221, a77
  v_accvgpr_read_b32 v222, a78
  v_accvgpr_read_b32 v223, a79
  v_mul_f32 v208, v208, v3
  v_mul_f32 v209, v209, v3
  v_mul_f32 v210, v210, v3
  v_mul_f32 v211, v211, v3
  v_mul_f32 v212, v212, v3
  v_mul_f32 v213, v213, v3
  v_mul_f32 v214, v214, v3
  v_mul_f32 v215, v215, v3
  v_mul_f32 v216, v216, v3
  v_mul_f32 v217, v217, v3
  v_mul_f32 v218, v218, v3
  v_mul_f32 v219, v219, v3
  v_mul_f32 v220, v220, v3
  v_mul_f32 v221, v221, v3
  v_mul_f32 v222, v222, v3
  v_mul_f32 v223, v223, v3
  v_accvgpr_write_b32 a64, v208
  v_accvgpr_write_b32 a65, v209
  v_accvgpr_write_b32 a66, v210
  v_accvgpr_write_b32 a67, v211
  v_accvgpr_write_b32 a68, v212
  v_accvgpr_write_b32 a69, v213
  v_accvgpr_write_b32 a70, v214
  v_accvgpr_write_b32 a71, v215
  v_accvgpr_write_b32 a72, v216
  v_accvgpr_write_b32 a73, v217
  v_accvgpr_write_b32 a74, v218
  v_accvgpr_write_b32 a75, v219
  v_accvgpr_write_b32 a76, v220
  v_accvgpr_write_b32 a77, v221
  v_accvgpr_write_b32 a78, v222
  v_accvgpr_write_b32 a79, v223
  v_accvgpr_read_b32 v208, a96
  v_accvgpr_read_b32 v209, a97
  v_accvgpr_read_b32 v210, a98
  v_accvgpr_read_b32 v211, a99
  v_accvgpr_read_b32 v212, a100
  v_accvgpr_read_b32 v213, a101
  v_accvgpr_read_b32 v214, a102
  v_accvgpr_read_b32 v215, a103
  v_accvgpr_read_b32 v216, a104
  v_accvgpr_read_b32 v217, a105
  v_accvgpr_read_b32 v218, a106
  v_accvgpr_read_b32 v219, a107
  v_accvgpr_read_b32 v220, a108
  v_accvgpr_read_b32 v221, a109
  v_accvgpr_read_b32 v222, a110
  v_accvgpr_read_b32 v223, a111
  v_mul_f32 v208, v208, v3
  v_mul_f32 v209, v209, v3
  v_mul_f32 v210, v210, v3
  v_mul_f32 v211, v211, v3
  v_mul_f32 v212, v212, v3
  v_mul_f32 v213, v213, v3
  v_mul_f32 v214, v214, v3
  v_mul_f32 v215, v215, v3
  v_mul_f32 v216, v216, v3
  v_mul_f32 v217, v217, v3
  v_mul_f32 v218, v218, v3
  v_mul_f32 v219, v219, v3
  v_mul_f32 v220, v220, v3
  v_mul_f32 v221, v221, v3
  v_mul_f32 v222, v222, v3
  v_mul_f32 v223, v223, v3
  v_accvgpr_write_b32 a96, v208
  v_accvgpr_write_b32 a97, v209
  v_accvgpr_write_b32 a98, v210
  v_accvgpr_write_b32 a99, v211
  v_accvgpr_write_b32 a100, v212
  v_accvgpr_write_b32 a101, v213
  v_accvgpr_write_b32 a102, v214
  v_accvgpr_write_b32 a103, v215
  v_accvgpr_write_b32 a104, v216
  v_accvgpr_write_b32 a105, v217
  v_accvgpr_write_b32 a106, v218
  v_accvgpr_write_b32 a107, v219
  v_accvgpr_write_b32 a108, v220
  v_accvgpr_write_b32 a109, v221
  v_accvgpr_write_b32 a110, v222
  v_accvgpr_write_b32 a111, v223
  v_exp_f32 v208, v144
  v_exp_f32 v209, v145
  v_exp_f32 v210, v146
  v_exp_f32 v211, v147
  v_exp_f32 v212, v148
  v_exp_f32 v213, v149
  v_exp_f32 v214, v150
  v_exp_f32 v215, v151
  v_exp_f32 v216, v152
  v_exp_f32 v217, v153
  v_exp_f32 v218, v154
  v_exp_f32 v219, v155
  v_exp_f32 v220, v156
  v_exp_f32 v221, v157
  v_exp_f32 v222, v158
  v_exp_f32 v223, v159
  s_nop 0
  v_add_f32 v30, v208, v209
  v_add_f32 v30, v30, v210
  v_add_f32 v30, v30, v211
  v_add_f32 v30, v30, v212
  v_add_f32 v30, v30, v213
  v_add_f32 v30, v30, v214
  v_add_f32 v30, v30, v215
  v_add_f32 v30, v30, v216
  v_add_f32 v30, v30, v217
  v_add_f32 v30, v30, v218
  v_add_f32 v30, v30, v219
  v_add_f32 v30, v30, v220
  v_add_f32 v30, v30, v221
  v_add_f32 v30, v30, v222
  v_add_f32 v30, v30, v223
  v_cvt_pk_bf16_f32 v224, v208, v209
  v_cvt_pk_bf16_f32 v225, v210, v211
  v_cvt_pk_bf16_f32 v226, v212, v213
  v_cvt_pk_bf16_f32 v227, v214, v215
  v_cvt_pk_bf16_f32 v228, v216, v217
  v_cvt_pk_bf16_f32 v229, v218, v219
  v_cvt_pk_bf16_f32 v230, v220, v221
  v_cvt_pk_bf16_f32 v231, v222, v223
  v_max3_f32 v2, v160, v161, v162
  v_max3_f32 v2, v2, v163, v164
  v_max3_f32 v2, v2, v165, v166
  v_max3_f32 v2, v2, v167, v168
  v_max3_f32 v2, v2, v169, v170
  v_max3_f32 v2, v2, v171, v172
  v_max3_f32 v2, v2, v173, v174
  v_max_f32 v2, v2, v175
  v_mov_b32 v3, v2
  s_nop 1
  v_permlane32_swap_b32 v3, v2
  s_nop 1
  v_max_f32 v2, v2, v3
  v_max_f32 v2, 0, v2
  v_sub_f32 v3, 0, v2
  v_exp_f32 v3, v3
  v_sub_f32 v192, v192, v2
  v_sub_f32 v193, v193, v2
  v_sub_f32 v194, v194, v2
  v_sub_f32 v195, v195, v2
  v_sub_f32 v196, v196, v2
  v_sub_f32 v197, v197, v2
  v_sub_f32 v198, v198, v2
  v_sub_f32 v199, v199, v2
  v_sub_f32 v200, v200, v2
  v_sub_f32 v201, v201, v2
  v_sub_f32 v202, v202, v2
  v_sub_f32 v203, v203, v2
  v_sub_f32 v204, v204, v2
  v_sub_f32 v205, v205, v2
  v_sub_f32 v206, v206, v2
  v_sub_f32 v207, v207, v2
  v_sub_f32 v160, v160, v2
  v_sub_f32 v161, v161, v2
  v_sub_f32 v162, v162, v2
  v_sub_f32 v163, v163, v2
  v_sub_f32 v164, v164, v2
  v_sub_f32 v165, v165, v2
  v_sub_f32 v166, v166, v2
  v_sub_f32 v167, v167, v2
  v_sub_f32 v168, v168, v2
  v_sub_f32 v169, v169, v2
  v_sub_f32 v170, v170, v2
  v_sub_f32 v171, v171, v2
  v_sub_f32 v172, v172, v2
  v_sub_f32 v173, v173, v2
  v_sub_f32 v174, v174, v2
  v_sub_f32 v175, v175, v2
  v_mul_f32 v11, v11, v3
  v_accvgpr_read_b32 v208, a16
  v_accvgpr_read_b32 v209, a17
  v_accvgpr_read_b32 v210, a18
  v_accvgpr_read_b32 v211, a19
  v_accvgpr_read_b32 v212, a20
  v_accvgpr_read_b32 v213, a21
  v_accvgpr_read_b32 v214, a22
  v_accvgpr_read_b32 v215, a23
  v_accvgpr_read_b32 v216, a24
  v_accvgpr_read_b32 v217, a25
  v_accvgpr_read_b32 v218, a26
  v_accvgpr_read_b32 v219, a27
  v_accvgpr_read_b32 v220, a28
  v_accvgpr_read_b32 v221, a29
  v_accvgpr_read_b32 v222, a30
  v_accvgpr_read_b32 v223, a31
  v_mul_f32 v208, v208, v3
  v_mul_f32 v209, v209, v3
  v_mul_f32 v210, v210, v3
  v_mul_f32 v211, v211, v3
  v_mul_f32 v212, v212, v3
  v_mul_f32 v213, v213, v3
  v_mul_f32 v214, v214, v3
  v_mul_f32 v215, v215, v3
  v_mul_f32 v216, v216, v3
  v_mul_f32 v217, v217, v3
  v_mul_f32 v218, v218, v3
  v_mul_f32 v219, v219, v3
  v_mul_f32 v220, v220, v3
  v_mul_f32 v221, v221, v3
  v_mul_f32 v222, v222, v3
  v_mul_f32 v223, v223, v3
  v_accvgpr_write_b32 a16, v208
  v_accvgpr_write_b32 a17, v209
  v_accvgpr_write_b32 a18, v210
  v_accvgpr_write_b32 a19, v211
  v_accvgpr_write_b32 a20, v212
  v_accvgpr_write_b32 a21, v213
  v_accvgpr_write_b32 a22, v214
  v_accvgpr_write_b32 a23, v215
  v_accvgpr_write_b32 a24, v216
  v_accvgpr_write_b32 a25, v217
  v_accvgpr_write_b32 a26, v218
  v_accvgpr_write_b32 a27, v219
  v_accvgpr_write_b32 a28, v220
  v_accvgpr_write_b32 a29, v221
  v_accvgpr_write_b32 a30, v222
  v_accvgpr_write_b32 a31, v223
  v_accvgpr_read_b32 v208, a48
  v_accvgpr_read_b32 v209, a49
  v_accvgpr_read_b32 v210, a50
  v_accvgpr_read_b32 v211, a51
  v_accvgpr_read_b32 v212, a52
  v_accvgpr_read_b32 v213, a53
  v_accvgpr_read_b32 v214, a54
  v_accvgpr_read_b32 v215, a55
  v_accvgpr_read_b32 v216, a56
  v_accvgpr_read_b32 v217, a57
  v_accvgpr_read_b32 v218, a58
  v_accvgpr_read_b32 v219, a59
  v_accvgpr_read_b32 v220, a60
  v_accvgpr_read_b32 v221, a61
  v_accvgpr_read_b32 v222, a62
  v_accvgpr_read_b32 v223, a63
  v_mul_f32 v208, v208, v3
  v_mul_f32 v209, v209, v3
  v_mul_f32 v210, v210, v3
  v_mul_f32 v211, v211, v3
  v_mul_f32 v212, v212, v3
  v_mul_f32 v213, v213, v3
  v_mul_f32 v214, v214, v3
  v_mul_f32 v215, v215, v3
  v_mul_f32 v216, v216, v3
  v_mul_f32 v217, v217, v3
  v_mul_f32 v218, v218, v3
  v_mul_f32 v219, v219, v3
  v_mul_f32 v220, v220, v3
  v_mul_f32 v221, v221, v3
  v_mul_f32 v222, v222, v3
  v_mul_f32 v223, v223, v3
  v_accvgpr_write_b32 a48, v208
  v_accvgpr_write_b32 a49, v209
  v_accvgpr_write_b32 a50, v210
  v_accvgpr_write_b32 a51, v211
  v_accvgpr_write_b32 a52, v212
  v_accvgpr_write_b32 a53, v213
  v_accvgpr_write_b32 a54, v214
  v_accvgpr_write_b32 a55, v215
  v_accvgpr_write_b32 a56, v216
  v_accvgpr_write_b32 a57, v217
  v_accvgpr_write_b32 a58, v218
  v_accvgpr_write_b32 a59, v219
  v_accvgpr_write_b32 a60, v220
  v_accvgpr_write_b32 a61, v221
  v_accvgpr_write_b32 a62, v222
  v_accvgpr_write_b32 a63, v223
  v_accvgpr_read_b32 v208, a80
  v_accvgpr_read_b32 v209, a81
  v_accvgpr_read_b32 v210, a82
  v_accvgpr_read_b32 v211, a83
  v_accvgpr_read_b32 v212, a84
  v_accvgpr_read_b32 v213, a85
  v_accvgpr_read_b32 v214, a86
  v_accvgpr_read_b32 v215, a87
  v_accvgpr_read_b32 v216, a88
  v_accvgpr_read_b32 v217, a89
  v_accvgpr_read_b32 v218, a90
  v_accvgpr_read_b32 v219, a91
  v_accvgpr_read_b32 v220, a92
  v_accvgpr_read_b32 v221, a93
  v_accvgpr_read_b32 v222, a94
  v_accvgpr_read_b32 v223, a95
  v_mul_f32 v208, v208, v3
  v_mul_f32 v209, v209, v3
  v_mul_f32 v210, v210, v3
  v_mul_f32 v211, v211, v3
  v_mul_f32 v212, v212, v3
  v_mul_f32 v213, v213, v3
  v_mul_f32 v214, v214, v3
  v_mul_f32 v215, v215, v3
  v_mul_f32 v216, v216, v3
  v_mul_f32 v217, v217, v3
  v_mul_f32 v218, v218, v3
  v_mul_f32 v219, v219, v3
  v_mul_f32 v220, v220, v3
  v_mul_f32 v221, v221, v3
  v_mul_f32 v222, v222, v3
  v_mul_f32 v223, v223, v3
  v_accvgpr_write_b32 a80, v208
  v_accvgpr_write_b32 a81, v209
  v_accvgpr_write_b32 a82, v210
  v_accvgpr_write_b32 a83, v211
  v_accvgpr_write_b32 a84, v212
  v_accvgpr_write_b32 a85, v213
  v_accvgpr_write_b32 a86, v214
  v_accvgpr_write_b32 a87, v215
  v_accvgpr_write_b32 a88, v216
  v_accvgpr_write_b32 a89, v217
  v_accvgpr_write_b32 a90, v218
  v_accvgpr_write_b32 a91, v219
  v_accvgpr_write_b32 a92, v220
  v_accvgpr_write_b32 a93, v221
  v_accvgpr_write_b32 a94, v222
  v_accvgpr_write_b32 a95, v223
  v_accvgpr_read_b32 v208, a112
  v_accvgpr_read_b32 v209, a113
  v_accvgpr_read_b32 v210, a114
  v_accvgpr_read_b32 v211, a115
  v_accvgpr_read_b32 v212, a116
  v_accvgpr_read_b32 v213, a117
  v_accvgpr_read_b32 v214, a118
  v_accvgpr_read_b32 v215, a119
  v_accvgpr_read_b32 v216, a120
  v_accvgpr_read_b32 v217, a121
  v_accvgpr_read_b32 v218, a122
  v_accvgpr_read_b32 v219, a123
  v_accvgpr_read_b32 v220, a124
  v_accvgpr_read_b32 v221, a125
  v_accvgpr_read_b32 v222, a126
  v_accvgpr_read_b32 v223, a127
  v_mul_f32 v208, v208, v3
  v_mul_f32 v209, v209, v3
  v_mul_f32 v210, v210, v3
  v_mul_f32 v211, v211, v3
  v_mul_f32 v212, v212, v3
  v_mul_f32 v213, v213, v3
  v_mul_f32 v214, v214, v3
  v_mul_f32 v215, v215, v3
  v_mul_f32 v216, v216, v3
  v_mul_f32 v217, v217, v3
  v_mul_f32 v218, v218, v3
  v_mul_f32 v219, v219, v3
  v_mul_f32 v220, v220, v3
  v_mul_f32 v221, v221, v3
  v_mul_f32 v222, v222, v3
  v_mul_f32 v223, v223, v3
  v_accvgpr_write_b32 a112, v208
  v_accvgpr_write_b32 a113, v209
  v_accvgpr_write_b32 a114, v210
  v_accvgpr_write_b32 a115, v211
  v_accvgpr_write_b32 a116, v212
  v_accvgpr_write_b32 a117, v213
  v_accvgpr_write_b32 a118, v214
  v_accvgpr_write_b32 a119, v215
  v_accvgpr_write_b32 a120, v216
  v_accvgpr_write_b32 a121, v217
  v_accvgpr_write_b32 a122, v218
  v_accvgpr_write_b32 a123, v219
  v_accvgpr_write_b32 a124, v220
  v_accvgpr_write_b32 a125, v221
  v_accvgpr_write_b32 a126, v222
  v_accvgpr_write_b32 a127, v223
  v_exp_f32 v208, v160
  v_exp_f32 v209, v161
  v_exp_f32 v210, v162
  v_exp_f32 v211, v163
  v_exp_f32 v212, v164
  v_exp_f32 v213, v165
  v_exp_f32 v214, v166
  v_exp_f32 v215, v167
  v_exp_f32 v216, v168
  v_exp_f32 v217, v169
  v_exp_f32 v218, v170
  v_exp_f32 v219, v171
  v_exp_f32 v220, v172
  v_exp_f32 v221, v173
  v_exp_f32 v222, v174
  v_exp_f32 v223, v175
  s_nop 0
  v_add_f32 v31, v208, v209
  v_add_f32 v31, v31, v210
  v_add_f32 v31, v31, v211
  v_add_f32 v31, v31, v212
  v_add_f32 v31, v31, v213
  v_add_f32 v31, v31, v214
  v_add_f32 v31, v31, v215
  v_add_f32 v31, v31, v216
  v_add_f32 v31, v31, v217
  v_add_f32 v31, v31, v218
  v_add_f32 v31, v31, v219
  v_add_f32 v31, v31, v220
  v_add_f32 v31, v31, v221
  v_add_f32 v31, v31, v222
  v_add_f32 v31, v31, v223
  v_cvt_pk_bf16_f32 v232, v208, v209
  v_cvt_pk_bf16_f32 v233, v210, v211
  v_cvt_pk_bf16_f32 v234, v212, v213
  v_cvt_pk_bf16_f32 v235, v214, v215
  v_cvt_pk_bf16_f32 v236, v216, v217
  v_cvt_pk_bf16_f32 v237, v218, v219
  v_cvt_pk_bf16_f32 v238, v220, v221
  v_cvt_pk_bf16_f32 v239, v222, v223
  s_nop 1
  s_branch L_ret_t1
L_fbk_11:
  s_nop 7
  s_nop 7
  s_nop 7
  v_max3_f32 v2, v144, v145, v146
  v_max3_f32 v2, v2, v147, v148
  v_max3_f32 v2, v2, v149, v150
  v_max3_f32 v2, v2, v151, v152
  v_max3_f32 v2, v2, v153, v154
  v_max3_f32 v2, v2, v155, v156
  v_max3_f32 v2, v2, v157, v158
  v_max_f32 v2, v2, v159
  v_mov_b32 v3, v2
  s_nop 1
  v_permlane32_swap_b32 v3, v2
  s_nop 1
  v_max_f32 v2, v2, v3
  v_max_f32 v2, 0, v2
  v_sub_f32 v3, 0, v2
  v_exp_f32 v3, v3
  v_sub_f32 v176, v176, v2
  v_sub_f32 v177, v177, v2
  v_sub_f32 v178, v178, v2
  v_sub_f32 v179, v179, v2
  v_sub_f32 v180, v180, v2
  v_sub_f32 v181, v181, v2
  v_sub_f32 v182, v182, v2
  v_sub_f32 v183, v183, v2
  v_sub_f32 v184, v184, v2
  v_sub_f32 v185, v185, v2
  v_sub_f32 v186, v186, v2
  v_sub_f32 v187, v187, v2
  v_sub_f32 v188, v188, v2
  v_sub_f32 v189, v189, v2
  v_sub_f32 v190, v190, v2
  v_sub_f32 v191, v191, v2
  v_sub_f32 v144, v144, v2
  v_sub_f32 v145, v145, v2
  v_sub_f32 v146, v146, v2
  v_sub_f32 v147, v147, v2
  v_sub_f32 v148, v148, v2
  v_sub_f32 v149, v149, v2
  v_sub_f32 v150, v150, v2
  v_sub_f32 v151, v151, v2
  v_sub_f32 v152, v152, v2
  v_sub_f32 v153, v153, v2
  v_sub_f32 v154, v154, v2
  v_sub_f32 v155, v155, v2
  v_sub_f32 v156, v156, v2
  v_sub_f32 v157, v157, v2
  v_sub_f32 v158, v158, v2
  v_sub_f32 v159, v159, v2
  v_sub_f32 v112, v112, v2
  v_sub_f32 v113, v113, v2
  v_sub_f32 v114, v114, v2
  v_sub_f32 v115, v115, v2
  v_sub_f32 v116, v116, v2
  v_sub_f32 v117, v117, v2
  v_sub_f32 v118, v118, v2
  v_sub_f32 v119, v119, v2
  v_sub_f32 v120, v120, v2
  v_sub_f32 v121, v121, v2
  v_sub_f32 v122, v122, v2
  v_sub_f32 v123, v123, v2
  v_sub_f32 v124, v124, v2
  v_sub_f32 v125, v125, v2
  v_sub_f32 v126, v126, v2
  v_sub_f32 v127, v127, v2
  v_mul_f32 v10, v10, v3
  v_accvgpr_read_b32 v208, a0
  v_accvgpr_read_b32 v209, a1
  v_accvgpr_read_b32 v210, a2
  v_accvgpr_read_b32 v211, a3
  v_accvgpr_read_b32 v212, a4
  v_accvgpr_read_b32 v213, a5
  v_accvgpr_read_b32 v214, a6
  v_accvgpr_read_b32 v215, a7
  v_accvgpr_read_b32 v216, a8
  v_accvgpr_read_b32 v217, a9
  v_accvgpr_read_b32 v218, a10
  v_accvgpr_read_b32 v219, a11
  v_accvgpr_read_b32 v220, a12
  v_accvgpr_read_b32 v221, a13
  v_accvgpr_read_b32 v222, a14
  v_accvgpr_read_b32 v223, a15
  v_mul_f32 v208, v208, v3
  v_mul_f32 v209, v209, v3
  v_mul_f32 v210, v210, v3
  v_mul_f32 v211, v211, v3
  v_mul_f32 v212, v212, v3
  v_mul_f32 v213, v213, v3
  v_mul_f32 v214, v214, v3
  v_mul_f32 v215, v215, v3
  v_mul_f32 v216, v216, v3
  v_mul_f32 v217, v217, v3
  v_mul_f32 v218, v218, v3
  v_mul_f32 v219, v219, v3
  v_mul_f32 v220, v220, v3
  v_mul_f32 v221, v221, v3
  v_mul_f32 v222, v222, v3
  v_mul_f32 v223, v223, v3
  v_accvgpr_write_b32 a0, v208
  v_accvgpr_write_b32 a1, v209
  v_accvgpr_write_b32 a2, v210
  v_accvgpr_write_b32 a3, v211
  v_accvgpr_write_b32 a4, v212
  v_accvgpr_write_b32 a5, v213
  v_accvgpr_write_b32 a6, v214
  v_accvgpr_write_b32 a7, v215
  v_accvgpr_write_b32 a8, v216
  v_accvgpr_write_b32 a9, v217
  v_accvgpr_write_b32 a10, v218
  v_accvgpr_write_b32 a11, v219
  v_accvgpr_write_b32 a12, v220
  v_accvgpr_write_b32 a13, v221
  v_accvgpr_write_b32 a14, v222
  v_accvgpr_write_b32 a15, v223
  v_accvgpr_read_b32 v208, a32
  v_accvgpr_read_b32 v209, a33
  v_accvgpr_read_b32 v210, a34
  v_accvgpr_read_b32 v211, a35
  v_accvgpr_read_b32 v212, a36
  v_accvgpr_read_b32 v213, a37
  v_accvgpr_read_b32 v214, a38
  v_accvgpr_read_b32 v215, a39
  v_accvgpr_read_b32 v216, a40
  v_accvgpr_read_b32 v217, a41
  v_accvgpr_read_b32 v218, a42
  v_accvgpr_read_b32 v219, a43
  v_accvgpr_read_b32 v220, a44
  v_accvgpr_read_b32 v221, a45
  v_accvgpr_read_b32 v222, a46
  v_accvgpr_read_b32 v223, a47
  v_mul_f32 v208, v208, v3
  v_mul_f32 v209, v209, v3
  v_mul_f32 v210, v210, v3
  v_mul_f32 v211, v211, v3
  v_mul_f32 v212, v212, v3
  v_mul_f32 v213, v213, v3
  v_mul_f32 v214, v214, v3
  v_mul_f32 v215, v215, v3
  v_mul_f32 v216, v216, v3
  v_mul_f32 v217, v217, v3
  v_mul_f32 v218, v218, v3
  v_mul_f32 v219, v219, v3
  v_mul_f32 v220, v220, v3
  v_mul_f32 v221, v221, v3
  v_mul_f32 v222, v222, v3
  v_mul_f32 v223, v223, v3
  v_accvgpr_write_b32 a32, v208
  v_accvgpr_write_b32 a33, v209
  v_accvgpr_write_b32 a34, v210
  v_accvgpr_write_b32 a35, v211
  v_accvgpr_write_b32 a36, v212
  v_accvgpr_write_b32 a37, v213
  v_accvgpr_write_b32 a38, v214
  v_accvgpr_write_b32 a39, v215
  v_accvgpr_write_b32 a40, v216
  v_accvgpr_write_b32 a41, v217
  v_accvgpr_write_b32 a42, v218
  v_accvgpr_write_b32 a43, v219
  v_accvgpr_write_b32 a44, v220
  v_accvgpr_write_b32 a45, v221
  v_accvgpr_write_b32 a46, v222
  v_accvgpr_write_b32 a47, v223
  v_accvgpr_read_b32 v208, a64
  v_accvgpr_read_b32 v209, a65
  v_accvgpr_read_b32 v210, a66
  v_accvgpr_read_b32 v211, a67
  v_accvgpr_read_b32 v212, a68
  v_accvgpr_read_b32 v213, a69
  v_accvgpr_read_b32 v214, a70
  v_accvgpr_read_b32 v215, a71
  v_accvgpr_read_b32 v216, a72
  v_accvgpr_read_b32 v217, a73
  v_accvgpr_read_b32 v218, a74
  v_accvgpr_read_b32 v219, a75
  v_accvgpr_read_b32 v220, a76
  v_accvgpr_read_b32 v221, a77
  v_accvgpr_read_b32 v222, a78
  v_accvgpr_read_b32 v223, a79
  v_mul_f32 v208, v208, v3
  v_mul_f32 v209, v209, v3
  v_mul_f32 v210, v210, v3
  v_mul_f32 v211, v211, v3
  v_mul_f32 v212, v212, v3
  v_mul_f32 v213, v213, v3
  v_mul_f32 v214, v214, v3
  v_mul_f32 v215, v215, v3
  v_mul_f32 v216, v216, v3
  v_mul_f32 v217, v217, v3
  v_mul_f32 v218, v218, v3
  v_mul_f32 v219, v219, v3
  v_mul_f32 v220, v220, v3
  v_mul_f32 v221, v221, v3
  v_mul_f32 v222, v222, v3
  v_mul_f32 v223, v223, v3
  v_accvgpr_write_b32 a64, v208
  v_accvgpr_write_b32 a65, v209
  v_accvgpr_write_b32 a66, v210
  v_accvgpr_write_b32 a67, v211
  v_accvgpr_write_b32 a68, v212
  v_accvgpr_write_b32 a69, v213
  v_accvgpr_write_b32 a70, v214
  v_accvgpr_write_b32 a71, v215
  v_accvgpr_write_b32 a72, v216
  v_accvgpr_write_b32 a73, v217
  v_accvgpr_write_b32 a74, v218
  v_accvgpr_write_b32 a75, v219
  v_accvgpr_write_b32 a76, v220
  v_accvgpr_write_b32 a77, v221
  v_accvgpr_write_b32 a78, v222
  v_accvgpr_write_b32 a79, v223
  v_accvgpr_read_b32 v208, a96
  v_accvgpr_read_b32 v209, a97
  v_accvgpr_read_b32 v210, a98
  v_accvgpr_read_b32 v211, a99
  v_accvgpr_read_b32 v212, a100
  v_accvgpr_read_b32 v213, a101
  v_accvgpr_read_b32 v214, a102
  v_accvgpr_read_b32 v215, a103
  v_accvgpr_read_b32 v216, a104
  v_accvgpr_read_b32 v217, a105
  v_accvgpr_read_b32 v218, a106
  v_accvgpr_read_b32 v219, a107
  v_accvgpr_read_b32 v220, a108
  v_accvgpr_read_b32 v221, a109
  v_accvgpr_read_b32 v222, a110
  v_accvgpr_read_b32 v223, a111
  v_mul_f32 v208, v208, v3
  v_mul_f32 v209, v209, v3
  v_mul_f32 v210, v210, v3
  v_mul_f32 v211, v211, v3
  v_mul_f32 v212, v212, v3
  v_mul_f32 v213, v213, v3
  v_mul_f32 v214, v214, v3
  v_mul_f32 v215, v215, v3
  v_mul_f32 v216, v216, v3
  v_mul_f32 v217, v217, v3
  v_mul_f32 v218, v218, v3
  v_mul_f32 v219, v219, v3
  v_mul_f32 v220, v220, v3
  v_mul_f32 v221, v221, v3
  v_mul_f32 v222, v222, v3
  v_mul_f32 v223, v223, v3
  v_accvgpr_write_b32 a96, v208
  v_accvgpr_write_b32 a97, v209
  v_accvgpr_write_b32 a98, v210
  v_accvgpr_write_b32 a99, v211
  v_accvgpr_write_b32 a100, v212
  v_accvgpr_write_b32 a101, v213
  v_accvgpr_write_b32 a102, v214
  v_accvgpr_write_b32 a103, v215
  v_accvgpr_write_b32 a104, v216
  v_accvgpr_write_b32 a105, v217
  v_accvgpr_write_b32 a106, v218
  v_accvgpr_write_b32 a107, v219
  v_accvgpr_write_b32 a108, v220
  v_accvgpr_write_b32 a109, v221
  v_accvgpr_write_b32 a110, v222
  v_accvgpr_write_b32 a111, v223
  v_exp_f32 v208, v144
  v_exp_f32 v209, v145
  v_exp_f32 v210, v146
  v_exp_f32 v211, v147
  v_exp_f32 v212, v148
  v_exp_f32 v213, v149
  v_exp_f32 v214, v150
  v_exp_f32 v215, v151
  v_exp_f32 v216, v152
  v_exp_f32 v217, v153
  v_exp_f32 v218, v154
  v_exp_f32 v219, v155
  v_exp_f32 v220, v156
  v_exp_f32 v221, v157
  v_exp_f32 v222, v158
  v_exp_f32 v223, v159
  s_nop 0
  v_add_f32 v30, v208, v209
  v_add_f32 v30, v30, v210
  v_add_f32 v30, v30, v211
  v_add_f32 v30, v30, v212
  v_add_f32 v30, v30, v213
  v_add_f32 v30, v30, v214
  v_add_f32 v30, v30, v215
  v_add_f32 v30, v30, v216
  v_add_f32 v30, v30, v217
  v_add_f32 v30, v30, v218
  v_add_f32 v30, v30, v219
  v_add_f32 v30, v30, v220
  v_add_f32 v30, v30, v221
  v_add_f32 v30, v30, v222
  v_add_f32 v30, v30, v223
  v_cvt_pk_bf16_f32 v224, v208, v209
  v_cvt_pk_bf16_f32 v225, v210, v211
  v_cvt_pk_bf16_f32 v226, v212, v213
  v_cvt_pk_bf16_f32 v227, v214, v215
  v_cvt_pk_bf16_f32 v228, v216, v217
  v_cvt_pk_bf16_f32 v229, v218, v219
  v_cvt_pk_bf16_f32 v230, v220, v221
  v_cvt_pk_bf16_f32 v231, v222, v223
  v_max3_f32 v2, v160, v161, v162
  v_max3_f32 v2, v2, v163, v164
  v_max3_f32 v2, v2, v165, v166
  v_max3_f32 v2, v2, v167, v168
  v_max3_f32 v2, v2, v169, v170
  v_max3_f32 v2, v2, v171, v172
  v_max3_f32 v2, v2, v173, v174
  v_max_f32 v2, v2, v175
  v_mov_b32 v3, v2
  s_nop 1
  v_permlane32_swap_b32 v3, v2
  s_nop 1
  v_max_f32 v2, v2, v3
  v_max_f32 v2, 0, v2
  v_sub_f32 v3, 0, v2
  v_exp_f32 v3, v3
  v_sub_f32 v192, v192, v2
  v_sub_f32 v193, v193, v2
  v_sub_f32 v194, v194, v2
  v_sub_f32 v195, v195, v2
  v_sub_f32 v196, v196, v2
  v_sub_f32 v197, v197, v2
  v_sub_f32 v198, v198, v2
  v_sub_f32 v199, v199, v2
  v_sub_f32 v200, v200, v2
  v_sub_f32 v201, v201, v2
  v_sub_f32 v202, v202, v2
  v_sub_f32 v203, v203, v2
  v_sub_f32 v204, v204, v2
  v_sub_f32 v205, v205, v2
  v_sub_f32 v206, v206, v2
  v_sub_f32 v207, v207, v2
  v_sub_f32 v160, v160, v2
  v_sub_f32 v161, v161, v2
  v_sub_f32 v162, v162, v2
  v_sub_f32 v163, v163, v2
  v_sub_f32 v164, v164, v2
  v_sub_f32 v165, v165, v2
  v_sub_f32 v166, v166, v2
  v_sub_f32 v167, v167, v2
  v_sub_f32 v168, v168, v2
  v_sub_f32 v169, v169, v2
  v_sub_f32 v170, v170, v2
  v_sub_f32 v171, v171, v2
  v_sub_f32 v172, v172, v2
  v_sub_f32 v173, v173, v2
  v_sub_f32 v174, v174, v2
  v_sub_f32 v175, v175, v2
  v_sub_f32 v128, v128, v2
  v_sub_f32 v129, v129, v2
  v_sub_f32 v130, v130, v2
  v_sub_f32 v131, v131, v2
  v_sub_f32 v132, v132, v2
  v_sub_f32 v133, v133, v2
  v_sub_f32 v134, v134, v2
  v_sub_f32 v135, v135, v2
  v_sub_f32 v136, v136, v2
  v_sub_f32 v137, v137, v2
  v_sub_f32 v138, v138, v2
  v_sub_f32 v139, v139, v2
  v_sub_f32 v140, v140, v2
  v_sub_f32 v141, v141, v2
  v_sub_f32 v142, v142, v2
  v_sub_f32 v143, v143, v2
  v_mul_f32 v11, v11, v3
  v_accvgpr_read_b32 v208, a16
  v_accvgpr_read_b32 v209, a17
  v_accvgpr_read_b32 v210, a18
  v_accvgpr_read_b32 v211, a19
  v_accvgpr_read_b32 v212, a20
  v_accvgpr_read_b32 v213, a21
  v_accvgpr_read_b32 v214, a22
  v_accvgpr_read_b32 v215, a23
  v_accvgpr_read_b32 v216, a24
  v_accvgpr_read_b32 v217, a25
  v_accvgpr_read_b32 v218, a26
  v_accvgpr_read_b32 v219, a27
  v_accvgpr_read_b32 v220, a28
  v_accvgpr_read_b32 v221, a29
  v_accvgpr_read_b32 v222, a30
  v_accvgpr_read_b32 v223, a31
  v_mul_f32 v208, v208, v3
  v_mul_f32 v209, v209, v3
  v_mul_f32 v210, v210, v3
  v_mul_f32 v211, v211, v3
  v_mul_f32 v212, v212, v3
  v_mul_f32 v213, v213, v3
  v_mul_f32 v214, v214, v3
  v_mul_f32 v215, v215, v3
  v_mul_f32 v216, v216, v3
  v_mul_f32 v217, v217, v3
  v_mul_f32 v218, v218, v3
  v_mul_f32 v219, v219, v3
  v_mul_f32 v220, v220, v3
  v_mul_f32 v221, v221, v3
  v_mul_f32 v222, v222, v3
  v_mul_f32 v223, v223, v3
  v_accvgpr_write_b32 a16, v208
  v_accvgpr_write_b32 a17, v209
  v_accvgpr_write_b32 a18, v210
  v_accvgpr_write_b32 a19, v211
  v_accvgpr_write_b32 a20, v212
  v_accvgpr_write_b32 a21, v213
  v_accvgpr_write_b32 a22, v214
  v_accvgpr_write_b32 a23, v215
  v_accvgpr_write_b32 a24, v216
  v_accvgpr_write_b32 a25, v217
  v_accvgpr_write_b32 a26, v218
  v_accvgpr_write_b32 a27, v219
  v_accvgpr_write_b32 a28, v220
  v_accvgpr_write_b32 a29, v221
  v_accvgpr_write_b32 a30, v222
  v_accvgpr_write_b32 a31, v223
  v_accvgpr_read_b32 v208, a48
  v_accvgpr_read_b32 v209, a49
  v_accvgpr_read_b32 v210, a50
  v_accvgpr_read_b32 v211, a51
  v_accvgpr_read_b32 v212, a52
  v_accvgpr_read_b32 v213, a53
  v_accvgpr_read_b32 v214, a54
  v_accvgpr_read_b32 v215, a55
  v_accvgpr_read_b32 v216, a56
  v_accvgpr_read_b32 v217, a57
  v_accvgpr_read_b32 v218, a58
  v_accvgpr_read_b32 v219, a59
  v_accvgpr_read_b32 v220, a60
  v_accvgpr_read_b32 v221, a61
  v_accvgpr_read_b32 v222, a62
  v_accvgpr_read_b32 v223, a63
  v_mul_f32 v208, v208, v3
  v_mul_f32 v209, v209, v3
  v_mul_f32 v210, v210, v3
  v_mul_f32 v211, v211, v3
  v_mul_f32 v212, v212, v3
  v_mul_f32 v213, v213, v3
  v_mul_f32 v214, v214, v3
  v_mul_f32 v215, v215, v3
  v_mul_f32 v216, v216, v3
  v_mul_f32 v217, v217, v3
  v_mul_f32 v218, v218, v3
  v_mul_f32 v219, v219, v3
  v_mul_f32 v220, v220, v3
  v_mul_f32 v221, v221, v3
  v_mul_f32 v222, v222, v3
  v_mul_f32 v223, v223, v3
  v_accvgpr_write_b32 a48, v208
  v_accvgpr_write_b32 a49, v209
  v_accvgpr_write_b32 a50, v210
  v_accvgpr_write_b32 a51, v211
  v_accvgpr_write_b32 a52, v212
  v_accvgpr_write_b32 a53, v213
  v_accvgpr_write_b32 a54, v214
  v_accvgpr_write_b32 a55, v215
  v_accvgpr_write_b32 a56, v216
  v_accvgpr_write_b32 a57, v217
  v_accvgpr_write_b32 a58, v218
  v_accvgpr_write_b32 a59, v219
  v_accvgpr_write_b32 a60, v220
  v_accvgpr_write_b32 a61, v221
  v_accvgpr_write_b32 a62, v222
  v_accvgpr_write_b32 a63, v223
  v_accvgpr_read_b32 v208, a80
  v_accvgpr_read_b32 v209, a81
  v_accvgpr_read_b32 v210, a82
  v_accvgpr_read_b32 v211, a83
  v_accvgpr_read_b32 v212, a84
  v_accvgpr_read_b32 v213, a85
  v_accvgpr_read_b32 v214, a86
  v_accvgpr_read_b32 v215, a87
  v_accvgpr_read_b32 v216, a88
  v_accvgpr_read_b32 v217, a89
  v_accvgpr_read_b32 v218, a90
  v_accvgpr_read_b32 v219, a91
  v_accvgpr_read_b32 v220, a92
  v_accvgpr_read_b32 v221, a93
  v_accvgpr_read_b32 v222, a94
  v_accvgpr_read_b32 v223, a95
  v_mul_f32 v208, v208, v3
  v_mul_f32 v209, v209, v3
  v_mul_f32 v210, v210, v3
  v_mul_f32 v211, v211, v3
  v_mul_f32 v212, v212, v3
  v_mul_f32 v213, v213, v3
  v_mul_f32 v214, v214, v3
  v_mul_f32 v215, v215, v3
  v_mul_f32 v216, v216, v3
  v_mul_f32 v217, v217, v3
  v_mul_f32 v218, v218, v3
  v_mul_f32 v219, v219, v3
  v_mul_f32 v220, v220, v3
  v_mul_f32 v221, v221, v3
  v_mul_f32 v222, v222, v3
  v_mul_f32 v223, v223, v3
  v_accvgpr_write_b32 a80, v208
  v_accvgpr_write_b32 a81, v209
  v_accvgpr_write_b32 a82, v210
  v_accvgpr_write_b32 a83, v211
  v_accvgpr_write_b32 a84, v212
  v_accvgpr_write_b32 a85, v213
  v_accvgpr_write_b32 a86, v214
  v_accvgpr_write_b32 a87, v215
  v_accvgpr_write_b32 a88, v216
  v_accvgpr_write_b32 a89, v217
  v_accvgpr_write_b32 a90, v218
  v_accvgpr_write_b32 a91, v219
  v_accvgpr_write_b32 a92, v220
  v_accvgpr_write_b32 a93, v221
  v_accvgpr_write_b32 a94, v222
  v_accvgpr_write_b32 a95, v223
  v_accvgpr_read_b32 v208, a112
  v_accvgpr_read_b32 v209, a113
  v_accvgpr_read_b32 v210, a114
  v_accvgpr_read_b32 v211, a115
  v_accvgpr_read_b32 v212, a116
  v_accvgpr_read_b32 v213, a117
  v_accvgpr_read_b32 v214, a118
  v_accvgpr_read_b32 v215, a119
  v_accvgpr_read_b32 v216, a120
  v_accvgpr_read_b32 v217, a121
  v_accvgpr_read_b32 v218, a122
  v_accvgpr_read_b32 v219, a123
  v_accvgpr_read_b32 v220, a124
  v_accvgpr_read_b32 v221, a125
  v_accvgpr_read_b32 v222, a126
  v_accvgpr_read_b32 v223, a127
  v_mul_f32 v208, v208, v3
  v_mul_f32 v209, v209, v3
  v_mul_f32 v210, v210, v3
  v_mul_f32 v211, v211, v3
  v_mul_f32 v212, v212, v3
  v_mul_f32 v213, v213, v3
  v_mul_f32 v214, v214, v3
  v_mul_f32 v215, v215, v3
  v_mul_f32 v216, v216, v3
  v_mul_f32 v217, v217, v3
  v_mul_f32 v218, v218, v3
  v_mul_f32 v219, v219, v3
  v_mul_f32 v220, v220, v3
  v_mul_f32 v221, v221, v3
  v_mul_f32 v222, v222, v3
  v_mul_f32 v223, v223, v3
  v_accvgpr_write_b32 a112, v208
  v_accvgpr_write_b32 a113, v209
  v_accvgpr_write_b32 a114, v210
  v_accvgpr_write_b32 a115, v211
  v_accvgpr_write_b32 a116, v212
  v_accvgpr_write_b32 a117, v213
  v_accvgpr_write_b32 a118, v214
  v_accvgpr_write_b32 a119, v215
  v_accvgpr_write_b32 a120, v216
  v_accvgpr_write_b32 a121, v217
  v_accvgpr_write_b32 a122, v218
  v_accvgpr_write_b32 a123, v219
  v_accvgpr_write_b32 a124, v220
  v_accvgpr_write_b32 a125, v221
  v_accvgpr_write_b32 a126, v222
  v_accvgpr_write_b32 a127, v223
  v_exp_f32 v208, v160
  v_exp_f32 v209, v161
  v_exp_f32 v210, v162
  v_exp_f32 v211, v163
  v_exp_f32 v212, v164
  v_exp_f32 v213, v165
  v_exp_f32 v214, v166
  v_exp_f32 v215, v167
  v_exp_f32 v216, v168
  v_exp_f32 v217, v169
  v_exp_f32 v218, v170
  v_exp_f32 v219, v171
  v_exp_f32 v220, v172
  v_exp_f32 v221, v173
  v_exp_f32 v222, v174
  v_exp_f32 v223, v175
  s_nop 0
  v_add_f32 v31, v208, v209
  v_add_f32 v31, v31, v210
  v_add_f32 v31, v31, v211
  v_add_f32 v31, v31, v212
  v_add_f32 v31, v31, v213
  v_add_f32 v31, v31, v214
  v_add_f32 v31, v31, v215
  v_add_f32 v31, v31, v216
  v_add_f32 v31, v31, v217
  v_add_f32 v31, v31, v218
  v_add_f32 v31, v31, v219
  v_add_f32 v31, v31, v220
  v_add_f32 v31, v31, v221
  v_add_f32 v31, v31, v222
  v_add_f32 v31, v31, v223
  v_cvt_pk_bf16_f32 v232, v208, v209
  v_cvt_pk_bf16_f32 v233, v210, v211
  v_cvt_pk_bf16_f32 v234, v212, v213
  v_cvt_pk_bf16_f32 v235, v214, v215
  v_cvt_pk_bf16_f32 v236, v216, v217
  v_cvt_pk_bf16_f32 v237, v218, v219
  v_cvt_pk_bf16_f32 v238, v220, v221
  v_cvt_pk_bf16_f32 v239, v222, v223
  s_cmp_eq_u32 s71, 0
  s_cbranch_scc1 L_ret_b1
  s_cmp_eq_u32 s71, 2
  s_cbranch_scc1 L_ret_c1
  s_nop 1
  s_branch L_ret_d1
L_code_end:
.section .rodata,"a"
.p2align 6
.amdhsa_kernel recurrent_scan__sliding_block_cached__glu_gated_glu__prompt_kernel
  .amdhsa_next_free_vgpr 512
  .amdhsa_next_free_sgpr 102
  .amdhsa_accum_offset 256
  .amdhsa_group_segment_fixed_size 0
  .amdhsa_kernarg_size 96
  .amdhsa_user_sgpr_count 2
  .amdhsa_user_sgpr_kernarg_segment_ptr 1
  .amdhsa_system_sgpr_workgroup_id_x 1
.end_amdhsa_kernel
```
